```python
import torch

def _softmax(x, axis=-1):
    return torch.softmax(x, dim=axis)
def _gelu(x):
    return torch.nn.functional.gelu(x, approximate="tanh")
def _silu(x):
    return torch.nn.functional.silu(x)
def _sigmoid(x):
    return torch.sigmoid(x)
def _layernorm(x, axis=-1, eps=1e-5):
    m = x.mean(dim=axis, keepdim=True)
    v = x.var(dim=axis, keepdim=True, unbiased=False)
    return (x - m) / torch.sqrt(v + eps)
def _scatter_add(tgt, idx, src, axis=0):
    return tgt.clone().index_add_(axis, idx, src)
def _segment_sum(src, seg, n):
    out = torch.zeros((n,) + src.shape[1:], dtype=src.dtype)
    return out.index_add_(0, seg, src)
def _pad(x, pw):
    flat = tuple(v for pair in reversed(pw) for v in pair)
    return torch.nn.functional.pad(x, flat)

kernel_name = 'concat_heads__compressed_kv_cla__linear_kernel_hedgehog__prompt'

def setup_inputs():

    _w = (lambda a: (lambda t: t.to(torch.bfloat16) if t.is_floating_point() else t)(torch.as_tensor(a)))
    def _A_setup():
        B, H, Sq, Sk, D, M = 1, 32, 2048, 2048, 128, 576
        Dc = 4 * D
        return {
            "x": _w((lambda *s: torch.randn(*s, dtype=torch.bfloat16) * 0.8)(B, Sq, M)),
            "c_kv": _w((lambda *s: torch.randn(*s, dtype=torch.bfloat16) * 0.4)(B, Sk, Dc)),
            "w_q": _w((lambda *s: torch.randn(*s, dtype=torch.bfloat16) * 6.4)(M, H, D) * (M ** -0.5)),
            "w_uk": _w((lambda *s: torch.randn(*s, dtype=torch.bfloat16) * 6.4)(Dc, H, D) * (Dc ** -0.5)),
            "w_uv": _w((lambda *s: torch.randn(*s, dtype=torch.bfloat16) * 0.4)(Dc, H, D) * (Dc ** -0.5)),
            "w_o": _w((lambda *s: torch.randn(*s, dtype=torch.bfloat16) * 0.4)(H, D, M) * ((H * D) ** -0.5)),
        }
    _A_in = _A_setup()

    def _B_setup():
        B, S, D, H = 1, 2048, 576, 32
        Dh = D // H
        return {
            "x": _w((lambda *s: torch.randn(*s, dtype=torch.bfloat16) * 0.4)(B, S, D)),
            "wqkv": _w((lambda *s: torch.randn(*s, dtype=torch.bfloat16) * 0.4)(D, 3 * D)),
            "w_phi": _w((lambda *s: torch.randn(*s, dtype=torch.bfloat16) * 0.4)(H, Dh, Dh) * (Dh ** -0.5)),
            "wo": _w((lambda *s: torch.randn(*s, dtype=torch.bfloat16) * 0.05)(D, D)),
        }
    _B_in = _B_setup()

    return {
        "A_x": _A_in["x"],
        "A_c_kv": _A_in["c_kv"],
        "A_w_q": _A_in["w_q"],
        "A_w_uk": _A_in["w_uk"],
        "A_w_uv": _A_in["w_uv"],
        "A_w_o": _A_in["w_o"],
        "B_x": _B_in["x"],
        "B_wqkv": _B_in["wqkv"],
        "B_w_phi": _B_in["w_phi"],
        "B_wo": _B_in["wo"],
    }

def reference(A_x, A_c_kv, A_w_q, A_w_uk, A_w_uv, A_w_o, B_x, B_wqkv, B_w_phi, B_wo):
    def _A_ref(x, c_kv, w_q, w_uk, w_uv, w_o):
        B, Sq, M = x.shape[0], x.shape[1], x.shape[2]
        Sk = c_kv.shape[1]
        H, D = w_q.shape[1], w_q.shape[2]
        q = torch.einsum("bqm,mhd->bhqd", x, w_q)
        k = torch.einsum("bkc,chd->bhkd", c_kv, w_uk)
        v = torch.einsum("bkc,chd->bhkd", c_kv, w_uv)
        scores = torch.einsum("bhqd,bhkd->bhqk", q, k) * (D ** -0.5)
        off = Sk - Sq
        qi = torch.arange(Sq)[:, None]
        kj = torch.arange(Sk)[None, :]
        cmask = kj <= (qi + off)
        scores = torch.where(cmask[None, None], scores, -1e9)
        p = _softmax(scores, axis=-1)
        ctx = torch.einsum("bhqk,bhkd->bhqd", p, v)
        return torch.einsum("bhqd,hdm->bqm", ctx, w_o)

    def _B_ref(x, wqkv, w_phi, wo):
        B, S, D = x.shape
        H = 32; Dh = D // H
        qkv = (lambda x, *d: x.permute(*d))((x @ wqkv).reshape(B, S, 3, H, Dh), 2, 0, 3, 1, 4)
        q, k, v = qkv[0], qkv[1], qkv[2]
        pq = torch.einsum("bhsd,hdf->bhsf", q, w_phi)
        pk = torch.einsum("bhsd,hdf->bhsf", k, w_phi)
        phi_q = torch.concatenate([_softmax(pq, axis=-1), _softmax(-pq, axis=-1)], axis=-1)
        phi_k = torch.concatenate([_softmax(pk, axis=-1), _softmax(-pk, axis=-1)], axis=-1)
        kv = torch.einsum("bhsf,bhsd->bhfd", phi_k, v)
        z  = torch.einsum("bhsf->bhf", phi_k)
        num = torch.einsum("bhqf,bhfd->bhqd", phi_q, kv)
        den = torch.einsum("bhqf,bhf->bhq", phi_q, z)[..., None] + 1e-6
        o = num / den
        return (lambda x, *d: x.permute(*d))(o, 0, 2, 1, 3).reshape(B, S, D) @ wo

    a = _A_ref(A_x, A_c_kv, A_w_q, A_w_uk, A_w_uv, A_w_o)
    b = _B_ref(B_x, B_wqkv, B_w_phi, B_wo)
    return torch.concatenate([a, b], axis=-1)
```

```asm
; @launch kernel=concat_heads__compressed_kv_cla__linear_kernel_hedgehog__prompt_kernel grid=(256,1,1) block=(512,1,1) lds=163840
.amdgcn_target "amdgcn-amd-amdhsa--gfx950"
.text
.globl concat_heads__compressed_kv_cla__linear_kernel_hedgehog__prompt_kernel
.p2align 8
.type concat_heads__compressed_kv_cla__linear_kernel_hedgehog__prompt_kernel,@function
concat_heads__compressed_kv_cla__linear_kernel_hedgehog__prompt_kernel:
  s_cmp_ge_u32 s2, 0x100
  s_cbranch_scc1 F_END
  s_cmp_ge_u32 s2, 16
  s_cbranch_scc1 F_NOPF
  s_getpc_b64 s[98:99]
F_PC:
  s_lshr_b32 s6, s2, 3
  s_and_b32 s6, s6, 1
  s_lshl_b32 s6, s6, 16
  v_lshlrev_b32 v31, 7, v0
  v_add_u32 v31, s6, v31
  v_min_u32 v31, F_CODE_END-F_PC-4, v31
  global_load_dword v31, v31, s[98:99]
F_NOPF:
  s_load_dwordx16 s[64:79], s[0:1], 0
  s_load_dwordx8 s[80:87], s[0:1], 64
  s_load_dwordx2 s[88:89], s[0:1], 0x60
  v_lshrrev_b32 v5, 6, v0
  v_and_b32 v1, 63, v0
  v_readfirstlane_b32 s3, v5
  v_lshlrev_b32 v2, 4, v1
  s_and_b32 s6, s2, 7
  s_lshr_b32 s7, s2, 3
  s_lshr_b32 s32, s6, 1
  s_lshl_b32 s32, s32, 3
  s_and_b32 s90, s7, 7
  s_add_u32 s32, s32, s90
  s_and_b32 s33, s6, 1
  s_lshl_b32 s33, s33, 2
  s_lshr_b32 s90, s7, 3
  s_add_u32 s33, s33, s90
  s_lshl_b32 s34, s6, 2
  s_and_b32 s90, s7, 3
  s_add_u32 s34, s34, s90
  s_lshr_b32 s35, s7, 2
  s_lshl_b32 s37, s2, 8
  s_add_u32 s37, s37, 0x7c00000
  v_mov_b32 v4, 1
  v_mov_b32 v6, 0x7fffff00
  v_cmp_eq_u32 vcc, 0, v0
  s_nop 1
  v_cndmask_b32 v3, v6, v0, vcc
  v_mov_b32 v7, 0
  v_cmp_eq_u32 vcc, 0x100, v0
  s_nop 1
  v_cndmask_b32 v30, v6, v7, vcc
  v_lshlrev_b32 v29, 7, v0
  s_lshr_b32 s39, s3, 2
  s_and_b32 s91, s3, 3
  s_xor_b32 s97, s39, 1
  s_and_b32 s6, s91, 1
  s_cmp_eq_u32 s6, 1
  s_cselect_b64 s[98:99], -1, 0
  s_cselect_b32 s43, 64, 0x1b000
  s_mul_i32 s46, s6, 9
  s_add_u32 s90, s46, 0
  s_lshl_b32 s6, s90, 6
  v_add_u32 v5, s6, v1
  v_mul_u32_u24 v6, 0x2493, v5
  v_lshrrev_b32 v6, 18, v6
  v_mul_u32_u24 v7, 28, v6
  v_sub_u32 v7, v5, v7
  v_mul_u32_u24 v8, 57, v7
  v_lshrrev_b32 v8, 9, v8
  v_min_u32 v8, 2, v8
  v_mul_u32_u24 v9, 0x3f0, v8
  v_lshl_add_u32 v9, v7, 4, v9
  v_mul_u32_u24 v6, 0xd80, v6
  v_add_u32 v9, v9, v6
  s_mul_i32 s6, s33, 0x90
  v_add_u32 v114, s6, v9
  s_add_u32 s90, s46, 1
  s_lshl_b32 s6, s90, 6
  v_add_u32 v5, s6, v1
  v_mul_u32_u24 v6, 0x2493, v5
  v_lshrrev_b32 v6, 18, v6
  v_mul_u32_u24 v7, 28, v6
  v_sub_u32 v7, v5, v7
  v_mul_u32_u24 v8, 57, v7
  v_lshrrev_b32 v8, 9, v8
  v_min_u32 v8, 2, v8
  v_mul_u32_u24 v9, 0x3f0, v8
  v_lshl_add_u32 v9, v7, 4, v9
  v_mul_u32_u24 v6, 0xd80, v6
  v_add_u32 v9, v9, v6
  s_mul_i32 s6, s33, 0x90
  v_add_u32 v115, s6, v9
  v_subrev_u32 v115, 0x400, v115
  s_add_u32 s90, s46, 2
  s_lshl_b32 s6, s90, 6
  v_add_u32 v5, s6, v1
  v_mul_u32_u24 v6, 0x2493, v5
  v_lshrrev_b32 v6, 18, v6
  v_mul_u32_u24 v7, 28, v6
  v_sub_u32 v7, v5, v7
  v_mul_u32_u24 v8, 57, v7
  v_lshrrev_b32 v8, 9, v8
  v_min_u32 v8, 2, v8
  v_mul_u32_u24 v9, 0x3f0, v8
  v_lshl_add_u32 v9, v7, 4, v9
  v_mul_u32_u24 v6, 0xd80, v6
  v_add_u32 v9, v9, v6
  s_mul_i32 s6, s33, 0x90
  v_add_u32 v116, s6, v9
  v_subrev_u32 v116, 0x800, v116
  s_add_u32 s90, s46, 3
  s_lshl_b32 s6, s90, 6
  v_add_u32 v5, s6, v1
  v_mul_u32_u24 v6, 0x2493, v5
  v_lshrrev_b32 v6, 18, v6
  v_mul_u32_u24 v7, 28, v6
  v_sub_u32 v7, v5, v7
  v_mul_u32_u24 v8, 57, v7
  v_lshrrev_b32 v8, 9, v8
  v_min_u32 v8, 2, v8
  v_mul_u32_u24 v9, 0x3f0, v8
  v_lshl_add_u32 v9, v7, 4, v9
  v_mul_u32_u24 v6, 0xd80, v6
  v_add_u32 v9, v9, v6
  s_mul_i32 s6, s33, 0x90
  v_add_u32 v117, s6, v9
  v_subrev_u32 v117, 0xc00, v117
  s_add_u32 s90, s46, 4
  s_lshl_b32 s6, s90, 6
  v_add_u32 v5, s6, v1
  v_mul_u32_u24 v6, 0x2493, v5
  v_lshrrev_b32 v6, 18, v6
  v_mul_u32_u24 v7, 28, v6
  v_sub_u32 v7, v5, v7
  v_mul_u32_u24 v8, 57, v7
  v_lshrrev_b32 v8, 9, v8
  v_min_u32 v8, 2, v8
  v_mul_u32_u24 v9, 0x3f0, v8
  v_lshl_add_u32 v9, v7, 4, v9
  v_mul_u32_u24 v6, 0xd80, v6
  v_add_u32 v9, v9, v6
  s_mul_i32 s6, s33, 0x90
  v_add_u32 v118, s6, v9
  s_add_u32 s90, s46, 5
  s_lshl_b32 s6, s90, 6
  v_add_u32 v5, s6, v1
  v_mul_u32_u24 v6, 0x2493, v5
  v_lshrrev_b32 v6, 18, v6
  v_mul_u32_u24 v7, 28, v6
  v_sub_u32 v7, v5, v7
  v_mul_u32_u24 v8, 57, v7
  v_lshrrev_b32 v8, 9, v8
  v_min_u32 v8, 2, v8
  v_mul_u32_u24 v9, 0x3f0, v8
  v_lshl_add_u32 v9, v7, 4, v9
  v_mul_u32_u24 v6, 0xd80, v6
  v_add_u32 v9, v9, v6
  s_mul_i32 s6, s33, 0x90
  v_add_u32 v119, s6, v9
  s_lshl_b32 s6, s32, 6
  s_add_u32 s90, s6, 0
  v_lshrrev_b32 v5, 2, v1
  v_add_u32 v5, s90, v5
  v_mul_u32_u24 v5, 0x480, v5
  v_lshrrev_b32 v6, 4, v1
  v_xor_b32 v6, v6, v1
  v_and_b32 v6, 3, v6
  v_lshl_add_u32 v9, v6, 4, v5
  v_cndmask_b32 v119, v119, v9, s[98:99]
  s_add_u32 s90, s46, 6
  s_lshl_b32 s6, s90, 6
  v_add_u32 v5, s6, v1
  v_mul_u32_u24 v6, 0x2493, v5
  v_lshrrev_b32 v6, 18, v6
  v_mul_u32_u24 v7, 28, v6
  v_sub_u32 v7, v5, v7
  v_mul_u32_u24 v8, 57, v7
  v_lshrrev_b32 v8, 9, v8
  v_min_u32 v8, 2, v8
  v_mul_u32_u24 v9, 0x3f0, v8
  v_lshl_add_u32 v9, v7, 4, v9
  v_mul_u32_u24 v6, 0xd80, v6
  v_add_u32 v9, v9, v6
  s_mul_i32 s6, s33, 0x90
  v_add_u32 v120, s6, v9
  s_lshl_b32 s6, s32, 6
  s_add_u32 s90, s6, 16
  v_lshrrev_b32 v5, 2, v1
  v_add_u32 v5, s90, v5
  v_mul_u32_u24 v5, 0x480, v5
  v_lshrrev_b32 v6, 4, v1
  v_xor_b32 v6, v6, v1
  v_and_b32 v6, 3, v6
  v_lshl_add_u32 v9, v6, 4, v5
  v_cndmask_b32 v120, v120, v9, s[98:99]
  v_subrev_u32 v120, 0x400, v120
  s_add_u32 s90, s46, 7
  s_lshl_b32 s6, s90, 6
  v_add_u32 v5, s6, v1
  v_mul_u32_u24 v6, 0x2493, v5
  v_lshrrev_b32 v6, 18, v6
  v_mul_u32_u24 v7, 28, v6
  v_sub_u32 v7, v5, v7
  v_mul_u32_u24 v8, 57, v7
  v_lshrrev_b32 v8, 9, v8
  v_min_u32 v8, 2, v8
  v_mul_u32_u24 v9, 0x3f0, v8
  v_lshl_add_u32 v9, v7, 4, v9
  v_mul_u32_u24 v6, 0xd80, v6
  v_add_u32 v9, v9, v6
  s_mul_i32 s6, s33, 0x90
  v_add_u32 v121, s6, v9
  s_lshl_b32 s6, s32, 6
  s_add_u32 s90, s6, 32
  v_lshrrev_b32 v5, 2, v1
  v_add_u32 v5, s90, v5
  v_mul_u32_u24 v5, 0x480, v5
  v_lshrrev_b32 v6, 4, v1
  v_xor_b32 v6, v6, v1
  v_and_b32 v6, 3, v6
  v_lshl_add_u32 v9, v6, 4, v5
  v_cndmask_b32 v121, v121, v9, s[98:99]
  v_subrev_u32 v121, 0x800, v121
  s_add_u32 s90, s46, 8
  s_lshl_b32 s6, s90, 6
  v_add_u32 v5, s6, v1
  v_mul_u32_u24 v6, 0x2493, v5
  v_lshrrev_b32 v6, 18, v6
  v_mul_u32_u24 v7, 28, v6
  v_sub_u32 v7, v5, v7
  v_mul_u32_u24 v8, 57, v7
  v_lshrrev_b32 v8, 9, v8
  v_min_u32 v8, 2, v8
  v_mul_u32_u24 v9, 0x3f0, v8
  v_lshl_add_u32 v9, v7, 4, v9
  v_mul_u32_u24 v6, 0xd80, v6
  v_add_u32 v9, v9, v6
  s_mul_i32 s6, s33, 0x90
  v_add_u32 v122, s6, v9
  s_lshl_b32 s6, s32, 6
  s_add_u32 s90, s6, 48
  v_lshrrev_b32 v5, 2, v1
  v_add_u32 v5, s90, v5
  v_mul_u32_u24 v5, 0x480, v5
  v_lshrrev_b32 v6, 4, v1
  v_xor_b32 v6, v6, v1
  v_and_b32 v6, 3, v6
  v_lshl_add_u32 v9, v6, 4, v5
  v_cndmask_b32 v122, v122, v9, s[98:99]
  v_subrev_u32 v122, 0xc00, v122
  s_lshr_b32 s7, s91, 1
  s_mul_i32 s41, s7, 0x1b000
  s_mul_i32 s42, s7, s43
  s_lshl_b32 s43, s43, 1
  s_mul_i32 s47, s43, 9
  s_and_b32 s6, s33, 3
  s_lshl_b32 s6, s6, 1
  s_and_b32 s90, s32, 7
  s_add_u32 s6, s6, s90
  s_cmp_ge_u32 s6, 9
  s_cselect_b32 s90, 9, 0
  s_sub_u32 s6, s6, s90
  s_mul_i32 s6, s6, 1
  s_mul_i32 s90, s6, 0x36000
  s_add_u32 s41, s41, s90
  s_mul_i32 s90, s6, s43
  s_add_u32 s42, s42, s90
  s_mul_i32 s7, s7, 0x4800
  s_lshl_b32 s6, s46, 10
  s_add_u32 s44, s7, s6
  s_add_u32 s44, s44, 0x1000
  s_add_u32 s6, s7, 0x2400
  s_cmp_eq_u32 s46, 0
  s_cselect_b32 s45, s6, s7
  s_waitcnt lgkmcnt(0)
  s_mov_b32 s12, s76
  s_mov_b32 s13, s77
  s_mov_b32 s14, 0x240000
  s_mov_b32 s15, 0x20000
  s_mov_b32 s16, s78
  s_mov_b32 s17, s79
  s_mov_b32 s18, 0x1e6000
  s_mov_b32 s19, 0x20000
  s_mov_b32 s20, s74
  s_mov_b32 s21, s75
  s_mov_b32 s22, 0x480000
  s_mov_b32 s23, 0x20000
  s_mov_b32 s8, s88
  s_mov_b32 s9, s89
  s_mov_b32 s10, 0x10000000
  s_mov_b32 s11, 0x20000
  s_mov_b32 s28, s86
  s_mov_b32 s29, s87
  s_mov_b32 s30, 0x100
  s_mov_b32 s31, 0x20000
  s_cmp_eq_u32 s46, 0
  s_cselect_b32 s24, s16, s12
  s_cselect_b32 s25, s17, s13
  s_cselect_b32 s26, s18, s14
  s_mov_b32 s27, 0x20000
  s_cmp_eq_u32 s97, 0
  s_cbranch_scc1 ONLY1
  s_add_u32 m0, s44, 0x4000
  s_nop 0
  buffer_load_dwordx4 v114, s[16:19], s41 offen lds
  buffer_load_dwordx4 v115, s[16:19], s41 offen offset:1024 lds
  buffer_load_dwordx4 v116, s[16:19], s41 offen offset:2048 lds
  buffer_load_dwordx4 v117, s[16:19], s41 offen offset:3072 lds
  s_add_u32 m0, s44, 0x5000
  s_nop 0
  buffer_load_dwordx4 v118, s[16:19], s41 offen lds
  s_add_u32 m0, s45, 0x4000
  s_nop 0
  buffer_load_dwordx4 v119, s[24:27], s42 offen lds
  buffer_load_dwordx4 v120, s[24:27], s42 offen offset:1024 lds
  buffer_load_dwordx4 v121, s[24:27], s42 offen offset:2048 lds
  buffer_load_dwordx4 v122, s[24:27], s42 offen offset:3072 lds
  s_add_u32 s41, s41, 0x36000
  s_add_u32 s42, s42, s43
  s_cmp_ge_u32 s41, 0x1e6000
  s_cselect_b32 s6, 0x1e6000, 0
  s_cselect_b32 s7, s47, 0
  s_sub_u32 s41, s41, s6
  s_sub_u32 s42, s42, s7
  s_add_u32 m0, s44, 0xd000
  s_nop 0
  buffer_load_dwordx4 v114, s[16:19], s41 offen lds
  buffer_load_dwordx4 v115, s[16:19], s41 offen offset:1024 lds
  buffer_load_dwordx4 v116, s[16:19], s41 offen offset:2048 lds
  buffer_load_dwordx4 v117, s[16:19], s41 offen offset:3072 lds
  s_add_u32 m0, s44, 0xe000
  s_nop 0
  buffer_load_dwordx4 v118, s[16:19], s41 offen lds
  s_add_u32 m0, s45, 0xd000
  s_nop 0
  buffer_load_dwordx4 v119, s[24:27], s42 offen lds
  buffer_load_dwordx4 v120, s[24:27], s42 offen offset:1024 lds
  buffer_load_dwordx4 v121, s[24:27], s42 offen offset:2048 lds
  buffer_load_dwordx4 v122, s[24:27], s42 offen offset:3072 lds
  s_add_u32 s41, s41, 0x36000
  s_add_u32 s42, s42, s43
  s_cmp_ge_u32 s41, 0x1e6000
  s_cselect_b32 s6, 0x1e6000, 0
  s_cselect_b32 s7, s47, 0
  s_sub_u32 s41, s41, s6
  s_sub_u32 s42, s42, s7
ONLY1:
  v_subrev_u32 v5, 0x100, v0
  v_cmp_gt_u32 vcc, 64, v5
  v_lshlrev_b32 v5, 2, v5
  v_mov_b32 v6, 0x7fffff00
  v_cndmask_b32 v5, v6, v5, vcc
  v_mov_b32 v7, 0
  s_cmp_eq_u32 s39, 0
  s_cbranch_scc1 ONLY2
  buffer_store_dword v7, v5, s[8:11], s37 offen sc1
  s_mul_i32 s90, s2, 0x4800
  s_mul_i32 s6, s91, 0x1400
  s_add_u32 s7, s6, s90
  s_add_u32 m0, s6, 0x1f000
  s_nop 0
  buffer_load_dwordx4 v2, s[20:23], s7 offen offset:0 nt lds
  buffer_load_dwordx4 v2, s[20:23], s7 offen offset:1024 nt lds
  buffer_load_dwordx4 v2, s[20:23], s7 offen offset:2048 nt lds
  buffer_load_dwordx4 v2, s[20:23], s7 offen offset:3072 nt lds
  s_add_u32 s7, s7, 0x1000
  s_add_u32 m0, s6, 0x20000
  s_nop 0
  buffer_load_dwordx4 v2, s[20:23], s7 offen offset:0 nt lds
  s_add_u32 s7, s7, 0x1000
ONLY2:
  s_add_u32 s6, s2, 0x100
  s_cmp_eq_u32 s3, 7
  s_cselect_b32 s90, s2, s6
  s_cselect_b32 s49, 1, 0
  s_cmp_lt_u32 s2, 32
  s_cselect_b32 s6, 6, 0x63
  s_cmp_eq_u32 s3, s6
  s_cselect_b32 s49, 1, s49
  s_and_b32 s6, s90, 7
  s_mul_i32 s48, s6, 0xa4400
  s_mul_i32 s62, s6, 0x90
  s_lshr_b32 s90, s90, 3
  s_add_u32 s6, s90, 0x100
  s_mul_i32 s6, s6, 0x900
  s_add_u32 s48, s48, s6
  s_add_u32 s48, s48, 0x7400000
  s_mul_i32 s6, s90, 18
  s_mul_i32 s7, s90, 0x90
  s_sub_u32 s7, s7, 0x11f8
  s_cmp_lt_u32 s90, 32
  s_cselect_b32 s6, s6, s7
  s_cselect_b32 s90, 1, 18
  s_mul_i32 s6, s6, 0x480
  s_add_u32 s62, s62, s6
  s_and_b32 s7, s3, 1
  s_mul_i32 s61, s7, 0xc00
  s_add_u32 s61, s61, 0x24000
  s_cmp_eq_u32 s49, 0
  s_cbranch_scc1 ONLY3
  s_mov_b32 s56, s82
  s_mov_b32 s57, s83
  s_mov_b32 s58, 0xa2000
  s_mov_b32 s59, 0x20000
  s_mov_b32 m0, s61
  v_add_u32 v5, 0, v1
  v_min_u32 v5, 0x8f, v5
  v_mul_u32_u24 v6, 57, v5
  v_lshrrev_b32 v6, 9, v6
  v_mul_u32_u24 v7, 9, v6
  v_sub_u32 v5, v5, v7
  v_lshrrev_b32 v7, 3, v6
  v_and_b32 v8, 3, v6
  v_lshl_add_u32 v7, v7, 2, v8
  v_mul_u32_u24 v7, s90, v7
  v_bfe_u32 v8, v6, 2, 1
  v_mad_u32_u24 v7, v8, 9, v7
  v_mul_u32_u24 v7, 0x480, v7
  v_lshl_add_u32 v7, v5, 4, v7
  v_add_u32 v7, 0x1000, v7
  s_mov_b32 s6, s62
  v_add_u32 v7, s6, v7
  v_subrev_u32 v7, 0x1000, v7
  buffer_load_dwordx4 v7, s[56:59], 0 offen lds
  v_add_u32 v5, 64, v1
  v_min_u32 v5, 0x8f, v5
  v_mul_u32_u24 v6, 57, v5
  v_lshrrev_b32 v6, 9, v6
  v_mul_u32_u24 v7, 9, v6
  v_sub_u32 v5, v5, v7
  v_lshrrev_b32 v7, 3, v6
  v_and_b32 v8, 3, v6
  v_lshl_add_u32 v7, v7, 2, v8
  v_mul_u32_u24 v7, s90, v7
  v_bfe_u32 v8, v6, 2, 1
  v_mad_u32_u24 v7, v8, 9, v7
  v_mul_u32_u24 v7, 0x480, v7
  v_lshl_add_u32 v7, v5, 4, v7
  v_add_u32 v7, 0xc00, v7
  s_mov_b32 s6, s62
  v_add_u32 v7, s6, v7
  v_subrev_u32 v7, 0x1000, v7
  buffer_load_dwordx4 v7, s[56:59], 0 offen offset:1024 lds
  v_add_u32 v5, 0x80, v1
  v_min_u32 v5, 0x8f, v5
  v_mul_u32_u24 v6, 57, v5
  v_lshrrev_b32 v6, 9, v6
  v_mul_u32_u24 v7, 9, v6
  v_sub_u32 v5, v5, v7
  v_lshrrev_b32 v7, 3, v6
  v_and_b32 v8, 3, v6
  v_lshl_add_u32 v7, v7, 2, v8
  v_mul_u32_u24 v7, s90, v7
  v_bfe_u32 v8, v6, 2, 1
  v_mad_u32_u24 v7, v8, 9, v7
  v_mul_u32_u24 v7, 0x480, v7
  v_lshl_add_u32 v7, v5, 4, v7
  v_add_u32 v7, 0x800, v7
  s_mov_b32 s6, s62
  v_add_u32 v7, s6, v7
  v_subrev_u32 v7, 0x1000, v7
  buffer_load_dwordx4 v7, s[56:59], 0 offen offset:2048 lds
ONLY3:
  s_lshl_b32 s6, s33, 2
  s_add_u32 s40, s91, s6
  v_bfe_u32 v5, v1, 3, 2
  v_and_b32 v6, 3, v1
  v_lshl_add_u32 v25, v5, 2, v6
  v_bfe_u32 v26, v1, 2, 1
  s_mov_b32 s20, s80
  s_mov_b32 s21, s81
  s_mov_b32 s22, 0x5100
  s_mov_b32 s23, 0x20000
  v_mad_u32_u24 v5, v26, 9, v25
  v_lshrrev_b32 v6, 5, v1
  v_mul_u32_u24 v7, 0x120, v6
  v_lshl_add_u32 v7, v5, 1, v7
  s_mul_i32 s6, s40, 0x288
  v_add_u32 v7, s6, v7
  v_mov_b32 v9, 0x7fffff00
  v_cmp_lt_u32 s[4:5], v25, 9
  s_nop 1
  v_cndmask_b32 v7, v9, v7, s[4:5]
  v_cmp_eq_u32 s[4:5], v6, 0
  s_nop 1
  v_cndmask_b32 v8, v9, v7, s[4:5]
  buffer_load_ushort v88, v7, s[20:23], 0 offen
  buffer_load_ushort v89, v7, s[20:23], 0 offen offset:36
  buffer_load_ushort v90, v7, s[20:23], 0 offen offset:72
  buffer_load_ushort v91, v7, s[20:23], 0 offen offset:108
  buffer_load_ushort v92, v7, s[20:23], 0 offen offset:144
  buffer_load_ushort v93, v7, s[20:23], 0 offen offset:180
  buffer_load_ushort v94, v7, s[20:23], 0 offen offset:216
  buffer_load_ushort v95, v7, s[20:23], 0 offen offset:252
  buffer_load_ushort v112, v8, s[20:23], 0 offen offset:576
  buffer_load_ushort v113, v8, s[20:23], 0 offen offset:612
  v_and_b32 v5, 31, v1
  v_lshlrev_b32 v6, 6, v5
  v_lshrrev_b32 v7, 5, v1
  v_bfe_u32 v8, v1, 2, 2
  v_xor_b32 v7, v7, v8
  v_lshl_add_u32 v16, v7, 4, v6
  v_xor_b32 v18, 32, v16
  v_lshrrev_b32 v5, 5, v1
  v_bfe_u32 v6, v1, 2, 2
  v_lshl_add_u32 v5, v5, 3, v6
  v_mul_u32_u24 v5, 0x1c0, v5
  v_bfe_u32 v7, v1, 4, 1
  v_lshl_add_u32 v5, v7, 5, v5
  v_and_b32 v7, 3, v1
  v_lshl_add_u32 v8, v7, 3, v5
  s_lshl_b32 s6, s3, 6
  v_add_u32 v20, s6, v8
  v_add_u32 v17, 0x10000, v16
  v_add_u32 v19, 0x10000, v18
  v_add_u32 v21, 0x10000, v20
  s_sub_u32 s6, 15, s35
  s_cmp_eq_u32 s39, 0
  s_cselect_b32 s90, s35, s6
  s_add_u32 s94, s90, 1
  s_lshl_b32 s94, s94, 2
  s_add_u32 s95, s6, 1
  s_lshl_b32 s95, s95, 2
  s_lshl_b32 s96, s90, 7
  s_lshl_b32 s7, s91, 5
  s_add_u32 s96, s96, s7
  s_lshl_b32 s6, s35, 8
  s_lshl_b32 s7, s91, 6
  s_add_u32 s90, s6, s7
  v_lshrrev_b32 v5, 2, v1
  v_add_u32 v5, s90, v5
  v_mul_u32_u24 v5, 0x400, v5
  v_lshrrev_b32 v6, 4, v1
  v_xor_b32 v6, v6, v1
  v_and_b32 v6, 3, v6
  v_lshl_add_u32 v10, v6, 4, v5
  v_add_u32 v11, 0x3c00, v10
  v_add_u32 v12, 0x7800, v10
  v_add_u32 v13, 0xb400, v10
  s_lshl_b32 s6, s91, 3
  v_lshrrev_b32 v5, 4, v1
  v_add_u32 v6, s6, v5
  v_lshlrev_b32 v6, 13, v6
  v_lshrrev_b32 v7, 2, v1
  v_xor_b32 v7, v7, v5
  v_and_b32 v7, 3, v7
  v_and_b32 v8, 3, v1
  v_lshl_add_u32 v7, v7, 2, v8
  v_lshl_add_u32 v6, v7, 4, v6
  s_lshl_b32 s6, s34, 8
  v_add_u32 v14, s6, v6
  v_add_u32 v15, 0x7c00, v14
  s_lshl_b32 s50, s91, 12
  s_lshl_b32 s51, s91, 11
  s_add_u32 s51, s51, 0x4000
  s_and_b32 s54, s3, 1
  s_lshr_b32 s55, s3, 1
  s_and_b32 s6, s34, 3
  s_lshl_b32 s6, s6, 1
  s_add_u32 s61, s6, s35
  s_lshl_b32 s61, s61, 1
  s_and_b32 s61, s61, 15
  s_mul_i32 s61, s61, 0
  v_lshrrev_b32 v5, 5, v1
  v_bfe_u32 v6, v1, 2, 2
  v_lshl_add_u32 v5, v5, 2, v6
  v_mul_u32_u24 v5, 0x480, v5
  v_bfe_u32 v7, v1, 4, 1
  v_lshl_add_u32 v5, v7, 5, v5
  v_and_b32 v7, 3, v1
  v_lshl_add_u32 v8, v7, 3, v5
  s_lshr_b32 s6, s3, 1
  s_mul_i32 s6, s6, 0x120
  s_lshl_b32 s7, s54, 7
  s_add_u32 s6, s6, s7
  s_add_u32 s6, s6, 0x1f000
  v_add_u32 v104, s6, v8
  s_mul_i32 s6, s3, 0x90
  s_add_u32 s6, s6, 0x1f000
  v_and_b32 v5, 31, v1
  v_lshrrev_b32 v6, 5, v1
  v_bfe_u32 v9, v1, 2, 2
  v_lshl_add_u32 v9, v6, 2, v9
  v_mul_u32_u24 v9, 0x3f0, v9
  v_sub_u32 v9, v8, v9
  s_and_b32 s7, s3, 1
  s_mul_i32 s7, s7, 0xc00
  s_add_u32 s7, s7, 0x24000
  v_add_u32 v110, s7, v9
  v_lshlrev_b32 v9, 7, v6
  v_lshl_add_u32 v9, v5, 4, v9
  v_mov_b32 v7, 0x7fffff00
  v_cmp_gt_u32 vcc, 8, v5
  s_nop 1
  v_cndmask_b32 v106, v7, v9, vcc
  v_lshlrev_b32 v9, 8, v6
  v_lshl_add_u32 v9, v5, 4, v9
  s_lshl_b32 s7, s54, 4
  v_cmp_gt_u32 vcc, s7, v5
  s_nop 1
  v_cndmask_b32 v111, v7, v9, vcc
  s_lshr_b32 s6, s3, 1
  s_lshl_b32 s6, s6, 8
  s_add_u32 s6, s6, s2
  s_lshl_b32 s60, s6, 12
  s_lshl_b32 s7, s54, 11
  s_add_u32 s60, s60, s7
  s_add_u32 s60, s60, 0x3000000
  s_lshl_b32 s6, s6, 9
  s_add_u32 s6, s6, 0x3400000
  v_add_u32 v111, s6, v111
  s_cmp_lg_u32 s97, 0
  s_cselect_b64 vcc, -1, 0
  s_cbranch_vccz B1_G1
  s_waitcnt vmcnt(19)
B1_G1:
  s_waitcnt lgkmcnt(0)
  s_barrier
  ds_read_b128 v[64:67], v16 offset:16384
  ds_read_b64_tr_b16 v[80:81], v20 offset:20480
  ds_read_b64_tr_b16 v[82:83], v20 offset:22272
  ds_read_b128 v[68:71], v16 offset:18432
  s_cbranch_vccz B1_G2
  s_add_u32 m0, s44, 0x16000
  s_nop 0
  buffer_load_dwordx4 v114, s[16:19], s41 offen lds
  buffer_load_dwordx4 v115, s[16:19], s41 offen offset:1024 lds
  buffer_load_dwordx4 v116, s[16:19], s41 offen offset:2048 lds
  buffer_load_dwordx4 v117, s[16:19], s41 offen offset:3072 lds
  s_add_u32 m0, s44, 0x17000
  s_nop 0
  buffer_load_dwordx4 v118, s[16:19], s41 offen lds
  s_add_u32 m0, s45, 0x16000
  s_nop 0
  buffer_load_dwordx4 v119, s[24:27], s42 offen lds
  buffer_load_dwordx4 v120, s[24:27], s42 offen offset:1024 lds
  buffer_load_dwordx4 v121, s[24:27], s42 offen offset:2048 lds
  buffer_load_dwordx4 v122, s[24:27], s42 offen offset:3072 lds
  s_add_u32 s41, s41, 0x36000
  s_add_u32 s42, s42, s43
  s_cmp_ge_u32 s41, 0x1e6000
  s_cselect_b32 s6, 0x1e6000, 0
  s_cselect_b32 s7, s47, 0
  s_sub_u32 s41, s41, s6
  s_sub_u32 s42, s42, s7
B1_G2:
  s_waitcnt lgkmcnt(1)
  v_mfma_f32_32x32x16_bf16 v[32:47], v[64:67], v[80:83], 0
  ds_read_b128 v[72:75], v18 offset:16384
  ds_read_b64_tr_b16 v[84:85], v20 offset:27648
  s_waitcnt lgkmcnt(2)
  v_mfma_f32_32x32x16_bf16 v[48:63], v[68:71], v[80:83], 0
  ds_read_b64_tr_b16 v[86:87], v20 offset:29440
  ds_read_b128 v[76:79], v18 offset:18432
  s_waitcnt lgkmcnt(1)
  v_mfma_f32_32x32x16_bf16 v[32:47], v[72:75], v[84:87], v[32:47]
  ds_read_b128 v[64:67], v16 offset:34816
  ds_read_b64_tr_b16 v[80:81], v20 offset:38912
  s_waitcnt lgkmcnt(2)
  v_mfma_f32_32x32x16_bf16 v[48:63], v[76:79], v[84:87], v[48:63]
  ds_read_b64_tr_b16 v[82:83], v20 offset:40704
  ds_read_b128 v[68:71], v16 offset:36864
  s_waitcnt lgkmcnt(1)
  v_mfma_f32_32x32x16_bf16 v[32:47], v[64:67], v[80:83], v[32:47]
  ds_read_b128 v[72:75], v18 offset:34816
  ds_read_b64_tr_b16 v[84:85], v20 offset:46080
  s_waitcnt lgkmcnt(2)
  v_mfma_f32_32x32x16_bf16 v[48:63], v[68:71], v[80:83], v[48:63]
  ds_read_b64_tr_b16 v[86:87], v20 offset:47872
  ds_read_b128 v[76:79], v18 offset:36864
  s_cbranch_vccz B1_G3
  s_waitcnt vmcnt(9)
B1_G3:
  s_waitcnt lgkmcnt(0)
  s_barrier
  v_mfma_f32_32x32x16_bf16 v[32:47], v[72:75], v[84:87], v[32:47]
  ds_read_b128 v[64:67], v16 offset:53248
  ds_read_b64_tr_b16 v[80:81], v20 offset:57344
  s_cbranch_vccz B1_G4
  s_add_u32 m0, s44, 0x4000
  s_nop 0
  buffer_load_dwordx4 v114, s[16:19], s41 offen lds
  buffer_load_dwordx4 v115, s[16:19], s41 offen offset:1024 lds
  buffer_load_dwordx4 v116, s[16:19], s41 offen offset:2048 lds
  buffer_load_dwordx4 v117, s[16:19], s41 offen offset:3072 lds
  s_add_u32 m0, s44, 0x5000
  s_nop 0
  buffer_load_dwordx4 v118, s[16:19], s41 offen lds
  s_add_u32 m0, s45, 0x4000
  s_nop 0
  buffer_load_dwordx4 v119, s[24:27], s42 offen lds
  buffer_load_dwordx4 v120, s[24:27], s42 offen offset:1024 lds
  buffer_load_dwordx4 v121, s[24:27], s42 offen offset:2048 lds
  buffer_load_dwordx4 v122, s[24:27], s42 offen offset:3072 lds
  s_add_u32 s41, s41, 0x36000
  s_add_u32 s42, s42, s43
  s_cmp_ge_u32 s41, 0x1e6000
  s_cselect_b32 s6, 0x1e6000, 0
  s_cselect_b32 s7, s47, 0
  s_sub_u32 s41, s41, s6
  s_sub_u32 s42, s42, s7
B1_G4:
  s_cmp_eq_u32 s39, 0
  s_cbranch_scc1 ONLY4
  s_waitcnt vmcnt(0)
ONLY4:
  v_mfma_f32_32x32x16_bf16 v[48:63], v[76:79], v[84:87], v[48:63]
  ds_read_b64_tr_b16 v[82:83], v20 offset:59136
  ds_read_b128 v[68:71], v16 offset:55296
  s_waitcnt lgkmcnt(1)
  v_mfma_f32_32x32x16_bf16 v[32:47], v[64:67], v[80:83], v[32:47]
  ds_read_b128 v[72:75], v18 offset:53248
  ds_read_b64_tr_b16 v[84:85], v20 offset:64512
  s_waitcnt lgkmcnt(2)
  v_mfma_f32_32x32x16_bf16 v[48:63], v[68:71], v[80:83], v[48:63]
  ds_read_b64_tr_b16 v[86:87], v21 offset:768
  ds_read_b128 v[76:79], v18 offset:55296
  s_waitcnt lgkmcnt(1)
  v_mfma_f32_32x32x16_bf16 v[32:47], v[72:75], v[84:87], v[32:47]
  ds_read_b128 v[64:67], v17 offset:6144
  ds_read_b64_tr_b16 v[80:81], v21 offset:10240
  s_cmp_lg_u32 s3, 4
  s_cbranch_scc1 ONLYW5
  buffer_atomic_add v4, v30, s[28:31], 0 offen sc1
ONLYW5:
  s_waitcnt lgkmcnt(2)
  v_mfma_f32_32x32x16_bf16 v[48:63], v[76:79], v[84:87], v[48:63]
  ds_read_b64_tr_b16 v[82:83], v21 offset:12032
  ds_read_b128 v[68:71], v17 offset:8192
  s_waitcnt lgkmcnt(1)
  v_mfma_f32_32x32x16_bf16 v[32:47], v[64:67], v[80:83], v[32:47]
  ds_read_b128 v[72:75], v19 offset:6144
  ds_read_b64_tr_b16 v[84:85], v21 offset:17408
  s_waitcnt lgkmcnt(2)
  v_mfma_f32_32x32x16_bf16 v[48:63], v[68:71], v[80:83], v[48:63]
  ds_read_b64_tr_b16 v[86:87], v21 offset:19200
  ds_read_b128 v[76:79], v19 offset:8192
  s_cbranch_vccz B1_G5
  s_waitcnt vmcnt(9)
B1_G5:
  s_waitcnt lgkmcnt(0)
  s_barrier
  v_mfma_f32_32x32x16_bf16 v[32:47], v[72:75], v[84:87], v[32:47]
  ds_read_b128 v[64:67], v17 offset:24576
  ds_read_b64_tr_b16 v[80:81], v21 offset:28672
  s_cbranch_vccz B1_G6
  s_add_u32 m0, s44, 0xd000
  s_nop 0
  buffer_load_dwordx4 v114, s[16:19], s41 offen lds
  buffer_load_dwordx4 v115, s[16:19], s41 offen offset:1024 lds
  buffer_load_dwordx4 v116, s[16:19], s41 offen offset:2048 lds
  buffer_load_dwordx4 v117, s[16:19], s41 offen offset:3072 lds
  s_add_u32 m0, s44, 0xe000
  s_nop 0
  buffer_load_dwordx4 v118, s[16:19], s41 offen lds
  s_add_u32 m0, s45, 0xd000
  s_nop 0
  buffer_load_dwordx4 v119, s[24:27], s42 offen lds
  buffer_load_dwordx4 v120, s[24:27], s42 offen offset:1024 lds
  buffer_load_dwordx4 v121, s[24:27], s42 offen offset:2048 lds
  buffer_load_dwordx4 v122, s[24:27], s42 offen offset:3072 lds
  s_add_u32 s41, s41, 0x36000
  s_add_u32 s42, s42, s43
  s_cmp_ge_u32 s41, 0x1e6000
  s_cselect_b32 s6, 0x1e6000, 0
  s_cselect_b32 s7, s47, 0
  s_sub_u32 s41, s41, s6
  s_sub_u32 s42, s42, s7
B1_G6:
  ds_read_b64_tr_b16 a[0:1], v104
  v_mfma_f32_32x32x16_bf16 v[48:63], v[76:79], v[84:87], v[48:63]
  ds_read_b64_tr_b16 v[82:83], v21 offset:30464
  ds_read_b128 v[68:71], v17 offset:26624
  ds_read_b64_tr_b16 a[2:3], v104 offset:9216
  s_waitcnt lgkmcnt(2)
  v_mfma_f32_32x32x16_bf16 v[32:47], v[64:67], v[80:83], v[32:47]
  ds_read_b128 v[72:75], v19 offset:24576
  ds_read_b64_tr_b16 v[84:85], v21 offset:35840
  ds_read_b64_tr_b16 a[4:5], v104 offset:64
  s_waitcnt lgkmcnt(4)
  v_mfma_f32_32x32x16_bf16 v[48:63], v[68:71], v[80:83], v[48:63]
  ds_read_b64_tr_b16 v[86:87], v21 offset:37632
  ds_read_b128 v[76:79], v19 offset:26624
  ds_read_b64_tr_b16 a[6:7], v104 offset:9280
  s_waitcnt lgkmcnt(2)
  v_mfma_f32_32x32x16_bf16 v[32:47], v[72:75], v[84:87], v[32:47]
  ds_read_b128 v[64:67], v17 offset:43008
  ds_read_b64_tr_b16 v[80:81], v21 offset:47104
  ds_read_b64_tr_b16 a[8:9], v104 offset:128
  ds_read_b64_tr_b16 a[10:11], v104 offset:9344
  s_waitcnt lgkmcnt(5)
  v_mfma_f32_32x32x16_bf16 v[48:63], v[76:79], v[84:87], v[48:63]
  ds_read_b64_tr_b16 v[82:83], v21 offset:48896
  ds_read_b128 v[68:71], v17 offset:45056
  buffer_store_dwordx4 a[0:3], v2, s[8:11], s60 offen sc1
  s_waitcnt lgkmcnt(1)
  v_mfma_f32_32x32x16_bf16 v[32:47], v[64:67], v[80:83], v[32:47]
  ds_read_b128 v[72:75], v19 offset:43008
  ds_read_b64_tr_b16 v[84:85], v21 offset:54272
  buffer_store_dwordx4 a[4:7], v2, s[8:11], s60 offen offset:1024 sc1
  s_waitcnt lgkmcnt(2)
  v_mfma_f32_32x32x16_bf16 v[48:63], v[68:71], v[80:83], v[48:63]
  ds_read_b64_tr_b16 v[86:87], v21 offset:56064
  ds_read_b128 v[76:79], v19 offset:45056
  buffer_store_dwordx4 a[8:11], v111, s[8:11], 0 offen sc1
  s_cbranch_vccz B1_G7
  s_waitcnt vmcnt(9)
B1_G7:
  s_waitcnt lgkmcnt(0)
  s_barrier
  v_mfma_f32_32x32x16_bf16 v[32:47], v[72:75], v[84:87], v[32:47]
  ds_read_b128 v[64:67], v16 offset:16384
  ds_read_b64_tr_b16 v[80:81], v20 offset:20480
  s_cbranch_vccz B1_G8
  s_add_u32 m0, s44, 0x16000
  s_nop 0
  buffer_load_dwordx4 v114, s[16:19], s41 offen lds
  buffer_load_dwordx4 v115, s[16:19], s41 offen offset:1024 lds
  buffer_load_dwordx4 v116, s[16:19], s41 offen offset:2048 lds
  buffer_load_dwordx4 v117, s[16:19], s41 offen offset:3072 lds
  s_add_u32 m0, s44, 0x17000
  s_nop 0
  buffer_load_dwordx4 v118, s[16:19], s41 offen lds
  s_add_u32 m0, s45, 0x16000
  s_nop 0
  buffer_load_dwordx4 v119, s[24:27], s42 offen lds
  buffer_load_dwordx4 v120, s[24:27], s42 offen offset:1024 lds
  buffer_load_dwordx4 v121, s[24:27], s42 offen offset:2048 lds
  buffer_load_dwordx4 v122, s[24:27], s42 offen offset:3072 lds
  s_add_u32 s41, s41, 0x36000
  s_add_u32 s42, s42, s43
  s_cmp_ge_u32 s41, 0x1e6000
  s_cselect_b32 s6, 0x1e6000, 0
  s_cselect_b32 s7, s47, 0
  s_sub_u32 s41, s41, s6
  s_sub_u32 s42, s42, s7
B1_G8:
  v_lshl_or_b32 v96, v89, 16, v88
  v_lshl_or_b32 v97, v91, 16, v90
  v_mfma_f32_32x32x16_bf16 v[48:63], v[76:79], v[84:87], v[48:63]
  ds_read_b64_tr_b16 v[82:83], v20 offset:22272
  ds_read_b128 v[68:71], v16 offset:18432
  v_lshl_or_b32 v98, v93, 16, v92
  v_lshl_or_b32 v99, v95, 16, v94
  v_lshl_or_b32 v100, v113, 16, v112
  s_waitcnt lgkmcnt(1)
  v_mfma_f32_32x32x16_bf16 v[32:47], v[64:67], v[80:83], v[32:47]
  ds_read_b128 v[72:75], v18 offset:16384
  ds_read_b64_tr_b16 v[84:85], v20 offset:27648
  v_mov_b32 v101, 0
  v_mov_b32 v102, 0
  s_waitcnt lgkmcnt(2)
  v_mfma_f32_32x32x16_bf16 v[48:63], v[68:71], v[80:83], v[48:63]
  ds_read_b64_tr_b16 v[86:87], v20 offset:29440
  ds_read_b128 v[76:79], v18 offset:18432
  v_mov_b32 v103, 0
  s_cmp_eq_u32 s49, 0
  s_cbranch_scc1 ONLY6
  ds_read_b64_tr_b16 a[0:1], v110
  ds_read_b64_tr_b16 a[2:3], v110 offset:1152
  ds_read_b64_tr_b16 a[4:5], v110 offset:64
  ds_read_b64_tr_b16 a[6:7], v110 offset:1216
  ds_read_b64_tr_b16 a[8:9], v110 offset:128
  ds_read_b64_tr_b16 a[10:11], v110 offset:1280
  s_waitcnt lgkmcnt(4)
  buffer_store_dwordx4 a[0:3], v2, s[8:11], s48 offen sc1
  s_waitcnt lgkmcnt(2)
  buffer_store_dwordx4 a[4:7], v2, s[8:11], s48 offen offset:1024 sc1
  s_waitcnt lgkmcnt(0)
  buffer_store_dwordx4 a[8:11], v106, s[8:11], s48 offen offset:2048 sc1
ONLY6:
  s_waitcnt lgkmcnt(1)
  v_mfma_f32_32x32x16_bf16 v[32:47], v[72:75], v[84:87], v[32:47]
  ds_read_b128 v[64:67], v16 offset:34816
  ds_read_b64_tr_b16 v[80:81], v20 offset:38912
  s_waitcnt lgkmcnt(2)
  v_mfma_f32_32x32x16_bf16 v[48:63], v[76:79], v[84:87], v[48:63]
  ds_read_b64_tr_b16 v[82:83], v20 offset:40704
  ds_read_b128 v[68:71], v16 offset:36864
  s_waitcnt lgkmcnt(1)
  v_mfma_f32_32x32x16_bf16 v[32:47], v[64:67], v[80:83], v[32:47]
  ds_read_b128 v[72:75], v18 offset:34816
  ds_read_b64_tr_b16 v[84:85], v20 offset:46080
  s_waitcnt lgkmcnt(2)
  v_mfma_f32_32x32x16_bf16 v[48:63], v[68:71], v[80:83], v[48:63]
  ds_read_b64_tr_b16 v[86:87], v20 offset:47872
  ds_read_b128 v[76:79], v18 offset:36864
  s_cbranch_vccz B1_G9
  s_waitcnt vmcnt(9)
B1_G9:
  s_waitcnt lgkmcnt(0)
  s_barrier
  v_mfma_f32_32x32x16_bf16 v[32:47], v[72:75], v[84:87], v[32:47]
  ds_read_b128 v[64:67], v16 offset:53248
  ds_read_b64_tr_b16 v[80:81], v20 offset:57344
  s_cbranch_vccz B1_G10
  s_add_u32 m0, s44, 0x4000
  s_nop 0
  buffer_load_dwordx4 v114, s[16:19], s41 offen lds
  buffer_load_dwordx4 v115, s[16:19], s41 offen offset:1024 lds
  buffer_load_dwordx4 v116, s[16:19], s41 offen offset:2048 lds
  buffer_load_dwordx4 v117, s[16:19], s41 offen offset:3072 lds
  s_add_u32 m0, s44, 0x5000
  s_nop 0
  buffer_load_dwordx4 v118, s[16:19], s41 offen lds
  s_add_u32 m0, s45, 0x4000
  s_nop 0
  buffer_load_dwordx4 v119, s[24:27], s42 offen lds
  buffer_load_dwordx4 v120, s[24:27], s42 offen offset:1024 lds
  buffer_load_dwordx4 v121, s[24:27], s42 offen offset:2048 lds
  buffer_load_dwordx4 v122, s[24:27], s42 offen offset:3072 lds
  s_add_u32 s41, s41, 0x36000
  s_add_u32 s42, s42, s43
  s_cmp_ge_u32 s41, 0x1e6000
  s_cselect_b32 s6, 0x1e6000, 0
  s_cselect_b32 s7, s47, 0
  s_sub_u32 s41, s41, s6
  s_sub_u32 s42, s42, s7
B1_G10:
  v_mfma_f32_32x32x16_bf16 v[48:63], v[76:79], v[84:87], v[48:63]
  ds_read_b64_tr_b16 v[82:83], v20 offset:59136
  ds_read_b128 v[68:71], v16 offset:55296
  s_waitcnt lgkmcnt(1)
  v_mfma_f32_32x32x16_bf16 v[32:47], v[64:67], v[80:83], v[32:47]
  ds_read_b128 v[72:75], v18 offset:53248
  ds_read_b64_tr_b16 v[84:85], v20 offset:64512
  s_waitcnt lgkmcnt(2)
  v_mfma_f32_32x32x16_bf16 v[48:63], v[68:71], v[80:83], v[48:63]
  ds_read_b64_tr_b16 v[86:87], v21 offset:768
  ds_read_b128 v[76:79], v18 offset:55296
  s_waitcnt lgkmcnt(1)
  v_mfma_f32_32x32x16_bf16 v[32:47], v[72:75], v[84:87], v[32:47]
  ds_read_b128 v[64:67], v17 offset:6144
  ds_read_b64_tr_b16 v[80:81], v21 offset:10240
  s_waitcnt lgkmcnt(2)
  v_mfma_f32_32x32x16_bf16 v[48:63], v[76:79], v[84:87], v[48:63]
  ds_read_b64_tr_b16 v[82:83], v21 offset:12032
  ds_read_b128 v[68:71], v17 offset:8192
  s_waitcnt lgkmcnt(1)
  v_mfma_f32_32x32x16_bf16 v[32:47], v[64:67], v[80:83], v[32:47]
  ds_read_b128 v[72:75], v19 offset:6144
  ds_read_b64_tr_b16 v[84:85], v21 offset:17408
  s_waitcnt lgkmcnt(2)
  v_mfma_f32_32x32x16_bf16 v[48:63], v[68:71], v[80:83], v[48:63]
  ds_read_b64_tr_b16 v[86:87], v21 offset:19200
  ds_read_b128 v[76:79], v19 offset:8192
  s_cbranch_vccz B1_G11
  s_waitcnt vmcnt(9)
B1_G11:
  s_waitcnt lgkmcnt(0)
  s_barrier
  v_mfma_f32_32x32x16_bf16 v[32:47], v[72:75], v[84:87], v[32:47]
  ds_read_b128 v[64:67], v17 offset:24576
  ds_read_b64_tr_b16 v[80:81], v21 offset:28672
  s_cbranch_vccz B1_G12
  s_add_u32 m0, s44, 0xd000
  s_nop 0
  buffer_load_dwordx4 v114, s[16:19], s41 offen lds
  buffer_load_dwordx4 v115, s[16:19], s41 offen offset:1024 lds
  buffer_load_dwordx4 v116, s[16:19], s41 offen offset:2048 lds
  buffer_load_dwordx4 v117, s[16:19], s41 offen offset:3072 lds
  s_add_u32 m0, s44, 0xe000
  s_nop 0
  buffer_load_dwordx4 v118, s[16:19], s41 offen lds
  s_add_u32 m0, s45, 0xd000
  s_nop 0
  buffer_load_dwordx4 v119, s[24:27], s42 offen lds
  buffer_load_dwordx4 v120, s[24:27], s42 offen offset:1024 lds
  buffer_load_dwordx4 v121, s[24:27], s42 offen offset:2048 lds
  buffer_load_dwordx4 v122, s[24:27], s42 offen offset:3072 lds
  s_add_u32 s41, s41, 0x36000
  s_add_u32 s42, s42, s43
  s_cmp_ge_u32 s41, 0x1e6000
  s_cselect_b32 s6, 0x1e6000, 0
  s_cselect_b32 s7, s47, 0
  s_sub_u32 s41, s41, s6
  s_sub_u32 s42, s42, s7
B1_G12:
  v_mfma_f32_32x32x16_bf16 v[48:63], v[76:79], v[84:87], v[48:63]
  ds_read_b64_tr_b16 v[82:83], v21 offset:30464
  ds_read_b128 v[68:71], v17 offset:26624
  s_waitcnt lgkmcnt(1)
  v_mfma_f32_32x32x16_bf16 v[32:47], v[64:67], v[80:83], v[32:47]
  ds_read_b128 v[72:75], v19 offset:24576
  ds_read_b64_tr_b16 v[84:85], v21 offset:35840
  s_waitcnt lgkmcnt(2)
  v_mfma_f32_32x32x16_bf16 v[48:63], v[68:71], v[80:83], v[48:63]
  ds_read_b64_tr_b16 v[86:87], v21 offset:37632
  ds_read_b128 v[76:79], v19 offset:26624
  s_waitcnt lgkmcnt(1)
  v_mfma_f32_32x32x16_bf16 v[32:47], v[72:75], v[84:87], v[32:47]
  ds_read_b128 v[64:67], v17 offset:43008
  ds_read_b64_tr_b16 v[80:81], v21 offset:47104
  s_waitcnt lgkmcnt(2)
  v_mfma_f32_32x32x16_bf16 v[48:63], v[76:79], v[84:87], v[48:63]
  ds_read_b64_tr_b16 v[82:83], v21 offset:48896
  ds_read_b128 v[68:71], v17 offset:45056
  s_waitcnt lgkmcnt(1)
  v_mfma_f32_32x32x16_bf16 v[32:47], v[64:67], v[80:83], v[32:47]
  ds_read_b128 v[72:75], v19 offset:43008
  ds_read_b64_tr_b16 v[84:85], v21 offset:54272
  s_waitcnt lgkmcnt(2)
  v_mfma_f32_32x32x16_bf16 v[48:63], v[68:71], v[80:83], v[48:63]
  ds_read_b64_tr_b16 v[86:87], v21 offset:56064
  ds_read_b128 v[76:79], v19 offset:45056
  s_cbranch_vccz B1_G13
  s_waitcnt vmcnt(9)
B1_G13:
  s_waitcnt lgkmcnt(0)
  s_barrier
  v_mfma_f32_32x32x16_bf16 v[32:47], v[72:75], v[84:87], v[32:47]
  ds_read_b128 v[64:67], v16 offset:16384
  ds_read_b64_tr_b16 v[80:81], v20 offset:20480
  s_cbranch_vccz B1_G14
  s_add_u32 m0, s44, 0x16000
  s_nop 0
  buffer_load_dwordx4 v114, s[16:19], s41 offen lds
  buffer_load_dwordx4 v115, s[16:19], s41 offen offset:1024 lds
  buffer_load_dwordx4 v116, s[16:19], s41 offen offset:2048 lds
  buffer_load_dwordx4 v117, s[16:19], s41 offen offset:3072 lds
  s_add_u32 m0, s44, 0x17000
  s_nop 0
  buffer_load_dwordx4 v118, s[16:19], s41 offen lds
  s_add_u32 m0, s45, 0x16000
  s_nop 0
  buffer_load_dwordx4 v119, s[24:27], s42 offen lds
  buffer_load_dwordx4 v120, s[24:27], s42 offen offset:1024 lds
  buffer_load_dwordx4 v121, s[24:27], s42 offen offset:2048 lds
  buffer_load_dwordx4 v122, s[24:27], s42 offen offset:3072 lds
  s_add_u32 s41, s41, 0x36000
  s_add_u32 s42, s42, s43
  s_cmp_ge_u32 s41, 0x1e6000
  s_cselect_b32 s6, 0x1e6000, 0
  s_cselect_b32 s7, s47, 0
  s_sub_u32 s41, s41, s6
  s_sub_u32 s42, s42, s7
B1_G14:
  s_cmp_lg_u32 s3, 4
  s_cbranch_scc1 ONLYW7
  s_mov_b32 s56, s66
  s_mov_b32 s57, s67
  s_mov_b32 s58, 0x200000
  s_mov_b32 s59, 0x20000
  s_mul_i32 s63, s2, 0x2000
  s_add_u32 s63, s63, 0
  v_min_u32 v5, 63, v1
  v_lshlrev_b32 v5, 7, v5
  buffer_load_dword v31, v5, s[56:59], s63 offen
ONLYW7:
  v_mfma_f32_32x32x16_bf16 v[48:63], v[76:79], v[84:87], v[48:63]
  ds_read_b64_tr_b16 v[82:83], v20 offset:22272
  ds_read_b128 v[68:71], v16 offset:18432
  s_cmp_lg_u32 s3, 5
  s_cbranch_scc1 ONLYW8
  s_mov_b32 s56, s70
  s_mov_b32 s57, s71
  s_mov_b32 s58, 0x400000
  s_mov_b32 s59, 0x20000
  s_mul_i32 s63, s2, 0x4000
  s_add_u32 s63, s63, 0
  v_min_u32 v5, 63, v1
  v_lshlrev_b32 v5, 7, v5
  buffer_load_dword v31, v5, s[56:59], s63 offen
ONLYW8:
  s_waitcnt lgkmcnt(1)
  v_mfma_f32_32x32x16_bf16 v[32:47], v[64:67], v[80:83], v[32:47]
  ds_read_b128 v[72:75], v18 offset:16384
  ds_read_b64_tr_b16 v[84:85], v20 offset:27648
  s_waitcnt lgkmcnt(2)
  v_mfma_f32_32x32x16_bf16 v[48:63], v[68:71], v[80:83], v[48:63]
  ds_read_b64_tr_b16 v[86:87], v20 offset:29440
  ds_read_b128 v[76:79], v18 offset:18432
  s_cmp_lg_u32 s3, 6
  s_cbranch_scc1 ONLYW9
  s_mov_b32 s56, s70
  s_mov_b32 s57, s71
  s_mov_b32 s58, 0x400000
  s_mov_b32 s59, 0x20000
  s_mul_i32 s63, s2, 0x4000
  s_add_u32 s63, s63, 0x2000
  v_min_u32 v5, 63, v1
  v_lshlrev_b32 v5, 7, v5
  buffer_load_dword v31, v5, s[56:59], s63 offen
ONLYW9:
  s_waitcnt lgkmcnt(1)
  v_mfma_f32_32x32x16_bf16 v[32:47], v[72:75], v[84:87], v[32:47]
  ds_read_b128 v[64:67], v16 offset:34816
  ds_read_b64_tr_b16 v[80:81], v20 offset:38912
  s_cmp_lg_u32 s3, 7
  s_cbranch_scc1 ONLYW10
  s_mov_b32 s56, s72
  s_mov_b32 s57, s73
  s_mov_b32 s58, 0x400000
  s_mov_b32 s59, 0x20000
  s_mul_i32 s63, s2, 0x4000
  s_add_u32 s63, s63, 0
  v_min_u32 v5, 63, v1
  v_lshlrev_b32 v5, 7, v5
  buffer_load_dword v31, v5, s[56:59], s63 offen
ONLYW10:
  s_waitcnt lgkmcnt(2)
  v_mfma_f32_32x32x16_bf16 v[48:63], v[76:79], v[84:87], v[48:63]
  ds_read_b64_tr_b16 v[82:83], v20 offset:40704
  ds_read_b128 v[68:71], v16 offset:36864
  s_waitcnt lgkmcnt(1)
  v_mfma_f32_32x32x16_bf16 v[32:47], v[64:67], v[80:83], v[32:47]
  ds_read_b128 v[72:75], v18 offset:34816
  ds_read_b64_tr_b16 v[84:85], v20 offset:46080
  s_cmp_lg_u32 s3, 4
  s_cbranch_scc1 ONLYW11
  s_mov_b32 s56, s72
  s_mov_b32 s57, s73
  s_mov_b32 s58, 0x400000
  s_mov_b32 s59, 0x20000
  s_mul_i32 s63, s2, 0x4000
  s_add_u32 s63, s63, 0x2000
  v_min_u32 v5, 63, v1
  v_lshlrev_b32 v5, 7, v5
  buffer_load_dword v31, v5, s[56:59], s63 offen
ONLYW11:
  s_waitcnt lgkmcnt(2)
  v_mfma_f32_32x32x16_bf16 v[48:63], v[68:71], v[80:83], v[48:63]
  ds_read_b64_tr_b16 v[86:87], v20 offset:47872
  ds_read_b128 v[76:79], v18 offset:36864
  s_cbranch_vccz B1_G15
  s_waitcnt vmcnt(9)
B1_G15:
  s_waitcnt lgkmcnt(0)
  s_barrier
  v_mfma_f32_32x32x16_bf16 v[32:47], v[72:75], v[84:87], v[32:47]
  ds_read_b128 v[64:67], v16 offset:53248
  ds_read_b64_tr_b16 v[80:81], v20 offset:57344
  s_mov_b32 s12, s66
  s_mov_b32 s13, s67
  s_mov_b32 s14, 0x200000
  s_mov_b32 s15, 0x20000
  v_mfma_f32_32x32x16_bf16 v[48:63], v[76:79], v[84:87], v[48:63]
  ds_read_b64_tr_b16 v[82:83], v20 offset:59136
  ds_read_b128 v[68:71], v16 offset:55296
  s_mov_b32 s16, s70
  s_mov_b32 s17, s71
  s_mov_b32 s18, 0x400000
  s_waitcnt lgkmcnt(1)
  v_mfma_f32_32x32x16_bf16 v[32:47], v[64:67], v[80:83], v[32:47]
  ds_read_b128 v[72:75], v18 offset:53248
  ds_read_b64_tr_b16 v[84:85], v20 offset:64512
  s_mov_b32 s19, 0x20000
  s_mov_b32 s20, s72
  s_mov_b32 s21, s73
  s_mov_b32 s22, 0x400000
  s_waitcnt lgkmcnt(2)
  v_mfma_f32_32x32x16_bf16 v[48:63], v[68:71], v[80:83], v[48:63]
  ds_read_b64_tr_b16 v[86:87], v21 offset:768
  ds_read_b128 v[76:79], v18 offset:55296
  s_mov_b32 s23, 0x20000
  s_cmp_eq_u32 s97, 0
  s_cbranch_scc1 ONLY12
  s_add_u32 m0, s50, 0
  s_lshl_b32 s52, s61, 6
  buffer_load_dwordx4 v10, s[12:15], s52 offen lds
  buffer_load_dwordx4 v11, s[12:15], s52 offen offset:1024 lds
  buffer_load_dwordx4 v12, s[12:15], s52 offen offset:2048 lds
  buffer_load_dwordx4 v13, s[12:15], s52 offen offset:3072 lds
  s_add_u32 m0, s51, 0
  s_lshl_b32 s53, s61, 18
  buffer_load_dwordx4 v14, s[16:19], s53 offen lds
  buffer_load_dwordx4 v15, s[16:19], s53 offen offset:1024 lds
  s_add_u32 m0, s51, 0x2000
  s_nop 0
  buffer_load_dwordx4 v14, s[20:23], s53 offen lds
  buffer_load_dwordx4 v15, s[20:23], s53 offen offset:1024 lds
  s_add_u32 s61, s61, 1
  s_and_b32 s61, s61, 15
ONLY12:
  s_waitcnt lgkmcnt(1)
  v_mfma_f32_32x32x16_bf16 v[32:47], v[72:75], v[84:87], v[32:47]
  ds_read_b128 v[64:67], v17 offset:6144
  ds_read_b64_tr_b16 v[80:81], v21 offset:10240
  s_waitcnt lgkmcnt(2)
  v_mfma_f32_32x32x16_bf16 v[48:63], v[76:79], v[84:87], v[48:63]
  ds_read_b64_tr_b16 v[82:83], v21 offset:12032
  ds_read_b128 v[68:71], v17 offset:8192
  s_waitcnt lgkmcnt(1)
  v_mfma_f32_32x32x16_bf16 v[32:47], v[64:67], v[80:83], v[32:47]
  ds_read_b128 v[72:75], v19 offset:6144
  ds_read_b64_tr_b16 v[84:85], v21 offset:17408
  s_waitcnt lgkmcnt(2)
  v_mfma_f32_32x32x16_bf16 v[48:63], v[68:71], v[80:83], v[48:63]
  ds_read_b64_tr_b16 v[86:87], v21 offset:19200
  ds_read_b128 v[76:79], v19 offset:8192
  s_cbranch_vccz B1_G16
  s_waitcnt vmcnt(8)
B1_G16:
  s_waitcnt lgkmcnt(0)
  s_barrier
  v_mfma_f32_32x32x16_bf16 v[32:47], v[72:75], v[84:87], v[32:47]
  ds_read_b128 v[64:67], v17 offset:24576
  ds_read_b64_tr_b16 v[80:81], v21 offset:28672
  s_cmp_eq_u32 s97, 0
  s_cbranch_scc1 ONLY13
  s_add_u32 m0, s50, 0x8000
  s_lshl_b32 s52, s61, 6
  buffer_load_dwordx4 v10, s[12:15], s52 offen lds
  buffer_load_dwordx4 v11, s[12:15], s52 offen offset:1024 lds
  buffer_load_dwordx4 v12, s[12:15], s52 offen offset:2048 lds
  buffer_load_dwordx4 v13, s[12:15], s52 offen offset:3072 lds
  s_add_u32 m0, s51, 0x8000
  s_lshl_b32 s53, s61, 18
  buffer_load_dwordx4 v14, s[16:19], s53 offen lds
  buffer_load_dwordx4 v15, s[16:19], s53 offen offset:1024 lds
  s_add_u32 m0, s51, 0xa000
  s_nop 0
  buffer_load_dwordx4 v14, s[20:23], s53 offen lds
  buffer_load_dwordx4 v15, s[20:23], s53 offen offset:1024 lds
  s_add_u32 s61, s61, 1
  s_and_b32 s61, s61, 15
ONLY13:
  v_mfma_f32_32x32x16_bf16 v[48:63], v[76:79], v[84:87], v[48:63]
  ds_read_b64_tr_b16 v[82:83], v21 offset:30464
  ds_read_b128 v[68:71], v17 offset:26624
  s_waitcnt lgkmcnt(1)
  v_mfma_f32_32x32x16_bf16 v[32:47], v[64:67], v[80:83], v[32:47]
  ds_read_b128 v[72:75], v19 offset:24576
  ds_read_b64_tr_b16 v[84:85], v21 offset:35840
  s_waitcnt lgkmcnt(2)
  v_mfma_f32_32x32x16_bf16 v[48:63], v[68:71], v[80:83], v[48:63]
  ds_read_b64_tr_b16 v[86:87], v21 offset:37632
  ds_read_b128 v[76:79], v19 offset:26624
  s_waitcnt lgkmcnt(1)
  v_mfma_f32_32x32x16_bf16 v[32:47], v[72:75], v[84:87], v[32:47]
  ds_read_b128 v[64:67], v17 offset:43008
  ds_read_b64_tr_b16 v[80:81], v21 offset:47104
  s_waitcnt lgkmcnt(2)
  v_mfma_f32_32x32x16_bf16 v[48:63], v[76:79], v[84:87], v[48:63]
  ds_read_b64_tr_b16 v[82:83], v21 offset:48896
  ds_read_b128 v[68:71], v17 offset:45056
  s_waitcnt lgkmcnt(1)
  v_mfma_f32_32x32x16_bf16 v[32:47], v[64:67], v[80:83], v[32:47]
  ds_read_b128 v[72:75], v19 offset:43008
  ds_read_b64_tr_b16 v[84:85], v21 offset:54272
  s_waitcnt lgkmcnt(2)
  v_mfma_f32_32x32x16_bf16 v[48:63], v[68:71], v[80:83], v[48:63]
  ds_read_b64_tr_b16 v[86:87], v21 offset:56064
  ds_read_b128 v[76:79], v19 offset:45056
  s_waitcnt lgkmcnt(1)
  v_mfma_f32_32x32x16_bf16 v[32:47], v[72:75], v[84:87], v[32:47]
  s_waitcnt lgkmcnt(0)
  v_mfma_f32_32x32x16_bf16 v[48:63], v[76:79], v[84:87], v[48:63]
  v_and_b32 v5, 31, v1
  s_lshl_b32 s6, s3, 5
  v_add_u32 v5, s6, v5
  v_mul_u32_u24 v5, 0x90, v5
  v_lshrrev_b32 v6, 5, v1
  v_lshl_add_u32 v5, v6, 3, v5
  v_add_u32 v22, 0x1f000, v5
  s_nop 2
  v_cvt_pk_bf16_f32 v64, v32, v33
  v_cvt_pk_bf16_f32 v65, v34, v35
  v_cvt_pk_bf16_f32 v66, v36, v37
  v_cvt_pk_bf16_f32 v67, v38, v39
  v_cvt_pk_bf16_f32 v68, v40, v41
  v_cvt_pk_bf16_f32 v69, v42, v43
  v_cvt_pk_bf16_f32 v70, v44, v45
  v_cvt_pk_bf16_f32 v71, v46, v47
  v_cvt_pk_bf16_f32 v72, v48, v49
  v_cvt_pk_bf16_f32 v73, v50, v51
  v_cvt_pk_bf16_f32 v74, v52, v53
  v_cvt_pk_bf16_f32 v75, v54, v55
  v_cvt_pk_bf16_f32 v76, v56, v57
  v_cvt_pk_bf16_f32 v77, v58, v59
  v_cvt_pk_bf16_f32 v78, v60, v61
  v_cvt_pk_bf16_f32 v79, v62, v63
  s_cmp_lg_u32 s3, 7
  s_cbranch_scc1 B1_NZ
  v_mov_b32 v64, 0
  v_mov_b32 v65, 0
  v_mov_b32 v66, 0
  v_mov_b32 v67, 0
  v_mov_b32 v68, 0
  v_mov_b32 v69, 0
  v_mov_b32 v70, 0
  v_mov_b32 v71, 0
  v_mov_b32 v72, 0
  v_mov_b32 v73, 0
  v_mov_b32 v74, 0
  v_mov_b32 v75, 0
  v_mov_b32 v76, 0
  v_mov_b32 v77, 0
  v_mov_b32 v78, 0
  v_mov_b32 v79, 0
B1_NZ:
  ds_write_b64 v22, v[64:65] offset:0
  ds_write_b64 v22, v[66:67] offset:16
  ds_write_b64 v22, v[68:69] offset:32
  ds_write_b64 v22, v[70:71] offset:48
  ds_write_b64 v22, v[72:73] offset:64
  ds_write_b64 v22, v[74:75] offset:80
  ds_write_b64 v22, v[76:77] offset:96
  ds_write_b64 v22, v[78:79] offset:112
  v_lshrrev_b32 v5, 5, v1
  v_bfe_u32 v6, v1, 2, 2
  v_lshl_add_u32 v5, v5, 3, v6
  v_mul_u32_u24 v5, 0x90, v5
  v_bfe_u32 v7, v1, 4, 1
  v_lshl_add_u32 v5, v7, 5, v5
  v_and_b32 v7, 3, v1
  v_lshl_add_u32 v8, v7, 3, v5
  s_mul_i32 s6, s3, 0xa20
  s_add_u32 s6, s6, 0x1f000
  v_add_u32 v23, s6, v8
  s_waitcnt lgkmcnt(0)
  s_barrier
  s_cmp_eq_u32 s97, 0
  s_cbranch_scc1 ONLY14
  s_add_u32 m0, s50, 0x10000
  s_lshl_b32 s52, s61, 6
  buffer_load_dwordx4 v10, s[12:15], s52 offen lds
  buffer_load_dwordx4 v11, s[12:15], s52 offen offset:1024 lds
  buffer_load_dwordx4 v12, s[12:15], s52 offen offset:2048 lds
  buffer_load_dwordx4 v13, s[12:15], s52 offen offset:3072 lds
  s_add_u32 m0, s51, 0x10000
  s_lshl_b32 s53, s61, 18
  buffer_load_dwordx4 v14, s[16:19], s53 offen lds
  buffer_load_dwordx4 v15, s[16:19], s53 offen offset:1024 lds
  s_add_u32 m0, s51, 0x12000
  s_nop 0
  buffer_load_dwordx4 v14, s[20:23], s53 offen lds
  buffer_load_dwordx4 v15, s[20:23], s53 offen offset:1024 lds
  s_add_u32 s61, s61, 1
  s_and_b32 s61, s61, 15
ONLY14:
  ds_read_b64_tr_b16 v[64:65], v23
  ds_read_b64_tr_b16 v[66:67], v23 offset:576
  ds_read_b64_tr_b16 v[68:69], v23 offset:2304
  ds_read_b64_tr_b16 v[70:71], v23 offset:2880
  ds_read_b64_tr_b16 v[72:73], v23 offset:64
  ds_read_b64_tr_b16 v[74:75], v23 offset:640
  ds_read_b64_tr_b16 v[76:77], v23 offset:2368
  ds_read_b64_tr_b16 v[78:79], v23 offset:2944
  s_waitcnt lgkmcnt(6)
  v_mfma_f32_32x32x16_bf16 v[32:47], v[96:99], v[64:67], 0
  s_waitcnt lgkmcnt(4)
  v_mfma_f32_32x32x16_bf16 v[32:47], v[100:103], v[68:71], v[32:47]
  s_waitcnt lgkmcnt(2)
  v_mfma_f32_32x32x16_bf16 v[48:63], v[96:99], v[72:75], 0
  s_waitcnt lgkmcnt(0)
  v_mfma_f32_32x32x16_bf16 v[48:63], v[100:103], v[76:79], v[48:63]
  s_mov_b32 s90, 0x3fb8aa3b
  s_nop 6
  v_max3_f32 v5, v32, v33, v34
  v_min3_f32 v6, v32, v33, v34
  v_max3_f32 v5, v5, v35, v36
  v_min3_f32 v6, v6, v35, v36
  v_max3_f32 v5, v5, v37, v38
  v_min3_f32 v6, v6, v37, v38
  v_max3_f32 v5, v5, v39, v40
  v_min3_f32 v6, v6, v39, v40
  v_mov_b32 v7, v5
  v_mov_b32 v8, v6
  s_nop 0
  v_permlane32_swap_b32 v5, v7
  v_permlane32_swap_b32 v6, v8
  v_max_f32 v5, v5, v7
  v_min_f32 v6, v6, v8
  v_mul_f32 v5, s90, v5
  v_mul_f32 v6, s90, v6
  v_fma_f32 v96, v32, s90, -v5
  v_fma_f32 v105, -v32, s90, v6
  v_fma_f32 v97, v33, s90, -v5
  v_fma_f32 v106, -v33, s90, v6
  v_fma_f32 v98, v34, s90, -v5
  v_fma_f32 v107, -v34, s90, v6
  v_fma_f32 v99, v35, s90, -v5
  v_fma_f32 v108, -v35, s90, v6
  v_fma_f32 v100, v36, s90, -v5
  v_fma_f32 v109, -v36, s90, v6
  v_fma_f32 v101, v37, s90, -v5
  v_fma_f32 v110, -v37, s90, v6
  v_fma_f32 v102, v38, s90, -v5
  v_fma_f32 v111, -v38, s90, v6
  v_fma_f32 v103, v39, s90, -v5
  v_fma_f32 v112, -v39, s90, v6
  v_fma_f32 v104, v40, s90, -v5
  v_fma_f32 v113, -v40, s90, v6
  v_exp_f32 v96, v96
  v_exp_f32 v97, v97
  v_exp_f32 v98, v98
  v_exp_f32 v99, v99
  v_exp_f32 v100, v100
  v_exp_f32 v101, v101
  v_exp_f32 v102, v102
  v_exp_f32 v103, v103
  v_exp_f32 v104, v104
  v_exp_f32 v105, v105
  v_exp_f32 v106, v106
  v_exp_f32 v107, v107
  v_exp_f32 v108, v108
  v_exp_f32 v109, v109
  v_exp_f32 v110, v110
  v_exp_f32 v111, v111
  v_exp_f32 v112, v112
  v_exp_f32 v113, v113
  v_add_f32 v5, v96, v97
  v_add_f32 v6, v105, v106
  v_add_f32 v5, v5, v98
  v_add_f32 v6, v6, v107
  v_add_f32 v5, v5, v99
  v_add_f32 v6, v6, v108
  v_add_f32 v5, v5, v100
  v_add_f32 v6, v6, v109
  v_add_f32 v5, v5, v101
  v_add_f32 v6, v6, v110
  v_add_f32 v5, v5, v102
  v_add_f32 v6, v6, v111
  v_add_f32 v5, v5, v103
  v_add_f32 v6, v6, v112
  v_add_f32 v5, v5, v104
  v_add_f32 v6, v6, v113
  v_mov_b32 v7, v5
  v_mov_b32 v8, v6
  s_nop 0
  v_permlane32_swap_b32 v5, v7
  v_permlane32_swap_b32 v6, v8
  v_add_f32 v5, v5, v7
  v_add_f32 v6, v6, v8
  v_rcp_f32 v5, v5
  v_rcp_f32 v6, v6
  v_mul_f32 v96, v96, v5
  v_mul_f32 v105, v105, v6
  v_mul_f32 v97, v97, v5
  v_mul_f32 v106, v106, v6
  v_mul_f32 v98, v98, v5
  v_mul_f32 v107, v107, v6
  v_mul_f32 v99, v99, v5
  v_mul_f32 v108, v108, v6
  v_mul_f32 v100, v100, v5
  v_mul_f32 v109, v109, v6
  v_mul_f32 v101, v101, v5
  v_mul_f32 v110, v110, v6
  v_mul_f32 v102, v102, v5
  v_mul_f32 v111, v111, v6
  v_mul_f32 v103, v103, v5
  v_mul_f32 v112, v112, v6
  v_mul_f32 v104, v104, v5
  v_mul_f32 v113, v113, v6
  v_cvt_pk_bf16_f32 v64, v96, v97
  v_cvt_pk_bf16_f32 v65, v98, v99
  v_cvt_pk_bf16_f32 v66, v100, v101
  v_cvt_pk_bf16_f32 v67, v102, v103
  v_cvt_pk_bf16_f32 v68, v104, v105
  v_cvt_pk_bf16_f32 v69, v106, v107
  v_cvt_pk_bf16_f32 v70, v108, v109
  v_cvt_pk_bf16_f32 v71, v110, v111
  v_cvt_pk_bf16_f32 v72, v112, v113
  v_mov_b32 v73, 0
  v_mov_b32 v74, 0
  v_mov_b32 v75, 0
  v_max3_f32 v5, v48, v49, v50
  v_min3_f32 v6, v48, v49, v50
  v_max3_f32 v5, v5, v51, v52
  v_min3_f32 v6, v6, v51, v52
  v_max3_f32 v5, v5, v53, v54
  v_min3_f32 v6, v6, v53, v54
  v_max3_f32 v5, v5, v55, v56
  v_min3_f32 v6, v6, v55, v56
  v_mov_b32 v7, v5
  v_mov_b32 v8, v6
  s_nop 0
  v_permlane32_swap_b32 v5, v7
  v_permlane32_swap_b32 v6, v8
  v_max_f32 v5, v5, v7
  v_min_f32 v6, v6, v8
  v_mul_f32 v5, s90, v5
  v_mul_f32 v6, s90, v6
  v_fma_f32 v96, v48, s90, -v5
  v_fma_f32 v105, -v48, s90, v6
  v_fma_f32 v97, v49, s90, -v5
  v_fma_f32 v106, -v49, s90, v6
  v_fma_f32 v98, v50, s90, -v5
  v_fma_f32 v107, -v50, s90, v6
  v_fma_f32 v99, v51, s90, -v5
  v_fma_f32 v108, -v51, s90, v6
  v_fma_f32 v100, v52, s90, -v5
  v_fma_f32 v109, -v52, s90, v6
  v_fma_f32 v101, v53, s90, -v5
  v_fma_f32 v110, -v53, s90, v6
  v_fma_f32 v102, v54, s90, -v5
  v_fma_f32 v111, -v54, s90, v6
  v_fma_f32 v103, v55, s90, -v5
  v_fma_f32 v112, -v55, s90, v6
  v_fma_f32 v104, v56, s90, -v5
  v_fma_f32 v113, -v56, s90, v6
  v_exp_f32 v96, v96
  v_exp_f32 v97, v97
  v_exp_f32 v98, v98
  v_exp_f32 v99, v99
  v_exp_f32 v100, v100
  v_exp_f32 v101, v101
  v_exp_f32 v102, v102
  v_exp_f32 v103, v103
  v_exp_f32 v104, v104
  v_exp_f32 v105, v105
  v_exp_f32 v106, v106
  v_exp_f32 v107, v107
  v_exp_f32 v108, v108
  v_exp_f32 v109, v109
  v_exp_f32 v110, v110
  v_exp_f32 v111, v111
  v_exp_f32 v112, v112
  v_exp_f32 v113, v113
  v_add_f32 v5, v96, v97
  v_add_f32 v6, v105, v106
  v_add_f32 v5, v5, v98
  v_add_f32 v6, v6, v107
  v_add_f32 v5, v5, v99
  v_add_f32 v6, v6, v108
  v_add_f32 v5, v5, v100
  v_add_f32 v6, v6, v109
  v_add_f32 v5, v5, v101
  v_add_f32 v6, v6, v110
  v_add_f32 v5, v5, v102
  v_add_f32 v6, v6, v111
  v_add_f32 v5, v5, v103
  v_add_f32 v6, v6, v112
  v_add_f32 v5, v5, v104
  v_add_f32 v6, v6, v113
  v_mov_b32 v7, v5
  v_mov_b32 v8, v6
  s_nop 0
  v_permlane32_swap_b32 v5, v7
  v_permlane32_swap_b32 v6, v8
  v_add_f32 v5, v5, v7
  v_add_f32 v6, v6, v8
  v_rcp_f32 v5, v5
  v_rcp_f32 v6, v6
  v_mul_f32 v96, v96, v5
  v_mul_f32 v105, v105, v6
  v_mul_f32 v97, v97, v5
  v_mul_f32 v106, v106, v6
  v_mul_f32 v98, v98, v5
  v_mul_f32 v107, v107, v6
  v_mul_f32 v99, v99, v5
  v_mul_f32 v108, v108, v6
  v_mul_f32 v100, v100, v5
  v_mul_f32 v109, v109, v6
  v_mul_f32 v101, v101, v5
  v_mul_f32 v110, v110, v6
  v_mul_f32 v102, v102, v5
  v_mul_f32 v111, v111, v6
  v_mul_f32 v103, v103, v5
  v_mul_f32 v112, v112, v6
  v_mul_f32 v104, v104, v5
  v_mul_f32 v113, v113, v6
  v_cvt_pk_bf16_f32 v76, v96, v97
  v_cvt_pk_bf16_f32 v77, v98, v99
  v_cvt_pk_bf16_f32 v78, v100, v101
  v_cvt_pk_bf16_f32 v79, v102, v103
  v_cvt_pk_bf16_f32 v80, v104, v105
  v_cvt_pk_bf16_f32 v81, v106, v107
  v_cvt_pk_bf16_f32 v82, v108, v109
  v_cvt_pk_bf16_f32 v83, v110, v111
  v_cvt_pk_bf16_f32 v84, v112, v113
  v_mov_b32 v85, 0
  v_mov_b32 v86, 0
  v_mov_b32 v87, 0
  s_cmp_ge_u32 s3, 4
  s_cbranch_scc1 B1_K
  s_lshl_b32 s6, s32, 6
  s_add_u32 s6, s6, s40
  s_mul_i32 s6, s6, 0xc00
  s_add_u32 s6, s6, 0x6000000
  s_add_u32 s7, s6, 0x18000
  buffer_store_dwordx4 v[64:67], v2, s[8:11], s6 offen sc1
  buffer_store_dwordx4 v[68:71], v2, s[8:11], s6 offen offset:1024 sc1
  buffer_store_dwordx4 v[72:75], v2, s[8:11], s6 offen offset:2048 sc1
  buffer_store_dwordx4 v[76:79], v2, s[8:11], s7 offen sc1
  buffer_store_dwordx4 v[80:83], v2, s[8:11], s7 offen offset:1024 sc1
  buffer_store_dwordx4 v[84:87], v2, s[8:11], s7 offen offset:2048 sc1
  s_branch B1_DONE
B1_K:
  s_sub_u32 s6, s3, 4
  s_mul_i32 s6, s6, 0x1c00
  s_add_u32 s6, s6, 0x18000
  v_and_b32 v5, 31, v1
  v_mul_u32_u24 v5, 0x70, v5
  v_lshrrev_b32 v6, 5, v1
  v_mul_u32_u24 v7, 48, v6
  v_add3_u32 v24, v5, v7, s6
  ds_write_b128 v24, v[64:67] offset:0
  ds_write_b128 v24, v[68:71] offset:16
  ds_write_b128 v24, v[72:75] offset:32
  ds_write_b128 v24, v[76:79] offset:3584
  ds_write_b128 v24, v[80:83] offset:3600
  ds_write_b128 v24, v[84:87] offset:3616
  v_bfe_u32 v7, v1, 2, 2
  v_lshl_add_u32 v5, v6, 3, v7
  v_mul_u32_u24 v5, 0x70, v5
  v_and_b32 v7, 1, v1
  v_mul_u32_u24 v7, 48, v7
  v_add_u32 v5, v5, v7
  v_bfe_u32 v7, v1, 1, 1
  v_lshl_add_u32 v5, v7, 3, v5
  v_add_u32 v5, s6, v5
  v_bfe_u32 v7, v1, 4, 1
  v_lshl_add_u32 v27, v7, 4, v5
  v_add_u32 v114, 32, v5
  v_min_u32 v5, 8, v25
  v_mad_u32_u24 v5, v26, 9, v5
  s_mul_i32 s6, s3, 18
  s_add_u32 s6, s6, 0x48
  v_add_u32 v5, s6, v5
  v_mul_u32_u24 v5, 0x90, v5
  v_lshl_add_u32 v5, v6, 4, v5
  v_add_u32 v28, 0x1f000, v5
  ds_read_b128 v[96:99], v28
  ds_read_b128 v[100:103], v28 offset:32
  ds_read_b128 v[104:107], v28 offset:64
  ds_read_b128 v[108:111], v28 offset:96
  ds_read_b64_tr_b16 a[64:65], v27
  ds_read_b64_tr_b16 a[66:67], v27 offset:448
  ds_read_b64_tr_b16 a[68:69], v27 offset:1792
  ds_read_b64_tr_b16 a[70:71], v27 offset:2240
  ds_read_b64_tr_b16 a[72:73], v27 offset:3584
  ds_read_b64_tr_b16 a[74:75], v27 offset:4032
  ds_read_b64_tr_b16 a[76:77], v27 offset:5376
  ds_read_b64_tr_b16 a[78:79], v27 offset:5824
  ds_read_b64_tr_b16 a[80:81], v114
  ds_read_b64_tr_b16 a[82:83], v114 offset:448
  ds_read_b64_tr_b16 a[84:85], v114 offset:1792
  ds_read_b64_tr_b16 a[86:87], v114 offset:2240
  ds_read_b64_tr_b16 a[88:89], v114 offset:3584
  ds_read_b64_tr_b16 a[90:91], v114 offset:4032
  ds_read_b64_tr_b16 a[92:93], v114 offset:5376
  ds_read_b64_tr_b16 a[94:95], v114 offset:5824
  v_cmp_eq_u32 s[4:5], v25, 9
  v_mov_b32 v9, 0x3f803f80
  s_waitcnt lgkmcnt(15)
  v_cndmask_b32 v96, v96, v9, s[4:5]
  v_cndmask_b32 v97, v97, v9, s[4:5]
  v_cndmask_b32 v98, v98, v9, s[4:5]
  v_cndmask_b32 v99, v99, v9, s[4:5]
  v_cndmask_b32 v100, v100, v9, s[4:5]
  v_cndmask_b32 v101, v101, v9, s[4:5]
  v_cndmask_b32 v102, v102, v9, s[4:5]
  v_cndmask_b32 v103, v103, v9, s[4:5]
  v_cndmask_b32 v104, v104, v9, s[4:5]
  v_cndmask_b32 v105, v105, v9, s[4:5]
  v_cndmask_b32 v106, v106, v9, s[4:5]
  v_cndmask_b32 v107, v107, v9, s[4:5]
  v_cndmask_b32 v108, v108, v9, s[4:5]
  v_cndmask_b32 v109, v109, v9, s[4:5]
  v_cndmask_b32 v110, v110, v9, s[4:5]
  v_cndmask_b32 v111, v111, v9, s[4:5]
  s_waitcnt lgkmcnt(14)
  v_mfma_f32_32x32x16_bf16 v[32:47], a[64:67], v[96:99], 0
  s_waitcnt lgkmcnt(12)
  v_mfma_f32_32x32x16_bf16 v[32:47], a[68:71], v[100:103], v[32:47]
  s_waitcnt lgkmcnt(10)
  v_mfma_f32_32x32x16_bf16 v[32:47], a[72:75], v[104:107], v[32:47]
  s_waitcnt lgkmcnt(8)
  v_mfma_f32_32x32x16_bf16 v[32:47], a[76:79], v[108:111], v[32:47]
  s_waitcnt lgkmcnt(6)
  v_mfma_f32_32x32x16_bf16 v[48:63], a[80:83], v[96:99], 0
  s_waitcnt lgkmcnt(4)
  v_mfma_f32_32x32x16_bf16 v[48:63], a[84:87], v[100:103], v[48:63]
  s_waitcnt lgkmcnt(2)
  v_mfma_f32_32x32x16_bf16 v[48:63], a[88:91], v[104:107], v[48:63]
  s_waitcnt lgkmcnt(0)
  v_mfma_f32_32x32x16_bf16 v[48:63], a[92:95], v[108:111], v[48:63]
  s_lshl_b32 s6, s32, 5
  s_add_u32 s6, s6, s40
  s_mul_i32 s6, s6, 0x1800
  s_add_u32 s6, s6, 0x6800000
  s_add_u32 s7, s6, 0x1000
  buffer_store_dwordx4 v[32:35], v2, s[8:11], s6 offen sc1
  buffer_store_dwordx4 v[36:39], v2, s[8:11], s6 offen offset:1024 sc1
  buffer_store_dwordx4 v[40:43], v2, s[8:11], s6 offen offset:2048 sc1
  buffer_store_dwordx4 v[44:47], v2, s[8:11], s6 offen offset:3072 sc1
  s_nop 2
  buffer_store_dwordx4 v[48:51], v2, s[8:11], s7 offen sc1
  buffer_store_dwordx4 v[52:55], v2, s[8:11], s7 offen offset:1024 sc1
B1_DONE:
  s_lshl_b32 s90, s54, 13
  v_and_b32 v5, 31, v1
  v_lshlrev_b32 v6, 6, v5
  v_add_u32 v6, s90, v6
  v_lshrrev_b32 v7, 5, v1
  v_bfe_u32 v8, v1, 2, 2
  v_xor_b32 v7, v7, v8
  v_lshl_add_u32 v16, v7, 4, v6
  v_xor_b32 v19, 32, v16
  v_lshrrev_b32 v5, 5, v1
  v_bfe_u32 v6, v1, 2, 2
  v_lshl_add_u32 v5, v5, 3, v6
  v_mul_u32_u24 v5, 0x100, v5
  v_bfe_u32 v7, v1, 4, 1
  v_lshl_add_u32 v5, v7, 5, v5
  v_and_b32 v7, 3, v1
  v_lshl_add_u32 v8, v7, 3, v5
  v_xor_b32 v6, s55, v6
  v_lshl_add_u32 v22, v6, 6, v8
  v_add_u32 v17, 0x10000, v16
  v_add_u32 v18, 0x20000, v16
  v_add_u32 v20, 0x10000, v19
  v_add_u32 v21, 0x20000, v19
  v_add_u32 v23, 0x10000, v22
  v_add_u32 v24, 0x20000, v22
  v_mov_b32 v80, 0
  v_and_b32 v82, 0xff, v0
  v_lshlrev_b32 v82, 8, v82
  v_add_u32 v82, 0x7c00000, v82
  s_cmp_lg_u32 s97, 0
  s_cselect_b64 vcc, -1, 0
  s_cbranch_vccz KV_G17
  s_waitcnt vmcnt(16)
KV_G17:
  s_waitcnt lgkmcnt(0)
  s_barrier
  ds_read_b128 v[32:35], v16
  ds_read_b64_tr_b16 v[64:65], v22 offset:16384
  ds_read_b64_tr_b16 v[66:67], v22 offset:17408
  ds_read_b64_tr_b16 v[68:69], v22 offset:24576
  ds_read_b64_tr_b16 v[70:71], v22 offset:25600
  ds_read_b128 v[36:39], v16 offset:2048
  ds_read_b128 v[40:43], v16 offset:4096
  ds_read_b128 v[44:47], v16 offset:6144
  s_cbranch_vccz KV_G18
  s_add_u32 m0, s50, 0x18000
  s_lshl_b32 s52, s61, 6
  buffer_load_dwordx4 v10, s[12:15], s52 offen lds
  buffer_load_dwordx4 v11, s[12:15], s52 offen offset:1024 lds
  buffer_load_dwordx4 v12, s[12:15], s52 offen offset:2048 lds
  buffer_load_dwordx4 v13, s[12:15], s52 offen offset:3072 lds
  s_add_u32 m0, s51, 0x18000
  s_lshl_b32 s53, s61, 18
  buffer_load_dwordx4 v14, s[16:19], s53 offen lds
  buffer_load_dwordx4 v15, s[16:19], s53 offen offset:1024 lds
  s_add_u32 m0, s51, 0x1a000
  s_nop 0
  buffer_load_dwordx4 v14, s[20:23], s53 offen lds
  buffer_load_dwordx4 v15, s[20:23], s53 offen offset:1024 lds
  s_add_u32 s61, s61, 1
  s_and_b32 s61, s61, 15
KV_G18:
  s_cbranch_vccz KV_G19
  s_add_u32 m0, s50, 0x20000
  s_lshl_b32 s52, s61, 6
  buffer_load_dwordx4 v10, s[12:15], s52 offen lds
  buffer_load_dwordx4 v11, s[12:15], s52 offen offset:1024 lds
  buffer_load_dwordx4 v12, s[12:15], s52 offen offset:2048 lds
  buffer_load_dwordx4 v13, s[12:15], s52 offen offset:3072 lds
  s_add_u32 m0, s51, 0x20000
  s_lshl_b32 s53, s61, 18
  buffer_load_dwordx4 v14, s[16:19], s53 offen lds
  buffer_load_dwordx4 v15, s[16:19], s53 offen offset:1024 lds
  s_add_u32 m0, s51, 0x22000
  s_nop 0
  buffer_load_dwordx4 v14, s[20:23], s53 offen lds
  buffer_load_dwordx4 v15, s[20:23], s53 offen offset:1024 lds
  s_add_u32 s61, s61, 1
  s_and_b32 s61, s61, 15
KV_G19:
  s_waitcnt lgkmcnt(5)
  v_mfma_f32_32x32x16_bf16 a[0:15], v[64:67], v[32:35], 0
  ds_read_b128 v[48:51], v19
  s_waitcnt lgkmcnt(4)
  v_mfma_f32_32x32x16_bf16 a[16:31], v[32:35], v[68:71], 0
  ds_read_b64_tr_b16 v[72:73], v22 offset:20480
  ds_read_b64_tr_b16 v[74:75], v22 offset:21504
  s_waitcnt lgkmcnt(5)
  v_mfma_f32_32x32x16_bf16 a[32:47], v[64:67], v[36:39], 0
  ds_read_b64_tr_b16 v[76:77], v22 offset:28672
  v_mfma_f32_32x32x16_bf16 a[48:63], v[36:39], v[68:71], 0
  ds_read_b64_tr_b16 v[78:79], v22 offset:29696
  s_waitcnt lgkmcnt(6)
  v_mfma_f32_32x32x16_bf16 a[64:79], v[64:67], v[40:43], 0
  ds_read_b128 v[52:55], v19 offset:2048
  ds_read_b128 v[56:59], v19 offset:4096
  v_mfma_f32_32x32x16_bf16 a[80:95], v[40:43], v[68:71], 0
  ds_read_b128 v[60:63], v19 offset:6144
  s_waitcnt lgkmcnt(8)
  v_mfma_f32_32x32x16_bf16 a[96:111], v[64:67], v[44:47], 0
  v_mfma_f32_32x32x16_bf16 a[112:127], v[44:47], v[68:71], 0
  s_cbranch_vccz KV_G20
  s_waitcnt vmcnt(24)
KV_G20:
  s_waitcnt lgkmcnt(0)
  s_barrier
  v_mfma_f32_32x32x16_bf16 a[0:15], v[72:75], v[48:51], a[0:15]
  ds_read_b128 v[32:35], v16 offset:32768
  s_cbranch_vccz KV_G21
  s_add_u32 m0, s50, 0
  s_lshl_b32 s52, s61, 6
  buffer_load_dwordx4 v10, s[12:15], s52 offen lds
  buffer_load_dwordx4 v11, s[12:15], s52 offen offset:1024 lds
  buffer_load_dwordx4 v12, s[12:15], s52 offen offset:2048 lds
  buffer_load_dwordx4 v13, s[12:15], s52 offen offset:3072 lds
  s_add_u32 m0, s51, 0
  s_lshl_b32 s53, s61, 18
  buffer_load_dwordx4 v14, s[16:19], s53 offen lds
  buffer_load_dwordx4 v15, s[16:19], s53 offen offset:1024 lds
  s_add_u32 m0, s51, 0x2000
  s_nop 0
  buffer_load_dwordx4 v14, s[20:23], s53 offen lds
  buffer_load_dwordx4 v15, s[20:23], s53 offen offset:1024 lds
  s_add_u32 s61, s61, 1
  s_and_b32 s61, s61, 15
KV_G21:
  s_mul_i32 s40, s35, 0x80
  s_mul_i32 s41, s35, 0xffffff80
  v_mfma_f32_32x32x16_bf16 a[16:31], v[48:51], v[76:79], a[16:31]
  ds_read_b64_tr_b16 v[64:65], v22 offset:49152
  ds_read_b64_tr_b16 v[66:67], v22 offset:50176
  v_mov_b32 v7, s41
  v_mfma_f32_32x32x16_bf16 a[32:47], v[72:75], v[52:55], a[32:47]
  ds_read_b64_tr_b16 v[68:69], v22 offset:57344
  v_add_u32 v7, 0x780, v7
  v_mov_b32 v8, s40
  v_mfma_f32_32x32x16_bf16 a[48:63], v[52:55], v[76:79], a[48:63]
  ds_read_b64_tr_b16 v[70:71], v22 offset:58368
  v_cmp_gt_u32 s[4:5], 2, s91
  v_mfma_f32_32x32x16_bf16 a[64:79], v[72:75], v[56:59], a[64:79]
  ds_read_b128 v[36:39], v16 offset:34816
  ds_read_b128 v[40:43], v16 offset:36864
  v_cndmask_b32 v8, v7, v8, s[4:5]
  v_mov_b32 v7, s91
  v_mfma_f32_32x32x16_bf16 a[80:95], v[56:59], v[76:79], a[80:95]
  ds_read_b128 v[44:47], v16 offset:38912
  v_and_b32 v7, 1, v7
  v_mfma_f32_32x32x16_bf16 a[96:111], v[72:75], v[60:63], a[96:111]
  v_lshl_add_u32 v8, v7, 6, v8
  v_lshrrev_b32 v5, 3, v1
  v_mfma_f32_32x32x16_bf16 a[112:127], v[60:63], v[76:79], a[112:127]
  v_add_u32 v5, v8, v5
  s_waitcnt lgkmcnt(5)
  v_mfma_f32_32x32x16_bf16 a[0:15], v[64:67], v[32:35], a[0:15]
  ds_read_b128 v[48:51], v19 offset:32768
  v_mul_u32_u24 v5, 0x480, v5
  v_lshrrev_b32 v6, 4, v1
  s_waitcnt lgkmcnt(4)
  v_mfma_f32_32x32x16_bf16 a[16:31], v[32:35], v[68:71], a[16:31]
  ds_read_b64_tr_b16 v[72:73], v22 offset:53248
  ds_read_b64_tr_b16 v[74:75], v22 offset:54272
  v_xor_b32 v6, v6, v1
  v_and_b32 v6, 7, v6
  s_waitcnt lgkmcnt(5)
  v_mfma_f32_32x32x16_bf16 a[32:47], v[64:67], v[36:39], a[32:47]
  ds_read_b64_tr_b16 v[76:77], v22 offset:61440
  v_lshl_add_u32 v123, v6, 4, v5
  v_mfma_f32_32x32x16_bf16 a[48:63], v[36:39], v[68:71], a[48:63]
  ds_read_b64_tr_b16 v[78:79], v22 offset:62464
  v_xor_b32 v6, 4, v6
  v_lshl_add_u32 v124, v6, 4, v5
  s_waitcnt lgkmcnt(6)
  v_mfma_f32_32x32x16_bf16 a[64:79], v[64:67], v[40:43], a[64:79]
  ds_read_b128 v[52:55], v19 offset:34816
  ds_read_b128 v[56:59], v19 offset:36864
  v_add_u32 v124, 0x2000, v124
  v_mfma_f32_32x32x16_bf16 a[80:95], v[40:43], v[68:71], a[80:95]
  ds_read_b128 v[60:63], v19 offset:38912
  v_add_u32 v125, 0x4000, v123
  v_add_u32 v126, 0x4000, v124
  s_waitcnt lgkmcnt(8)
  v_mfma_f32_32x32x16_bf16 a[96:111], v[64:67], v[44:47], a[96:111]
  s_mul_i32 s42, s91, 0x2000
  v_mfma_f32_32x32x16_bf16 a[112:127], v[44:47], v[68:71], a[112:127]
  s_mul_i32 s43, s91, 0x1000
  s_mul_i32 s44, s91, 0x10000
  s_cbranch_vccz KV_G22
  s_waitcnt vmcnt(24)
KV_G22:
  s_waitcnt lgkmcnt(0)
  s_barrier
  v_mfma_f32_32x32x16_bf16 a[0:15], v[72:75], v[48:51], a[0:15]
  ds_read_b128 v[32:35], v17
  s_cbranch_vccz KV_G23
  s_add_u32 m0, s50, 0x8000
  s_lshl_b32 s52, s61, 6
  buffer_load_dwordx4 v10, s[12:15], s52 offen lds
  buffer_load_dwordx4 v11, s[12:15], s52 offen offset:1024 lds
  buffer_load_dwordx4 v12, s[12:15], s52 offen offset:2048 lds
  buffer_load_dwordx4 v13, s[12:15], s52 offen offset:3072 lds
  s_add_u32 m0, s51, 0x8000
  s_lshl_b32 s53, s61, 18
  buffer_load_dwordx4 v14, s[16:19], s53 offen lds
  buffer_load_dwordx4 v15, s[16:19], s53 offen offset:1024 lds
  s_add_u32 m0, s51, 0xa000
  s_nop 0
  buffer_load_dwordx4 v14, s[20:23], s53 offen lds
  buffer_load_dwordx4 v15, s[20:23], s53 offen offset:1024 lds
  s_add_u32 s61, s61, 1
  s_and_b32 s61, s61, 15
KV_G23:
  v_mfma_f32_32x32x16_bf16 a[16:31], v[48:51], v[76:79], a[16:31]
  ds_read_b64_tr_b16 v[64:65], v23 offset:16384
  ds_read_b64_tr_b16 v[66:67], v23 offset:17408
  v_mfma_f32_32x32x16_bf16 a[32:47], v[72:75], v[52:55], a[32:47]
  ds_read_b64_tr_b16 v[68:69], v23 offset:24576
  v_mfma_f32_32x32x16_bf16 a[48:63], v[52:55], v[76:79], a[48:63]
  ds_read_b64_tr_b16 v[70:71], v23 offset:25600
  v_mfma_f32_32x32x16_bf16 a[64:79], v[72:75], v[56:59], a[64:79]
  ds_read_b128 v[36:39], v17 offset:2048
  ds_read_b128 v[40:43], v17 offset:4096
  v_mfma_f32_32x32x16_bf16 a[80:95], v[56:59], v[76:79], a[80:95]
  ds_read_b128 v[44:47], v17 offset:6144
  v_mfma_f32_32x32x16_bf16 a[96:111], v[72:75], v[60:63], a[96:111]
  v_mfma_f32_32x32x16_bf16 a[112:127], v[60:63], v[76:79], a[112:127]
  s_waitcnt lgkmcnt(5)
  v_mfma_f32_32x32x16_bf16 a[0:15], v[64:67], v[32:35], a[0:15]
  ds_read_b128 v[48:51], v20
  s_waitcnt lgkmcnt(4)
  v_mfma_f32_32x32x16_bf16 a[16:31], v[32:35], v[68:71], a[16:31]
  ds_read_b64_tr_b16 v[72:73], v23 offset:20480
  ds_read_b64_tr_b16 v[74:75], v23 offset:21504
  s_waitcnt lgkmcnt(5)
  v_mfma_f32_32x32x16_bf16 a[32:47], v[64:67], v[36:39], a[32:47]
  ds_read_b64_tr_b16 v[76:77], v23 offset:28672
  v_mfma_f32_32x32x16_bf16 a[48:63], v[36:39], v[68:71], a[48:63]
  ds_read_b64_tr_b16 v[78:79], v23 offset:29696
  s_waitcnt lgkmcnt(6)
  v_mfma_f32_32x32x16_bf16 a[64:79], v[64:67], v[40:43], a[64:79]
  ds_read_b128 v[52:55], v20 offset:2048
  ds_read_b128 v[56:59], v20 offset:4096
  v_mfma_f32_32x32x16_bf16 a[80:95], v[40:43], v[68:71], a[80:95]
  ds_read_b128 v[60:63], v20 offset:6144
  s_waitcnt lgkmcnt(8)
  v_mfma_f32_32x32x16_bf16 a[96:111], v[64:67], v[44:47], a[96:111]
  v_mfma_f32_32x32x16_bf16 a[112:127], v[44:47], v[68:71], a[112:127]
  s_cbranch_vccz KV_G24
  s_waitcnt vmcnt(24)
KV_G24:
  s_waitcnt lgkmcnt(0)
  s_barrier
  v_mfma_f32_32x32x16_bf16 a[0:15], v[72:75], v[48:51], a[0:15]
  ds_read_b128 v[32:35], v17 offset:32768
  s_cbranch_vccz KV_G25
  s_add_u32 m0, s50, 0x10000
  s_lshl_b32 s52, s61, 6
  buffer_load_dwordx4 v10, s[12:15], s52 offen lds
  buffer_load_dwordx4 v11, s[12:15], s52 offen offset:1024 lds
  buffer_load_dwordx4 v12, s[12:15], s52 offen offset:2048 lds
  buffer_load_dwordx4 v13, s[12:15], s52 offen offset:3072 lds
  s_add_u32 m0, s51, 0x10000
  s_lshl_b32 s53, s61, 18
  buffer_load_dwordx4 v14, s[16:19], s53 offen lds
  buffer_load_dwordx4 v15, s[16:19], s53 offen offset:1024 lds
  s_add_u32 m0, s51, 0x12000
  s_nop 0
  buffer_load_dwordx4 v14, s[20:23], s53 offen lds
  buffer_load_dwordx4 v15, s[20:23], s53 offen offset:1024 lds
  s_add_u32 s61, s61, 1
  s_and_b32 s61, s61, 15
KV_G25:
  v_mfma_f32_32x32x16_bf16 a[16:31], v[48:51], v[76:79], a[16:31]
  ds_read_b64_tr_b16 v[64:65], v23 offset:49152
  ds_read_b64_tr_b16 v[66:67], v23 offset:50176
  v_mfma_f32_32x32x16_bf16 a[32:47], v[72:75], v[52:55], a[32:47]
  ds_read_b64_tr_b16 v[68:69], v23 offset:57344
  s_cmp_eq_u32 s39, 0
  s_cbranch_scc1 ONLY15
  s_waitcnt vmcnt(0)
ONLY15:
  v_mfma_f32_32x32x16_bf16 a[48:63], v[52:55], v[76:79], a[48:63]
  ds_read_b64_tr_b16 v[70:71], v23 offset:58368
  v_mfma_f32_32x32x16_bf16 a[64:79], v[72:75], v[56:59], a[64:79]
  ds_read_b128 v[36:39], v17 offset:34816
  ds_read_b128 v[40:43], v17 offset:36864
  v_mfma_f32_32x32x16_bf16 a[80:95], v[56:59], v[76:79], a[80:95]
  ds_read_b128 v[44:47], v17 offset:38912
  v_mfma_f32_32x32x16_bf16 a[96:111], v[72:75], v[60:63], a[96:111]
  v_mfma_f32_32x32x16_bf16 a[112:127], v[60:63], v[76:79], a[112:127]
  s_waitcnt lgkmcnt(5)
  v_mfma_f32_32x32x16_bf16 a[0:15], v[64:67], v[32:35], a[0:15]
  ds_read_b128 v[48:51], v20 offset:32768
  s_waitcnt lgkmcnt(4)
  v_mfma_f32_32x32x16_bf16 a[16:31], v[32:35], v[68:71], a[16:31]
  ds_read_b64_tr_b16 v[72:73], v23 offset:53248
  ds_read_b64_tr_b16 v[74:75], v23 offset:54272
  s_waitcnt lgkmcnt(5)
  v_mfma_f32_32x32x16_bf16 a[32:47], v[64:67], v[36:39], a[32:47]
  ds_read_b64_tr_b16 v[76:77], v23 offset:61440
  v_mfma_f32_32x32x16_bf16 a[48:63], v[36:39], v[68:71], a[48:63]
  ds_read_b64_tr_b16 v[78:79], v23 offset:62464
  s_waitcnt lgkmcnt(6)
  v_mfma_f32_32x32x16_bf16 a[64:79], v[64:67], v[40:43], a[64:79]
  ds_read_b128 v[52:55], v20 offset:34816
  ds_read_b128 v[56:59], v20 offset:36864
  v_mfma_f32_32x32x16_bf16 a[80:95], v[40:43], v[68:71], a[80:95]
  ds_read_b128 v[60:63], v20 offset:38912
  s_waitcnt lgkmcnt(8)
  v_mfma_f32_32x32x16_bf16 a[96:111], v[64:67], v[44:47], a[96:111]
  v_mfma_f32_32x32x16_bf16 a[112:127], v[44:47], v[68:71], a[112:127]
  s_cbranch_vccz KV_G26
  s_waitcnt vmcnt(24)
KV_G26:
  s_waitcnt lgkmcnt(0)
  s_barrier
  v_mfma_f32_32x32x16_bf16 a[0:15], v[72:75], v[48:51], a[0:15]
  ds_read_b128 v[32:35], v18
  s_cbranch_vccz KV_G27
  s_add_u32 m0, s50, 0x18000
  s_lshl_b32 s52, s61, 6
  buffer_load_dwordx4 v10, s[12:15], s52 offen lds
  buffer_load_dwordx4 v11, s[12:15], s52 offen offset:1024 lds
  buffer_load_dwordx4 v12, s[12:15], s52 offen offset:2048 lds
  buffer_load_dwordx4 v13, s[12:15], s52 offen offset:3072 lds
  s_add_u32 m0, s51, 0x18000
  s_lshl_b32 s53, s61, 18
  buffer_load_dwordx4 v14, s[16:19], s53 offen lds
  buffer_load_dwordx4 v15, s[16:19], s53 offen offset:1024 lds
  s_add_u32 m0, s51, 0x1a000
  s_nop 0
  buffer_load_dwordx4 v14, s[20:23], s53 offen lds
  buffer_load_dwordx4 v15, s[20:23], s53 offen offset:1024 lds
  s_add_u32 s61, s61, 1
  s_and_b32 s61, s61, 15
KV_G27:
  v_mfma_f32_32x32x16_bf16 a[16:31], v[48:51], v[76:79], a[16:31]
  ds_read_b64_tr_b16 v[64:65], v24 offset:16384
  ds_read_b64_tr_b16 v[66:67], v24 offset:17408
  v_mfma_f32_32x32x16_bf16 a[32:47], v[72:75], v[52:55], a[32:47]
  ds_read_b64_tr_b16 v[68:69], v24 offset:24576
  s_cmp_lg_u32 s3, 4
  s_cbranch_scc1 ONLYW16
  buffer_store_dword v4, v30, s[8:11], s37 offen offset:0 sc1
ONLYW16:
  v_mfma_f32_32x32x16_bf16 a[48:63], v[52:55], v[76:79], a[48:63]
  ds_read_b64_tr_b16 v[70:71], v24 offset:25600
  v_mfma_f32_32x32x16_bf16 a[64:79], v[72:75], v[56:59], a[64:79]
  ds_read_b128 v[36:39], v18 offset:2048
  ds_read_b128 v[40:43], v18 offset:4096
  v_mfma_f32_32x32x16_bf16 a[80:95], v[56:59], v[76:79], a[80:95]
  ds_read_b128 v[44:47], v18 offset:6144
  v_mfma_f32_32x32x16_bf16 a[96:111], v[72:75], v[60:63], a[96:111]
  v_mfma_f32_32x32x16_bf16 a[112:127], v[60:63], v[76:79], a[112:127]
  s_waitcnt lgkmcnt(5)
  v_mfma_f32_32x32x16_bf16 a[0:15], v[64:67], v[32:35], a[0:15]
  ds_read_b128 v[48:51], v21
  s_waitcnt lgkmcnt(4)
  v_mfma_f32_32x32x16_bf16 a[16:31], v[32:35], v[68:71], a[16:31]
  ds_read_b64_tr_b16 v[72:73], v24 offset:20480
  ds_read_b64_tr_b16 v[74:75], v24 offset:21504
  s_waitcnt lgkmcnt(5)
  v_mfma_f32_32x32x16_bf16 a[32:47], v[64:67], v[36:39], a[32:47]
  ds_read_b64_tr_b16 v[76:77], v24 offset:28672
  v_mfma_f32_32x32x16_bf16 a[48:63], v[36:39], v[68:71], a[48:63]
  ds_read_b64_tr_b16 v[78:79], v24 offset:29696
  s_waitcnt lgkmcnt(6)
  v_mfma_f32_32x32x16_bf16 a[64:79], v[64:67], v[40:43], a[64:79]
  ds_read_b128 v[52:55], v21 offset:2048
  ds_read_b128 v[56:59], v21 offset:4096
  v_mfma_f32_32x32x16_bf16 a[80:95], v[40:43], v[68:71], a[80:95]
  ds_read_b128 v[60:63], v21 offset:6144
  s_waitcnt lgkmcnt(8)
  v_mfma_f32_32x32x16_bf16 a[96:111], v[64:67], v[44:47], a[96:111]
  v_mfma_f32_32x32x16_bf16 a[112:127], v[44:47], v[68:71], a[112:127]
  s_cbranch_vccz KV_G28
  s_waitcnt vmcnt(24)
KV_G28:
  s_waitcnt lgkmcnt(0)
  s_barrier
  v_mfma_f32_32x32x16_bf16 a[0:15], v[72:75], v[48:51], a[0:15]
  ds_read_b128 v[32:35], v16
  s_cbranch_vccz KV_G29
  s_add_u32 m0, s50, 0x20000
  s_lshl_b32 s52, s61, 6
  buffer_load_dwordx4 v10, s[12:15], s52 offen lds
  buffer_load_dwordx4 v11, s[12:15], s52 offen offset:1024 lds
  buffer_load_dwordx4 v12, s[12:15], s52 offen offset:2048 lds
  buffer_load_dwordx4 v13, s[12:15], s52 offen offset:3072 lds
  s_add_u32 m0, s51, 0x20000
  s_lshl_b32 s53, s61, 18
  buffer_load_dwordx4 v14, s[16:19], s53 offen lds
  buffer_load_dwordx4 v15, s[16:19], s53 offen offset:1024 lds
  s_add_u32 m0, s51, 0x22000
  s_nop 0
  buffer_load_dwordx4 v14, s[20:23], s53 offen lds
  buffer_load_dwordx4 v15, s[20:23], s53 offen offset:1024 lds
  s_add_u32 s61, s61, 1
  s_and_b32 s61, s61, 15
KV_G29:
  s_cmp_lg_u32 s3, 5
  s_cbranch_scc1 ONLYW17
  s_mov_b32 s56, s64
  s_mov_b32 s57, s65
  s_mov_b32 s58, 0x240000
  s_mov_b32 s59, 0x20000
  s_mul_i32 s63, s2, 0x2400
  s_add_u32 s63, s63, 0
  v_min_u32 v5, 63, v1
  v_lshlrev_b32 v5, 7, v5
  buffer_load_dword v31, v5, s[56:59], s63 offen
ONLYW17:
  v_mfma_f32_32x32x16_bf16 a[16:31], v[48:51], v[76:79], a[16:31]
  ds_read_b64_tr_b16 v[64:65], v22 offset:16384
  ds_read_b64_tr_b16 v[66:67], v22 offset:17408
  v_mfma_f32_32x32x16_bf16 a[32:47], v[72:75], v[52:55], a[32:47]
  ds_read_b64_tr_b16 v[68:69], v22 offset:24576
  v_mfma_f32_32x32x16_bf16 a[48:63], v[52:55], v[76:79], a[48:63]
  ds_read_b64_tr_b16 v[70:71], v22 offset:25600
  v_mfma_f32_32x32x16_bf16 a[64:79], v[72:75], v[56:59], a[64:79]
  ds_read_b128 v[36:39], v16 offset:2048
  ds_read_b128 v[40:43], v16 offset:4096
  v_mfma_f32_32x32x16_bf16 a[80:95], v[56:59], v[76:79], a[80:95]
  ds_read_b128 v[44:47], v16 offset:6144
  s_cmp_lg_u32 s3, 6
  s_cbranch_scc1 ONLYW18
  s_mov_b32 s56, s64
  s_mov_b32 s57, s65
  s_mov_b32 s58, 0x240000
  s_mov_b32 s59, 0x20000
  s_mul_i32 s63, s2, 0x2400
  s_add_u32 s63, s63, 0x2000
  v_min_u32 v5, 7, v1
  v_lshlrev_b32 v5, 7, v5
  buffer_load_dword v31, v5, s[56:59], s63 offen
ONLYW18:
  v_mfma_f32_32x32x16_bf16 a[96:111], v[72:75], v[60:63], a[96:111]
  v_mfma_f32_32x32x16_bf16 a[112:127], v[60:63], v[76:79], a[112:127]
  s_waitcnt lgkmcnt(5)
  v_mfma_f32_32x32x16_bf16 a[0:15], v[64:67], v[32:35], a[0:15]
  ds_read_b128 v[48:51], v19
  s_waitcnt lgkmcnt(4)
  v_mfma_f32_32x32x16_bf16 a[16:31], v[32:35], v[68:71], a[16:31]
  ds_read_b64_tr_b16 v[72:73], v22 offset:20480
  ds_read_b64_tr_b16 v[74:75], v22 offset:21504
  s_waitcnt lgkmcnt(5)
  v_mfma_f32_32x32x16_bf16 a[32:47], v[64:67], v[36:39], a[32:47]
  ds_read_b64_tr_b16 v[76:77], v22 offset:28672
  s_cmp_lg_u32 s3, 7
  s_cbranch_scc1 ONLYW19
  s_mov_b32 s56, s68
  s_mov_b32 s57, s69
  s_mov_b32 s58, 0x480000
  s_mov_b32 s59, 0x20000
  s_mul_i32 s63, s2, 0x4800
  s_add_u32 s63, s63, 0
  v_min_u32 v5, 63, v1
  v_lshlrev_b32 v5, 7, v5
  buffer_load_dword v31, v5, s[56:59], s63 offen
ONLYW19:
  v_mfma_f32_32x32x16_bf16 a[48:63], v[36:39], v[68:71], a[48:63]
  ds_read_b64_tr_b16 v[78:79], v22 offset:29696
  s_waitcnt lgkmcnt(6)
  v_mfma_f32_32x32x16_bf16 a[64:79], v[64:67], v[40:43], a[64:79]
  ds_read_b128 v[52:55], v19 offset:2048
  ds_read_b128 v[56:59], v19 offset:4096
  v_mfma_f32_32x32x16_bf16 a[80:95], v[40:43], v[68:71], a[80:95]
  ds_read_b128 v[60:63], v19 offset:6144
  s_waitcnt lgkmcnt(8)
  v_mfma_f32_32x32x16_bf16 a[96:111], v[64:67], v[44:47], a[96:111]
  v_mfma_f32_32x32x16_bf16 a[112:127], v[44:47], v[68:71], a[112:127]
  s_cbranch_vccz KV_G30
  s_waitcnt vmcnt(24)
KV_G30:
  s_waitcnt lgkmcnt(0)
  s_barrier
  v_mfma_f32_32x32x16_bf16 a[0:15], v[72:75], v[48:51], a[0:15]
  ds_read_b128 v[32:35], v16 offset:32768
  s_cbranch_vccz KV_G31
  s_add_u32 m0, s50, 0
  s_lshl_b32 s52, s61, 6
  buffer_load_dwordx4 v10, s[12:15], s52 offen lds
  buffer_load_dwordx4 v11, s[12:15], s52 offen offset:1024 lds
  buffer_load_dwordx4 v12, s[12:15], s52 offen offset:2048 lds
  buffer_load_dwordx4 v13, s[12:15], s52 offen offset:3072 lds
  s_add_u32 m0, s51, 0
  s_lshl_b32 s53, s61, 18
  buffer_load_dwordx4 v14, s[16:19], s53 offen lds
  buffer_load_dwordx4 v15, s[16:19], s53 offen offset:1024 lds
  s_add_u32 m0, s51, 0x2000
  s_nop 0
  buffer_load_dwordx4 v14, s[20:23], s53 offen lds
  buffer_load_dwordx4 v15, s[20:23], s53 offen offset:1024 lds
  s_add_u32 s61, s61, 1
  s_and_b32 s61, s61, 15
KV_G31:
  v_mfma_f32_32x32x16_bf16 a[16:31], v[48:51], v[76:79], a[16:31]
  ds_read_b64_tr_b16 v[64:65], v22 offset:49152
  ds_read_b64_tr_b16 v[66:67], v22 offset:50176
  v_mfma_f32_32x32x16_bf16 a[32:47], v[72:75], v[52:55], a[32:47]
  ds_read_b64_tr_b16 v[68:69], v22 offset:57344
  v_mfma_f32_32x32x16_bf16 a[48:63], v[52:55], v[76:79], a[48:63]
  ds_read_b64_tr_b16 v[70:71], v22 offset:58368
  v_mfma_f32_32x32x16_bf16 a[64:79], v[72:75], v[56:59], a[64:79]
  ds_read_b128 v[36:39], v16 offset:34816
  ds_read_b128 v[40:43], v16 offset:36864
  v_mfma_f32_32x32x16_bf16 a[80:95], v[56:59], v[76:79], a[80:95]
  ds_read_b128 v[44:47], v16 offset:38912
  v_mfma_f32_32x32x16_bf16 a[96:111], v[72:75], v[60:63], a[96:111]
  v_mfma_f32_32x32x16_bf16 a[112:127], v[60:63], v[76:79], a[112:127]
  s_waitcnt lgkmcnt(5)
  v_mfma_f32_32x32x16_bf16 a[0:15], v[64:67], v[32:35], a[0:15]
  ds_read_b128 v[48:51], v19 offset:32768
  s_waitcnt lgkmcnt(4)
  v_mfma_f32_32x32x16_bf16 a[16:31], v[32:35], v[68:71], a[16:31]
  ds_read_b64_tr_b16 v[72:73], v22 offset:53248
  ds_read_b64_tr_b16 v[74:75], v22 offset:54272
  s_waitcnt lgkmcnt(5)
  v_mfma_f32_32x32x16_bf16 a[32:47], v[64:67], v[36:39], a[32:47]
  ds_read_b64_tr_b16 v[76:77], v22 offset:61440
  v_mfma_f32_32x32x16_bf16 a[48:63], v[36:39], v[68:71], a[48:63]
  ds_read_b64_tr_b16 v[78:79], v22 offset:62464
  s_waitcnt lgkmcnt(6)
  v_mfma_f32_32x32x16_bf16 a[64:79], v[64:67], v[40:43], a[64:79]
  ds_read_b128 v[52:55], v19 offset:34816
  ds_read_b128 v[56:59], v19 offset:36864
  v_mfma_f32_32x32x16_bf16 a[80:95], v[40:43], v[68:71], a[80:95]
  ds_read_b128 v[60:63], v19 offset:38912
  s_waitcnt lgkmcnt(8)
  v_mfma_f32_32x32x16_bf16 a[96:111], v[64:67], v[44:47], a[96:111]
  v_mfma_f32_32x32x16_bf16 a[112:127], v[44:47], v[68:71], a[112:127]
  s_cbranch_vccz KV_G32
  s_waitcnt vmcnt(24)
KV_G32:
  s_waitcnt lgkmcnt(0)
  s_barrier
  v_mfma_f32_32x32x16_bf16 a[0:15], v[72:75], v[48:51], a[0:15]
  ds_read_b128 v[32:35], v17
  s_cbranch_vccz KV_G33
  s_add_u32 m0, s50, 0x8000
  s_lshl_b32 s52, s61, 6
  buffer_load_dwordx4 v10, s[12:15], s52 offen lds
  buffer_load_dwordx4 v11, s[12:15], s52 offen offset:1024 lds
  buffer_load_dwordx4 v12, s[12:15], s52 offen offset:2048 lds
  buffer_load_dwordx4 v13, s[12:15], s52 offen offset:3072 lds
  s_add_u32 m0, s51, 0x8000
  s_lshl_b32 s53, s61, 18
  buffer_load_dwordx4 v14, s[16:19], s53 offen lds
  buffer_load_dwordx4 v15, s[16:19], s53 offen offset:1024 lds
  s_add_u32 m0, s51, 0xa000
  s_nop 0
  buffer_load_dwordx4 v14, s[20:23], s53 offen lds
  buffer_load_dwordx4 v15, s[20:23], s53 offen offset:1024 lds
  s_add_u32 s61, s61, 1
  s_and_b32 s61, s61, 15
KV_G33:
  v_mfma_f32_32x32x16_bf16 a[16:31], v[48:51], v[76:79], a[16:31]
  ds_read_b64_tr_b16 v[64:65], v23 offset:16384
  ds_read_b64_tr_b16 v[66:67], v23 offset:17408
  v_mfma_f32_32x32x16_bf16 a[32:47], v[72:75], v[52:55], a[32:47]
  ds_read_b64_tr_b16 v[68:69], v23 offset:24576
  s_cmp_lg_u32 s3, 4
  s_cbranch_scc1 ONLYW23
  buffer_load_dword v81, v80, s[28:31], 0 offen sc1
ONLYW23:
  v_mfma_f32_32x32x16_bf16 a[48:63], v[52:55], v[76:79], a[48:63]
  ds_read_b64_tr_b16 v[70:71], v23 offset:25600
  v_mfma_f32_32x32x16_bf16 a[64:79], v[72:75], v[56:59], a[64:79]
  ds_read_b128 v[36:39], v17 offset:2048
  ds_read_b128 v[40:43], v17 offset:4096
  v_mfma_f32_32x32x16_bf16 a[80:95], v[56:59], v[76:79], a[80:95]
  ds_read_b128 v[44:47], v17 offset:6144
  v_mfma_f32_32x32x16_bf16 a[96:111], v[72:75], v[60:63], a[96:111]
  v_mfma_f32_32x32x16_bf16 a[112:127], v[60:63], v[76:79], a[112:127]
  s_waitcnt lgkmcnt(5)
  v_mfma_f32_32x32x16_bf16 a[0:15], v[64:67], v[32:35], a[0:15]
  ds_read_b128 v[48:51], v20
  s_waitcnt lgkmcnt(4)
  v_mfma_f32_32x32x16_bf16 a[16:31], v[32:35], v[68:71], a[16:31]
  ds_read_b64_tr_b16 v[72:73], v23 offset:20480
  ds_read_b64_tr_b16 v[74:75], v23 offset:21504
  s_waitcnt lgkmcnt(5)
  v_mfma_f32_32x32x16_bf16 a[32:47], v[64:67], v[36:39], a[32:47]
  ds_read_b64_tr_b16 v[76:77], v23 offset:28672
  v_mfma_f32_32x32x16_bf16 a[48:63], v[36:39], v[68:71], a[48:63]
  ds_read_b64_tr_b16 v[78:79], v23 offset:29696
  s_waitcnt lgkmcnt(6)
  v_mfma_f32_32x32x16_bf16 a[64:79], v[64:67], v[40:43], a[64:79]
  ds_read_b128 v[52:55], v20 offset:2048
  ds_read_b128 v[56:59], v20 offset:4096
  v_mfma_f32_32x32x16_bf16 a[80:95], v[40:43], v[68:71], a[80:95]
  ds_read_b128 v[60:63], v20 offset:6144
  s_waitcnt lgkmcnt(8)
  v_mfma_f32_32x32x16_bf16 a[96:111], v[64:67], v[44:47], a[96:111]
  v_mfma_f32_32x32x16_bf16 a[112:127], v[44:47], v[68:71], a[112:127]
  s_cbranch_vccz KV_G34
  s_waitcnt vmcnt(24)
KV_G34:
  s_waitcnt lgkmcnt(0)
  s_barrier
  v_mfma_f32_32x32x16_bf16 a[0:15], v[72:75], v[48:51], a[0:15]
  ds_read_b128 v[32:35], v17 offset:32768
  s_cbranch_vccz KV_G35
  s_add_u32 m0, s50, 0x10000
  s_lshl_b32 s52, s61, 6
  buffer_load_dwordx4 v10, s[12:15], s52 offen lds
  buffer_load_dwordx4 v11, s[12:15], s52 offen offset:1024 lds
  buffer_load_dwordx4 v12, s[12:15], s52 offen offset:2048 lds
  buffer_load_dwordx4 v13, s[12:15], s52 offen offset:3072 lds
  s_add_u32 m0, s51, 0x10000
  s_lshl_b32 s53, s61, 18
  buffer_load_dwordx4 v14, s[16:19], s53 offen lds
  buffer_load_dwordx4 v15, s[16:19], s53 offen offset:1024 lds
  s_add_u32 m0, s51, 0x12000
  s_nop 0
  buffer_load_dwordx4 v14, s[20:23], s53 offen lds
  buffer_load_dwordx4 v15, s[20:23], s53 offen offset:1024 lds
  s_add_u32 s61, s61, 1
  s_and_b32 s61, s61, 15
KV_G35:
  s_cmp_lg_u32 s3, 5
  s_cbranch_scc1 ONLYW20
  s_mov_b32 s56, s68
  s_mov_b32 s57, s69
  s_mov_b32 s58, 0x480000
  s_mov_b32 s59, 0x20000
  s_mul_i32 s63, s2, 0x4800
  s_add_u32 s63, s63, 0x2000
  v_min_u32 v5, 63, v1
  v_lshlrev_b32 v5, 7, v5
  buffer_load_dword v31, v5, s[56:59], s63 offen
ONLYW20:
  v_mfma_f32_32x32x16_bf16 a[16:31], v[48:51], v[76:79], a[16:31]
  ds_read_b64_tr_b16 v[64:65], v23 offset:49152
  ds_read_b64_tr_b16 v[66:67], v23 offset:50176
  v_mfma_f32_32x32x16_bf16 a[32:47], v[72:75], v[52:55], a[32:47]
  ds_read_b64_tr_b16 v[68:69], v23 offset:57344
  v_mfma_f32_32x32x16_bf16 a[48:63], v[52:55], v[76:79], a[48:63]
  ds_read_b64_tr_b16 v[70:71], v23 offset:58368
  v_mfma_f32_32x32x16_bf16 a[64:79], v[72:75], v[56:59], a[64:79]
  ds_read_b128 v[36:39], v17 offset:34816
  ds_read_b128 v[40:43], v17 offset:36864
  v_mfma_f32_32x32x16_bf16 a[80:95], v[56:59], v[76:79], a[80:95]
  ds_read_b128 v[44:47], v17 offset:38912
  v_mfma_f32_32x32x16_bf16 a[96:111], v[72:75], v[60:63], a[96:111]
  v_mfma_f32_32x32x16_bf16 a[112:127], v[60:63], v[76:79], a[112:127]
  s_waitcnt lgkmcnt(5)
  v_mfma_f32_32x32x16_bf16 a[0:15], v[64:67], v[32:35], a[0:15]
  ds_read_b128 v[48:51], v20 offset:32768
  s_cmp_lg_u32 s3, 6
  s_cbranch_scc1 ONLYW21
  s_mov_b32 s56, s68
  s_mov_b32 s57, s69
  s_mov_b32 s58, 0x480000
  s_mov_b32 s59, 0x20000
  s_mul_i32 s63, s2, 0x4800
  s_add_u32 s63, s63, 0x4000
  v_min_u32 v5, 15, v1
  v_lshlrev_b32 v5, 7, v5
  buffer_load_dword v31, v5, s[56:59], s63 offen
ONLYW21:
  s_waitcnt lgkmcnt(4)
  v_mfma_f32_32x32x16_bf16 a[16:31], v[32:35], v[68:71], a[16:31]
  ds_read_b64_tr_b16 v[72:73], v23 offset:53248
  ds_read_b64_tr_b16 v[74:75], v23 offset:54272
  s_waitcnt lgkmcnt(5)
  v_mfma_f32_32x32x16_bf16 a[32:47], v[64:67], v[36:39], a[32:47]
  ds_read_b64_tr_b16 v[76:77], v23 offset:61440
  v_mfma_f32_32x32x16_bf16 a[48:63], v[36:39], v[68:71], a[48:63]
  ds_read_b64_tr_b16 v[78:79], v23 offset:62464
  s_waitcnt lgkmcnt(6)
  v_mfma_f32_32x32x16_bf16 a[64:79], v[64:67], v[40:43], a[64:79]
  ds_read_b128 v[52:55], v20 offset:34816
  ds_read_b128 v[56:59], v20 offset:36864
  v_mfma_f32_32x32x16_bf16 a[80:95], v[40:43], v[68:71], a[80:95]
  ds_read_b128 v[60:63], v20 offset:38912
  s_waitcnt lgkmcnt(8)
  v_mfma_f32_32x32x16_bf16 a[96:111], v[64:67], v[44:47], a[96:111]
  v_mfma_f32_32x32x16_bf16 a[112:127], v[44:47], v[68:71], a[112:127]
  s_cbranch_vccz KV_G36
  s_waitcnt vmcnt(24)
KV_G36:
  s_waitcnt lgkmcnt(0)
  s_barrier
  v_mfma_f32_32x32x16_bf16 a[0:15], v[72:75], v[48:51], a[0:15]
  ds_read_b128 v[32:35], v18
  s_cbranch_vccz KV_G37
  s_add_u32 m0, s50, 0x18000
  s_lshl_b32 s52, s61, 6
  buffer_load_dwordx4 v10, s[12:15], s52 offen lds
  buffer_load_dwordx4 v11, s[12:15], s52 offen offset:1024 lds
  buffer_load_dwordx4 v12, s[12:15], s52 offen offset:2048 lds
  buffer_load_dwordx4 v13, s[12:15], s52 offen offset:3072 lds
  s_add_u32 m0, s51, 0x18000
  s_lshl_b32 s53, s61, 18
  buffer_load_dwordx4 v14, s[16:19], s53 offen lds
  buffer_load_dwordx4 v15, s[16:19], s53 offen offset:1024 lds
  s_add_u32 m0, s51, 0x1a000
  s_nop 0
  buffer_load_dwordx4 v14, s[20:23], s53 offen lds
  buffer_load_dwordx4 v15, s[20:23], s53 offen offset:1024 lds
  s_add_u32 s61, s61, 1
  s_and_b32 s61, s61, 15
KV_G37:
  v_mfma_f32_32x32x16_bf16 a[16:31], v[48:51], v[76:79], a[16:31]
  ds_read_b64_tr_b16 v[64:65], v24 offset:16384
  ds_read_b64_tr_b16 v[66:67], v24 offset:17408
  v_mfma_f32_32x32x16_bf16 a[32:47], v[72:75], v[52:55], a[32:47]
  ds_read_b64_tr_b16 v[68:69], v24 offset:24576
  v_mfma_f32_32x32x16_bf16 a[48:63], v[52:55], v[76:79], a[48:63]
  ds_read_b64_tr_b16 v[70:71], v24 offset:25600
  v_mfma_f32_32x32x16_bf16 a[64:79], v[72:75], v[56:59], a[64:79]
  ds_read_b128 v[36:39], v18 offset:2048
  ds_read_b128 v[40:43], v18 offset:4096
  v_mfma_f32_32x32x16_bf16 a[80:95], v[56:59], v[76:79], a[80:95]
  ds_read_b128 v[44:47], v18 offset:6144
  v_mfma_f32_32x32x16_bf16 a[96:111], v[72:75], v[60:63], a[96:111]
  v_mfma_f32_32x32x16_bf16 a[112:127], v[60:63], v[76:79], a[112:127]
  s_waitcnt lgkmcnt(5)
  v_mfma_f32_32x32x16_bf16 a[0:15], v[64:67], v[32:35], a[0:15]
  ds_read_b128 v[48:51], v21
  s_waitcnt lgkmcnt(4)
  v_mfma_f32_32x32x16_bf16 a[16:31], v[32:35], v[68:71], a[16:31]
  ds_read_b64_tr_b16 v[72:73], v24 offset:20480
  ds_read_b64_tr_b16 v[74:75], v24 offset:21504
  s_waitcnt lgkmcnt(5)
  v_mfma_f32_32x32x16_bf16 a[32:47], v[64:67], v[36:39], a[32:47]
  ds_read_b64_tr_b16 v[76:77], v24 offset:28672
  v_mfma_f32_32x32x16_bf16 a[48:63], v[36:39], v[68:71], a[48:63]
  ds_read_b64_tr_b16 v[78:79], v24 offset:29696
  s_waitcnt lgkmcnt(6)
  v_mfma_f32_32x32x16_bf16 a[64:79], v[64:67], v[40:43], a[64:79]
  ds_read_b128 v[52:55], v21 offset:2048
  ds_read_b128 v[56:59], v21 offset:4096
  v_mfma_f32_32x32x16_bf16 a[80:95], v[40:43], v[68:71], a[80:95]
  ds_read_b128 v[60:63], v21 offset:6144
  s_waitcnt lgkmcnt(8)
  v_mfma_f32_32x32x16_bf16 a[96:111], v[64:67], v[44:47], a[96:111]
  v_mfma_f32_32x32x16_bf16 a[112:127], v[44:47], v[68:71], a[112:127]
  s_cbranch_vccz KV_G38
  s_waitcnt vmcnt(24)
KV_G38:
  s_waitcnt lgkmcnt(0)
  s_barrier
  v_mfma_f32_32x32x16_bf16 a[0:15], v[72:75], v[48:51], a[0:15]
  ds_read_b128 v[32:35], v16
  s_cbranch_vccz KV_G39
  s_add_u32 m0, s50, 0x20000
  s_lshl_b32 s52, s61, 6
  buffer_load_dwordx4 v10, s[12:15], s52 offen lds
  buffer_load_dwordx4 v11, s[12:15], s52 offen offset:1024 lds
  buffer_load_dwordx4 v12, s[12:15], s52 offen offset:2048 lds
  buffer_load_dwordx4 v13, s[12:15], s52 offen offset:3072 lds
  s_add_u32 m0, s51, 0x20000
  s_lshl_b32 s53, s61, 18
  buffer_load_dwordx4 v14, s[16:19], s53 offen lds
  buffer_load_dwordx4 v15, s[16:19], s53 offen offset:1024 lds
  s_add_u32 m0, s51, 0x22000
  s_nop 0
  buffer_load_dwordx4 v14, s[20:23], s53 offen lds
  buffer_load_dwordx4 v15, s[20:23], s53 offen offset:1024 lds
  s_add_u32 s61, s61, 1
  s_and_b32 s61, s61, 15
KV_G39:
  v_mfma_f32_32x32x16_bf16 a[16:31], v[48:51], v[76:79], a[16:31]
  ds_read_b64_tr_b16 v[64:65], v22 offset:16384
  ds_read_b64_tr_b16 v[66:67], v22 offset:17408
  v_mfma_f32_32x32x16_bf16 a[32:47], v[72:75], v[52:55], a[32:47]
  ds_read_b64_tr_b16 v[68:69], v22 offset:24576
  v_mfma_f32_32x32x16_bf16 a[48:63], v[52:55], v[76:79], a[48:63]
  ds_read_b64_tr_b16 v[70:71], v22 offset:25600
  v_mfma_f32_32x32x16_bf16 a[64:79], v[72:75], v[56:59], a[64:79]
  ds_read_b128 v[36:39], v16 offset:2048
  ds_read_b128 v[40:43], v16 offset:4096
  v_mfma_f32_32x32x16_bf16 a[80:95], v[56:59], v[76:79], a[80:95]
  ds_read_b128 v[44:47], v16 offset:6144
  v_mfma_f32_32x32x16_bf16 a[96:111], v[72:75], v[60:63], a[96:111]
  v_mfma_f32_32x32x16_bf16 a[112:127], v[60:63], v[76:79], a[112:127]
  s_waitcnt lgkmcnt(5)
  v_mfma_f32_32x32x16_bf16 a[0:15], v[64:67], v[32:35], a[0:15]
  ds_read_b128 v[48:51], v19
  s_waitcnt lgkmcnt(4)
  v_mfma_f32_32x32x16_bf16 a[16:31], v[32:35], v[68:71], a[16:31]
  ds_read_b64_tr_b16 v[72:73], v22 offset:20480
  ds_read_b64_tr_b16 v[74:75], v22 offset:21504
  s_waitcnt lgkmcnt(5)
  v_mfma_f32_32x32x16_bf16 a[32:47], v[64:67], v[36:39], a[32:47]
  ds_read_b64_tr_b16 v[76:77], v22 offset:28672
  v_mfma_f32_32x32x16_bf16 a[48:63], v[36:39], v[68:71], a[48:63]
  ds_read_b64_tr_b16 v[78:79], v22 offset:29696
  s_waitcnt lgkmcnt(6)
  v_mfma_f32_32x32x16_bf16 a[64:79], v[64:67], v[40:43], a[64:79]
  ds_read_b128 v[52:55], v19 offset:2048
  ds_read_b128 v[56:59], v19 offset:4096
  v_mfma_f32_32x32x16_bf16 a[80:95], v[40:43], v[68:71], a[80:95]
  ds_read_b128 v[60:63], v19 offset:6144
  s_waitcnt lgkmcnt(8)
  v_mfma_f32_32x32x16_bf16 a[96:111], v[64:67], v[44:47], a[96:111]
  v_mfma_f32_32x32x16_bf16 a[112:127], v[44:47], v[68:71], a[112:127]
  s_cbranch_vccz KV_G40
  s_waitcnt vmcnt(24)
KV_G40:
  s_waitcnt lgkmcnt(0)
  s_barrier
  v_mfma_f32_32x32x16_bf16 a[0:15], v[72:75], v[48:51], a[0:15]
  ds_read_b128 v[32:35], v16 offset:32768
  s_cbranch_vccz KV_G41
  s_add_u32 m0, s50, 0
  s_lshl_b32 s52, s61, 6
  buffer_load_dwordx4 v10, s[12:15], s52 offen lds
  buffer_load_dwordx4 v11, s[12:15], s52 offen offset:1024 lds
  buffer_load_dwordx4 v12, s[12:15], s52 offen offset:2048 lds
  buffer_load_dwordx4 v13, s[12:15], s52 offen offset:3072 lds
  s_add_u32 m0, s51, 0
  s_lshl_b32 s53, s61, 18
  buffer_load_dwordx4 v14, s[16:19], s53 offen lds
  buffer_load_dwordx4 v15, s[16:19], s53 offen offset:1024 lds
  s_add_u32 m0, s51, 0x2000
  s_nop 0
  buffer_load_dwordx4 v14, s[20:23], s53 offen lds
  buffer_load_dwordx4 v15, s[20:23], s53 offen offset:1024 lds
  s_add_u32 s61, s61, 1
  s_and_b32 s61, s61, 15
KV_G41:
  s_cmp_lg_u32 s3, 4
  s_cbranch_scc1 ONLYW26
  s_waitcnt vmcnt(0)
  v_cmp_ne_u32 vcc, 0x100, v81
  s_nop 1
  s_cbranch_vccz Z_OK22
  s_mov_b32 s38, 0
PL24:
  buffer_load_dword v81, v80, s[28:31], 0 offen sc1
  s_waitcnt vmcnt(0)
  v_cmp_ne_u32 vcc, 0x100, v81
  s_add_u32 s38, s38, 1
  s_cbranch_vccz PD25
  s_sleep 1
  s_cmp_lt_u32 s38, 0x30d40
  s_cbranch_scc1 PL24
PD25:
Z_OK22:
  s_mov_b64 vcc, 0
ONLYW26:
  v_mfma_f32_32x32x16_bf16 a[16:31], v[48:51], v[76:79], a[16:31]
  ds_read_b64_tr_b16 v[64:65], v22 offset:49152
  ds_read_b64_tr_b16 v[66:67], v22 offset:50176
  v_mfma_f32_32x32x16_bf16 a[32:47], v[72:75], v[52:55], a[32:47]
  ds_read_b64_tr_b16 v[68:69], v22 offset:57344
  v_mfma_f32_32x32x16_bf16 a[48:63], v[52:55], v[76:79], a[48:63]
  ds_read_b64_tr_b16 v[70:71], v22 offset:58368
  v_mfma_f32_32x32x16_bf16 a[64:79], v[72:75], v[56:59], a[64:79]
  ds_read_b128 v[36:39], v16 offset:34816
  ds_read_b128 v[40:43], v16 offset:36864
  v_mfma_f32_32x32x16_bf16 a[80:95], v[56:59], v[76:79], a[80:95]
  ds_read_b128 v[44:47], v16 offset:38912
  v_mfma_f32_32x32x16_bf16 a[96:111], v[72:75], v[60:63], a[96:111]
  v_mfma_f32_32x32x16_bf16 a[112:127], v[60:63], v[76:79], a[112:127]
  s_waitcnt lgkmcnt(5)
  v_mfma_f32_32x32x16_bf16 a[0:15], v[64:67], v[32:35], a[0:15]
  ds_read_b128 v[48:51], v19 offset:32768
  s_waitcnt lgkmcnt(4)
  v_mfma_f32_32x32x16_bf16 a[16:31], v[32:35], v[68:71], a[16:31]
  ds_read_b64_tr_b16 v[72:73], v22 offset:53248
  ds_read_b64_tr_b16 v[74:75], v22 offset:54272
  s_waitcnt lgkmcnt(5)
  v_mfma_f32_32x32x16_bf16 a[32:47], v[64:67], v[36:39], a[32:47]
  ds_read_b64_tr_b16 v[76:77], v22 offset:61440
  v_mfma_f32_32x32x16_bf16 a[48:63], v[36:39], v[68:71], a[48:63]
  ds_read_b64_tr_b16 v[78:79], v22 offset:62464
  s_waitcnt lgkmcnt(6)
  v_mfma_f32_32x32x16_bf16 a[64:79], v[64:67], v[40:43], a[64:79]
  ds_read_b128 v[52:55], v19 offset:34816
  ds_read_b128 v[56:59], v19 offset:36864
  v_mfma_f32_32x32x16_bf16 a[80:95], v[40:43], v[68:71], a[80:95]
  ds_read_b128 v[60:63], v19 offset:38912
  s_waitcnt lgkmcnt(8)
  v_mfma_f32_32x32x16_bf16 a[96:111], v[64:67], v[44:47], a[96:111]
  v_mfma_f32_32x32x16_bf16 a[112:127], v[44:47], v[68:71], a[112:127]
  s_cbranch_vccz KV_G42
  s_waitcnt vmcnt(24)
KV_G42:
  s_waitcnt lgkmcnt(0)
  s_barrier
  v_mfma_f32_32x32x16_bf16 a[0:15], v[72:75], v[48:51], a[0:15]
  ds_read_b128 v[32:35], v17
  v_mfma_f32_32x32x16_bf16 a[16:31], v[48:51], v[76:79], a[16:31]
  ds_read_b64_tr_b16 v[64:65], v23 offset:16384
  ds_read_b64_tr_b16 v[66:67], v23 offset:17408
  v_mfma_f32_32x32x16_bf16 a[32:47], v[72:75], v[52:55], a[32:47]
  ds_read_b64_tr_b16 v[68:69], v23 offset:24576
  s_cmp_eq_u32 s39, 0
  s_cbranch_scc1 ONLY28
  buffer_load_dword v83, v82, s[8:11], 0 offen sc1
ONLY28:
  v_mfma_f32_32x32x16_bf16 a[48:63], v[52:55], v[76:79], a[48:63]
  ds_read_b64_tr_b16 v[70:71], v23 offset:25600
  v_mfma_f32_32x32x16_bf16 a[64:79], v[72:75], v[56:59], a[64:79]
  ds_read_b128 v[36:39], v17 offset:2048
  ds_read_b128 v[40:43], v17 offset:4096
  v_mfma_f32_32x32x16_bf16 a[80:95], v[56:59], v[76:79], a[80:95]
  ds_read_b128 v[44:47], v17 offset:6144
  v_mfma_f32_32x32x16_bf16 a[96:111], v[72:75], v[60:63], a[96:111]
  v_mfma_f32_32x32x16_bf16 a[112:127], v[60:63], v[76:79], a[112:127]
  s_waitcnt lgkmcnt(5)
  v_mfma_f32_32x32x16_bf16 a[0:15], v[64:67], v[32:35], a[0:15]
  ds_read_b128 v[48:51], v20
  s_waitcnt lgkmcnt(4)
  v_mfma_f32_32x32x16_bf16 a[16:31], v[32:35], v[68:71], a[16:31]
  ds_read_b64_tr_b16 v[72:73], v23 offset:20480
  ds_read_b64_tr_b16 v[74:75], v23 offset:21504
  s_waitcnt lgkmcnt(5)
  v_mfma_f32_32x32x16_bf16 a[32:47], v[64:67], v[36:39], a[32:47]
  ds_read_b64_tr_b16 v[76:77], v23 offset:28672
  v_mfma_f32_32x32x16_bf16 a[48:63], v[36:39], v[68:71], a[48:63]
  ds_read_b64_tr_b16 v[78:79], v23 offset:29696
  s_waitcnt lgkmcnt(6)
  v_mfma_f32_32x32x16_bf16 a[64:79], v[64:67], v[40:43], a[64:79]
  ds_read_b128 v[52:55], v20 offset:2048
  ds_read_b128 v[56:59], v20 offset:4096
  v_mfma_f32_32x32x16_bf16 a[80:95], v[40:43], v[68:71], a[80:95]
  ds_read_b128 v[60:63], v20 offset:6144
  s_waitcnt lgkmcnt(8)
  v_mfma_f32_32x32x16_bf16 a[96:111], v[64:67], v[44:47], a[96:111]
  v_mfma_f32_32x32x16_bf16 a[112:127], v[44:47], v[68:71], a[112:127]
  s_cbranch_vccz KV_G43
  s_waitcnt vmcnt(16)
KV_G43:
  s_waitcnt lgkmcnt(0)
  s_barrier
  v_mfma_f32_32x32x16_bf16 a[0:15], v[72:75], v[48:51], a[0:15]
  ds_read_b128 v[32:35], v17 offset:32768
  v_mfma_f32_32x32x16_bf16 a[16:31], v[48:51], v[76:79], a[16:31]
  ds_read_b64_tr_b16 v[64:65], v23 offset:49152
  ds_read_b64_tr_b16 v[66:67], v23 offset:50176
  v_mfma_f32_32x32x16_bf16 a[32:47], v[72:75], v[52:55], a[32:47]
  ds_read_b64_tr_b16 v[68:69], v23 offset:57344
  v_mfma_f32_32x32x16_bf16 a[48:63], v[52:55], v[76:79], a[48:63]
  ds_read_b64_tr_b16 v[70:71], v23 offset:58368
  v_mfma_f32_32x32x16_bf16 a[64:79], v[72:75], v[56:59], a[64:79]
  ds_read_b128 v[36:39], v17 offset:34816
  ds_read_b128 v[40:43], v17 offset:36864
  v_mfma_f32_32x32x16_bf16 a[80:95], v[56:59], v[76:79], a[80:95]
  ds_read_b128 v[44:47], v17 offset:38912
  v_mfma_f32_32x32x16_bf16 a[96:111], v[72:75], v[60:63], a[96:111]
  v_mfma_f32_32x32x16_bf16 a[112:127], v[60:63], v[76:79], a[112:127]
  s_waitcnt lgkmcnt(5)
  v_mfma_f32_32x32x16_bf16 a[0:15], v[64:67], v[32:35], a[0:15]
  ds_read_b128 v[48:51], v20 offset:32768
  s_waitcnt lgkmcnt(4)
  v_mfma_f32_32x32x16_bf16 a[16:31], v[32:35], v[68:71], a[16:31]
  ds_read_b64_tr_b16 v[72:73], v23 offset:53248
  ds_read_b64_tr_b16 v[74:75], v23 offset:54272
  s_waitcnt lgkmcnt(5)
  v_mfma_f32_32x32x16_bf16 a[32:47], v[64:67], v[36:39], a[32:47]
  ds_read_b64_tr_b16 v[76:77], v23 offset:61440
  v_mfma_f32_32x32x16_bf16 a[48:63], v[36:39], v[68:71], a[48:63]
  ds_read_b64_tr_b16 v[78:79], v23 offset:62464
  s_waitcnt lgkmcnt(6)
  v_mfma_f32_32x32x16_bf16 a[64:79], v[64:67], v[40:43], a[64:79]
  ds_read_b128 v[52:55], v20 offset:34816
  ds_read_b128 v[56:59], v20 offset:36864
  v_mfma_f32_32x32x16_bf16 a[80:95], v[40:43], v[68:71], a[80:95]
  ds_read_b128 v[60:63], v20 offset:38912
  s_waitcnt lgkmcnt(8)
  v_mfma_f32_32x32x16_bf16 a[96:111], v[64:67], v[44:47], a[96:111]
  v_mfma_f32_32x32x16_bf16 a[112:127], v[44:47], v[68:71], a[112:127]
  s_cbranch_vccz KV_G44
  s_waitcnt vmcnt(8)
KV_G44:
  s_waitcnt lgkmcnt(0)
  s_barrier
  v_mfma_f32_32x32x16_bf16 a[0:15], v[72:75], v[48:51], a[0:15]
  ds_read_b128 v[32:35], v18
  s_cmp_eq_u32 s39, 0
  s_cbranch_scc1 ONLY31
  s_waitcnt vmcnt(0)
  v_cmp_ne_u32 vcc, 1, v83
  s_nop 1
  s_cbranch_vccz B_OK27
  s_mov_b32 s38, 0
PL29:
  buffer_load_dword v83, v82, s[8:11], 0 offen sc1
  s_waitcnt vmcnt(0)
  v_cmp_ne_u32 vcc, 1, v83
  s_add_u32 s38, s38, 1
  s_cbranch_vccz PD30
  s_sleep 1
  s_cmp_lt_u32 s38, 0x30d40
  s_cbranch_scc1 PL29
PD30:
B_OK27:
  s_mov_b64 vcc, 0
ONLY31:
  v_mfma_f32_32x32x16_bf16 a[16:31], v[48:51], v[76:79], a[16:31]
  ds_read_b64_tr_b16 v[64:65], v24 offset:16384
  ds_read_b64_tr_b16 v[66:67], v24 offset:17408
  v_mfma_f32_32x32x16_bf16 a[32:47], v[72:75], v[52:55], a[32:47]
  ds_read_b64_tr_b16 v[68:69], v24 offset:24576
  v_mfma_f32_32x32x16_bf16 a[48:63], v[52:55], v[76:79], a[48:63]
  ds_read_b64_tr_b16 v[70:71], v24 offset:25600
  v_mfma_f32_32x32x16_bf16 a[64:79], v[72:75], v[56:59], a[64:79]
  ds_read_b128 v[36:39], v18 offset:2048
  ds_read_b128 v[40:43], v18 offset:4096
  v_mfma_f32_32x32x16_bf16 a[80:95], v[56:59], v[76:79], a[80:95]
  ds_read_b128 v[44:47], v18 offset:6144
  s_mov_b32 s12, s64
  v_mfma_f32_32x32x16_bf16 a[96:111], v[72:75], v[60:63], a[96:111]
  s_mov_b32 s13, s65
  s_mov_b32 s14, 0x240000
  s_mov_b32 s15, 0x20000
  v_mfma_f32_32x32x16_bf16 a[112:127], v[60:63], v[76:79], a[112:127]
  s_mov_b32 s16, s68
  s_mov_b32 s17, s69
  s_mov_b32 s18, 0x480000
  s_waitcnt lgkmcnt(5)
  v_mfma_f32_32x32x16_bf16 a[0:15], v[64:67], v[32:35], a[0:15]
  ds_read_b128 v[48:51], v21
  s_mov_b32 s19, 0x20000
  s_cmp_eq_u32 s39, 0
  s_cbranch_scc1 ONLY32
  s_add_u32 m0, s42, 0x10000
  s_mov_b32 s52, 0
  buffer_load_dwordx4 v123, s[12:15], s52 offen lds
  buffer_load_dwordx4 v124, s[12:15], s52 offen offset:1024 lds
  buffer_load_dwordx4 v125, s[12:15], s52 offen offset:2048 lds
  buffer_load_dwordx4 v126, s[12:15], s52 offen offset:3072 lds
  s_add_u32 m0, s42, 0x11000
  s_mov_b32 s52, 0x9000
  buffer_load_dwordx4 v123, s[12:15], s52 offen lds
  buffer_load_dwordx4 v124, s[12:15], s52 offen offset:1024 lds
  buffer_load_dwordx4 v125, s[12:15], s52 offen offset:2048 lds
  buffer_load_dwordx4 v126, s[12:15], s52 offen offset:3072 lds
  s_add_u32 m0, s43, 0x18000
  s_add_u32 s53, s44, 0
  buffer_load_dwordx4 v14, s[16:19], s53 offen lds
  buffer_load_dwordx4 v15, s[16:19], s53 offen offset:1024 lds
  s_add_u32 m0, s43, 0x18800
  s_add_u32 s53, s44, 0x10000
  buffer_load_dwordx4 v14, s[16:19], s53 offen lds
  buffer_load_dwordx4 v15, s[16:19], s53 offen offset:1024 lds
ONLY32:
  s_waitcnt lgkmcnt(4)
  v_mfma_f32_32x32x16_bf16 a[16:31], v[32:35], v[68:71], a[16:31]
  ds_read_b64_tr_b16 v[72:73], v24 offset:20480
  ds_read_b64_tr_b16 v[74:75], v24 offset:21504
  s_waitcnt lgkmcnt(5)
  v_mfma_f32_32x32x16_bf16 a[32:47], v[64:67], v[36:39], a[32:47]
  ds_read_b64_tr_b16 v[76:77], v24 offset:28672
  v_mfma_f32_32x32x16_bf16 a[48:63], v[36:39], v[68:71], a[48:63]
  ds_read_b64_tr_b16 v[78:79], v24 offset:29696
  s_waitcnt lgkmcnt(6)
  v_mfma_f32_32x32x16_bf16 a[64:79], v[64:67], v[40:43], a[64:79]
  ds_read_b128 v[52:55], v21 offset:2048
  ds_read_b128 v[56:59], v21 offset:4096
  v_mfma_f32_32x32x16_bf16 a[80:95], v[40:43], v[68:71], a[80:95]
  ds_read_b128 v[60:63], v21 offset:6144
  s_waitcnt lgkmcnt(8)
  v_mfma_f32_32x32x16_bf16 a[96:111], v[64:67], v[44:47], a[96:111]
  v_mfma_f32_32x32x16_bf16 a[112:127], v[44:47], v[68:71], a[112:127]
  s_cbranch_vccz KV_G45
  s_waitcnt vmcnt(0)
KV_G45:
  s_waitcnt lgkmcnt(0)
  s_barrier
  v_mfma_f32_32x32x16_bf16 a[0:15], v[72:75], v[48:51], a[0:15]
  ds_read_b128 v[32:35], v16
  s_cmp_eq_u32 s39, 0
  s_cbranch_scc1 ONLY33
  s_add_u32 m0, s42, 0x1c000
  s_mov_b32 s52, 0x80
  buffer_load_dwordx4 v123, s[12:15], s52 offen lds
  buffer_load_dwordx4 v124, s[12:15], s52 offen offset:1024 lds
  buffer_load_dwordx4 v125, s[12:15], s52 offen offset:2048 lds
  buffer_load_dwordx4 v126, s[12:15], s52 offen offset:3072 lds
  s_add_u32 m0, s42, 0x1d000
  s_mov_b32 s52, 0x9080
  buffer_load_dwordx4 v123, s[12:15], s52 offen lds
  buffer_load_dwordx4 v124, s[12:15], s52 offen offset:1024 lds
  buffer_load_dwordx4 v125, s[12:15], s52 offen offset:2048 lds
  buffer_load_dwordx4 v126, s[12:15], s52 offen offset:3072 lds
  s_add_u32 m0, s43, 0x24000
  s_add_u32 s53, s44, 0x80000
  buffer_load_dwordx4 v14, s[16:19], s53 offen lds
  buffer_load_dwordx4 v15, s[16:19], s53 offen offset:1024 lds
  s_add_u32 m0, s43, 0x24800
  s_add_u32 s53, s44, 0x90000
  buffer_load_dwordx4 v14, s[16:19], s53 offen lds
  buffer_load_dwordx4 v15, s[16:19], s53 offen offset:1024 lds
ONLY33:
  v_mfma_f32_32x32x16_bf16 a[16:31], v[48:51], v[76:79], a[16:31]
  ds_read_b64_tr_b16 v[64:65], v22 offset:16384
  ds_read_b64_tr_b16 v[66:67], v22 offset:17408
  v_mfma_f32_32x32x16_bf16 a[32:47], v[72:75], v[52:55], a[32:47]
  ds_read_b64_tr_b16 v[68:69], v22 offset:24576
  v_mfma_f32_32x32x16_bf16 a[48:63], v[52:55], v[76:79], a[48:63]
  ds_read_b64_tr_b16 v[70:71], v22 offset:25600
  v_mfma_f32_32x32x16_bf16 a[64:79], v[72:75], v[56:59], a[64:79]
  ds_read_b128 v[36:39], v16 offset:2048
  ds_read_b128 v[40:43], v16 offset:4096
  v_mfma_f32_32x32x16_bf16 a[80:95], v[56:59], v[76:79], a[80:95]
  ds_read_b128 v[44:47], v16 offset:6144
  v_mfma_f32_32x32x16_bf16 a[96:111], v[72:75], v[60:63], a[96:111]
  v_mfma_f32_32x32x16_bf16 a[112:127], v[60:63], v[76:79], a[112:127]
  s_waitcnt lgkmcnt(5)
  v_mfma_f32_32x32x16_bf16 a[0:15], v[64:67], v[32:35], a[0:15]
  ds_read_b128 v[48:51], v19
  s_waitcnt lgkmcnt(4)
  v_mfma_f32_32x32x16_bf16 a[16:31], v[32:35], v[68:71], a[16:31]
  ds_read_b64_tr_b16 v[72:73], v22 offset:20480
  ds_read_b64_tr_b16 v[74:75], v22 offset:21504
  s_waitcnt lgkmcnt(5)
  v_mfma_f32_32x32x16_bf16 a[32:47], v[64:67], v[36:39], a[32:47]
  ds_read_b64_tr_b16 v[76:77], v22 offset:28672
  v_mfma_f32_32x32x16_bf16 a[48:63], v[36:39], v[68:71], a[48:63]
  ds_read_b64_tr_b16 v[78:79], v22 offset:29696
  s_waitcnt lgkmcnt(6)
  v_mfma_f32_32x32x16_bf16 a[64:79], v[64:67], v[40:43], a[64:79]
  ds_read_b128 v[52:55], v19 offset:2048
  ds_read_b128 v[56:59], v19 offset:4096
  v_mfma_f32_32x32x16_bf16 a[80:95], v[40:43], v[68:71], a[80:95]
  ds_read_b128 v[60:63], v19 offset:6144
  s_waitcnt lgkmcnt(8)
  v_mfma_f32_32x32x16_bf16 a[96:111], v[64:67], v[44:47], a[96:111]
  v_mfma_f32_32x32x16_bf16 a[112:127], v[44:47], v[68:71], a[112:127]
  s_waitcnt lgkmcnt(5)
  v_mfma_f32_32x32x16_bf16 a[0:15], v[72:75], v[48:51], a[0:15]
  s_waitcnt lgkmcnt(3)
  v_mfma_f32_32x32x16_bf16 a[16:31], v[48:51], v[76:79], a[16:31]
  s_waitcnt lgkmcnt(2)
  v_mfma_f32_32x32x16_bf16 a[32:47], v[72:75], v[52:55], a[32:47]
  v_mfma_f32_32x32x16_bf16 a[48:63], v[52:55], v[76:79], a[48:63]
  s_waitcnt lgkmcnt(1)
  v_mfma_f32_32x32x16_bf16 a[64:79], v[72:75], v[56:59], a[64:79]
  v_mfma_f32_32x32x16_bf16 a[80:95], v[56:59], v[76:79], a[80:95]
  s_waitcnt lgkmcnt(0)
  v_mfma_f32_32x32x16_bf16 a[96:111], v[72:75], v[60:63], a[96:111]
  v_mfma_f32_32x32x16_bf16 a[112:127], v[60:63], v[76:79], a[112:127]
  s_lshl_b32 s6, s34, 19
  s_lshl_b32 s7, s35, 16
  s_add_u32 s6, s6, s7
  s_lshl_b32 s7, s54, 15
  s_add_u32 s6, s6, s7
  v_add_u32 v10, s6, v2
  v_add_u32 v11, 0x2000, v10
  v_add_u32 v12, 0x4000, v10
  v_add_u32 v13, 0x6000, v10
  s_lshl_b32 s58, s55, 11
  s_lshl_b32 s59, s55, 10
  s_add_u32 s58, s58, 0
  s_add_u32 s59, s59, 0x1000000
  s_add_u32 s60, s59, 0x1000
  s_cmp_eq_u32 s39, 0
  s_cbranch_scc1 ONLY34
  s_waitcnt vmcnt(24)
ONLY34:
  v_accvgpr_read_b32 v112, a96
  v_accvgpr_read_b32 v113, a97
  v_accvgpr_read_b32 v114, a98
  v_accvgpr_read_b32 v115, a99
  v_accvgpr_read_b32 v116, a100
  v_accvgpr_read_b32 v117, a101
  v_accvgpr_read_b32 v118, a102
  v_accvgpr_read_b32 v119, a103
  v_cvt_pk_bf16_f32 v28, v112, v113
  v_cvt_pk_bf16_f32 v29, v114, v115
  v_cvt_pk_bf16_f32 v30, v116, v117
  v_cvt_pk_bf16_f32 v31, v118, v119
  buffer_store_dwordx4 v[28:31], v13, s[8:11], s58 offen sc1
  v_accvgpr_read_b32 v112, a104
  v_accvgpr_read_b32 v113, a105
  v_accvgpr_read_b32 v114, a106
  v_accvgpr_read_b32 v115, a107
  v_accvgpr_read_b32 v116, a108
  v_accvgpr_read_b32 v117, a109
  v_accvgpr_read_b32 v118, a110
  v_accvgpr_read_b32 v119, a111
  v_cvt_pk_bf16_f32 v28, v112, v113
  v_cvt_pk_bf16_f32 v29, v114, v115
  v_cvt_pk_bf16_f32 v30, v116, v117
  v_cvt_pk_bf16_f32 v31, v118, v119
  buffer_store_dwordx4 v[28:31], v13, s[8:11], s58 offen offset:1024 sc1
  s_lshr_b32 s90, s3, 1
  s_lshl_b32 s90, s90, 13
  s_add_u32 s90, s90, 0x10000
  v_and_b32 v5, 31, v1
  v_lshlrev_b32 v6, 7, v5
  v_add_u32 v6, s90, v6
  v_lshrrev_b32 v7, 5, v1
  v_bfe_u32 v8, v1, 1, 3
  v_xor_b32 v7, v7, v8
  v_lshl_add_u32 v16, v7, 4, v6
  v_xor_b32 v17, 32, v16
  v_xor_b32 v18, 64, v16
  v_xor_b32 v19, 0x60, v16
  v_lshrrev_b32 v5, 5, v1
  v_bfe_u32 v6, v1, 2, 2
  v_lshl_add_u32 v5, v5, 3, v6
  v_mul_u32_u24 v5, 0x100, v5
  v_bfe_u32 v7, v1, 4, 1
  v_lshl_add_u32 v5, v7, 5, v5
  v_and_b32 v7, 3, v1
  v_lshl_add_u32 v8, v7, 3, v5
  s_and_b32 s6, s3, 1
  s_lshl_b32 s6, s6, 1
  v_xor_b32 v6, s6, v6
  v_lshl_add_u32 v20, v6, 6, v8
  v_add_u32 v20, 0x18000, v20
  v_xor_b32 v21, 64, v20
  s_and_b32 s6, s2, 31
  v_and_b32 v120, 7, v1
  v_lshlrev_b32 v120, 5, v120
  v_add_u32 v120, s6, v120
  v_lshlrev_b32 v120, 8, v120
  v_add_u32 v120, 0x7c00004, v120
  s_lshr_b32 s46, s34, 2
  s_and_b32 s47, s34, 3
  s_add_u32 s23, s47, 1
  s_and_b32 s23, s23, 3
  s_lshl_b32 s7, s46, 2
  s_add_u32 s23, s23, s7
  s_lshl_b32 s7, s47, 5
  s_add_u32 s23, s23, s7
  s_lshl_b32 s23, s23, 15
  s_add_u32 s23, s23, 0x3000000
  s_add_u32 s24, s47, 2
  s_and_b32 s24, s24, 3
  s_lshl_b32 s7, s46, 2
  s_add_u32 s24, s24, s7
  s_lshl_b32 s7, s47, 5
  s_add_u32 s24, s24, s7
  s_lshl_b32 s24, s24, 15
  s_add_u32 s24, s24, 0x3000000
  s_add_u32 s25, s47, 3
  s_and_b32 s25, s25, 3
  s_lshl_b32 s7, s46, 2
  s_add_u32 s25, s25, s7
  s_lshl_b32 s7, s47, 5
  s_add_u32 s25, s25, s7
  s_lshl_b32 s25, s25, 15
  s_add_u32 s25, s25, 0x3000000
  s_add_u32 s22, s47, s91
  s_and_b32 s22, s22, 3
  s_lshl_b32 s7, s46, 2
  s_add_u32 s22, s22, s7
  s_lshl_b32 s7, s47, 5
  s_add_u32 s22, s22, s7
  s_lshl_b32 s22, s22, 15
  s_add_u32 s22, s22, 0x3000000
  s_sub_u32 s22, s22, 0x3000000
  s_lshr_b32 s22, s22, 3
  s_add_u32 s22, s22, 0x3400000
  s_sub_u32 s22, s22, s50
  s_lshr_b32 s21, s95, 1
  s_lshl_b32 s26, s34, 19
  s_cmp_lg_u32 s39, 0
  s_cselect_b64 vcc, -1, 0
  s_cbranch_vccz Q_G46
  s_waitcnt vmcnt(14)
Q_G46:
  s_waitcnt lgkmcnt(0)
  s_barrier
  ds_read_b128 v[96:99], v16
  ds_read_b64_tr_b16 a[96:97], v20
  ds_read_b64_tr_b16 a[98:99], v20 offset:1024
  ds_read_b64_tr_b16 a[100:101], v21
  ds_read_b64_tr_b16 a[102:103], v21 offset:1024
  ds_read_b128 v[100:103], v16 offset:4096
  s_cbranch_vccz Q_G47
  s_add_u32 m0, s42, 0x4000
  s_mov_b32 s52, 0x100
  buffer_load_dwordx4 v123, s[12:15], s52 offen lds
  buffer_load_dwordx4 v124, s[12:15], s52 offen offset:1024 lds
  buffer_load_dwordx4 v125, s[12:15], s52 offen offset:2048 lds
  buffer_load_dwordx4 v126, s[12:15], s52 offen offset:3072 lds
  s_add_u32 m0, s42, 0x5000
  s_mov_b32 s52, 0x9100
  buffer_load_dwordx4 v123, s[12:15], s52 offen lds
  buffer_load_dwordx4 v124, s[12:15], s52 offen offset:1024 lds
  buffer_load_dwordx4 v125, s[12:15], s52 offen offset:2048 lds
  buffer_load_dwordx4 v126, s[12:15], s52 offen offset:3072 lds
  s_add_u32 m0, s43, 0xc000
  s_add_u32 s53, s44, 0x100000
  buffer_load_dwordx4 v14, s[16:19], s53 offen lds
  buffer_load_dwordx4 v15, s[16:19], s53 offen offset:1024 lds
  s_add_u32 m0, s43, 0xc800
  s_add_u32 s53, s44, 0x110000
  buffer_load_dwordx4 v14, s[16:19], s53 offen lds
  buffer_load_dwordx4 v15, s[16:19], s53 offen offset:1024 lds
Q_G47:
  s_waitcnt lgkmcnt(3)
  v_mfma_f32_32x32x16_bf16 v[32:47], a[96:99], v[96:99], 0
  ds_read_b128 v[104:107], v17
  ds_read_b64_tr_b16 a[104:105], v20 offset:4096
  v_accvgpr_read_b32 v112, a0
  v_accvgpr_read_b32 v113, a1
  v_accvgpr_read_b32 v114, a2
  v_accvgpr_read_b32 v115, a3
  s_waitcnt lgkmcnt(3)
  v_mfma_f32_32x32x16_bf16 v[48:63], a[100:103], v[96:99], 0
  ds_read_b64_tr_b16 a[106:107], v20 offset:5120
  ds_read_b64_tr_b16 a[108:109], v21 offset:4096
  v_accvgpr_read_b32 v116, a4
  v_accvgpr_read_b32 v117, a5
  v_accvgpr_read_b32 v118, a6
  v_accvgpr_read_b32 v119, a7
  v_cvt_pk_bf16_f32 v28, v112, v113
  s_waitcnt lgkmcnt(4)
  v_mfma_f32_32x32x16_bf16 v[64:79], a[96:99], v[100:103], 0
  ds_read_b64_tr_b16 a[110:111], v21 offset:5120
  ds_read_b128 v[108:111], v17 offset:4096
  v_cvt_pk_bf16_f32 v29, v114, v115
  v_cvt_pk_bf16_f32 v30, v116, v117
  v_cvt_pk_bf16_f32 v31, v118, v119
  buffer_store_dwordx4 v[28:31], v10, s[8:11], s58 offen sc1
  v_mfma_f32_32x32x16_bf16 v[80:95], a[100:103], v[100:103], 0
  v_accvgpr_read_b32 v112, a8
  v_accvgpr_read_b32 v113, a9
  v_accvgpr_read_b32 v114, a10
  v_accvgpr_read_b32 v115, a11
  s_waitcnt lgkmcnt(3)
  v_mfma_f32_32x32x16_bf16 v[32:47], a[104:107], v[104:107], v[32:47]
  ds_read_b128 v[96:99], v18
  ds_read_b64_tr_b16 a[96:97], v20 offset:8192
  v_accvgpr_read_b32 v116, a12
  v_accvgpr_read_b32 v117, a13
  v_accvgpr_read_b32 v118, a14
  v_accvgpr_read_b32 v119, a15
  v_cvt_pk_bf16_f32 v28, v112, v113
  s_waitcnt lgkmcnt(3)
  v_mfma_f32_32x32x16_bf16 v[48:63], a[108:111], v[104:107], v[48:63]
  ds_read_b64_tr_b16 a[98:99], v20 offset:9216
  ds_read_b64_tr_b16 a[100:101], v21 offset:8192
  v_cvt_pk_bf16_f32 v29, v114, v115
  v_cvt_pk_bf16_f32 v30, v116, v117
  v_cvt_pk_bf16_f32 v31, v118, v119
  buffer_store_dwordx4 v[28:31], v10, s[8:11], s58 offen offset:1024 sc1
  s_waitcnt lgkmcnt(4)
  v_mfma_f32_32x32x16_bf16 v[64:79], a[104:107], v[108:111], v[64:79]
  ds_read_b64_tr_b16 a[102:103], v21 offset:9216
  ds_read_b128 v[100:103], v18 offset:4096
  v_accvgpr_read_b32 v112, a16
  v_accvgpr_read_b32 v113, a17
  v_accvgpr_read_b32 v114, a18
  v_accvgpr_read_b32 v115, a19
  v_mfma_f32_32x32x16_bf16 v[80:95], a[108:111], v[108:111], v[80:95]
  v_accvgpr_read_b32 v116, a20
  v_accvgpr_read_b32 v117, a21
  v_accvgpr_read_b32 v118, a22
  v_accvgpr_read_b32 v119, a23
  v_cvt_pk_bf16_f32 v28, v112, v113
  s_waitcnt lgkmcnt(3)
  v_mfma_f32_32x32x16_bf16 v[32:47], a[96:99], v[96:99], v[32:47]
  ds_read_b128 v[104:107], v19
  ds_read_b64_tr_b16 a[104:105], v20 offset:12288
  v_cvt_pk_bf16_f32 v29, v114, v115
  v_cvt_pk_bf16_f32 v30, v116, v117
  v_cvt_pk_bf16_f32 v31, v118, v119
  buffer_store_dwordx4 v[28:31], v10, s[8:11], s59 offen sc1
  s_waitcnt lgkmcnt(3)
  v_mfma_f32_32x32x16_bf16 v[48:63], a[100:103], v[96:99], v[48:63]
  ds_read_b64_tr_b16 a[106:107], v20 offset:13312
  ds_read_b64_tr_b16 a[108:109], v21 offset:12288
  v_accvgpr_read_b32 v112, a24
  v_accvgpr_read_b32 v113, a25
  v_accvgpr_read_b32 v114, a26
  v_accvgpr_read_b32 v115, a27
  s_waitcnt lgkmcnt(4)
  v_mfma_f32_32x32x16_bf16 v[64:79], a[96:99], v[100:103], v[64:79]
  ds_read_b64_tr_b16 a[110:111], v21 offset:13312
  ds_read_b128 v[108:111], v19 offset:4096
  v_accvgpr_read_b32 v116, a28
  v_accvgpr_read_b32 v117, a29
  v_accvgpr_read_b32 v118, a30
  v_accvgpr_read_b32 v119, a31
  v_cvt_pk_bf16_f32 v28, v112, v113
  v_mfma_f32_32x32x16_bf16 v[80:95], a[100:103], v[100:103], v[80:95]
  v_cvt_pk_bf16_f32 v29, v114, v115
  v_cvt_pk_bf16_f32 v30, v116, v117
  v_cvt_pk_bf16_f32 v31, v118, v119
  buffer_store_dwordx4 v[28:31], v10, s[8:11], s60 offen sc1
  s_cbranch_vccz Q_G48
  s_waitcnt vmcnt(12)
Q_G48:
  s_waitcnt lgkmcnt(0)
  s_barrier
  v_mfma_f32_32x32x16_bf16 v[32:47], a[104:107], v[104:107], v[32:47]
  v_add_u32 v16, 0xc000, v16
  v_add_u32 v17, 0xc000, v17
  v_add_u32 v18, 0xc000, v18
  v_add_u32 v19, 0xc000, v19
  s_cbranch_vccz Q_G49
  s_add_u32 m0, s42, 0x10000
  s_mov_b32 s52, 0x180
  buffer_load_dwordx4 v123, s[12:15], s52 offen lds
  buffer_load_dwordx4 v124, s[12:15], s52 offen offset:1024 lds
  buffer_load_dwordx4 v125, s[12:15], s52 offen offset:2048 lds
  buffer_load_dwordx4 v126, s[12:15], s52 offen offset:3072 lds
  s_add_u32 m0, s42, 0x11000
  s_mov_b32 s52, 0x9180
  buffer_load_dwordx4 v123, s[12:15], s52 offen lds
  buffer_load_dwordx4 v124, s[12:15], s52 offen offset:1024 lds
  buffer_load_dwordx4 v125, s[12:15], s52 offen offset:2048 lds
  buffer_load_dwordx4 v126, s[12:15], s52 offen offset:3072 lds
  s_add_u32 m0, s43, 0x18000
  s_add_u32 s53, s44, 0x180000
  buffer_load_dwordx4 v14, s[16:19], s53 offen lds
  buffer_load_dwordx4 v15, s[16:19], s53 offen offset:1024 lds
  s_add_u32 m0, s43, 0x18800
  s_add_u32 s53, s44, 0x190000
  buffer_load_dwordx4 v14, s[16:19], s53 offen lds
  buffer_load_dwordx4 v15, s[16:19], s53 offen offset:1024 lds
Q_G49:
  v_accvgpr_read_b32 v112, a32
  v_accvgpr_read_b32 v113, a33
  v_accvgpr_read_b32 v114, a34
  v_mfma_f32_32x32x16_bf16 v[48:63], a[108:111], v[104:107], v[48:63]
  v_add_u32 v20, 0xc000, v20
  v_add_u32 v21, 0xc000, v21
  ds_read_b128 v[96:99], v16
  ds_read_b64_tr_b16 a[96:97], v20
  v_accvgpr_read_b32 v115, a35
  v_accvgpr_read_b32 v116, a36
  v_accvgpr_read_b32 v117, a37
  v_mfma_f32_32x32x16_bf16 v[64:79], a[104:107], v[108:111], v[64:79]
  ds_read_b64_tr_b16 a[98:99], v20 offset:1024
  ds_read_b64_tr_b16 a[100:101], v21
  ds_read_b64_tr_b16 a[102:103], v21 offset:1024
  ds_read_b128 v[100:103], v16 offset:4096
  v_accvgpr_read_b32 v118, a38
  v_accvgpr_read_b32 v119, a39
  v_cvt_pk_bf16_f32 v28, v112, v113
  v_cvt_pk_bf16_f32 v29, v114, v115
  v_mfma_f32_32x32x16_bf16 v[80:95], a[108:111], v[108:111], v[80:95]
  v_cvt_pk_bf16_f32 v30, v116, v117
  v_cvt_pk_bf16_f32 v31, v118, v119
  buffer_store_dwordx4 v[28:31], v11, s[8:11], s58 offen sc1
  s_waitcnt lgkmcnt(3)
  v_mfma_f32_32x32x16_bf16 v[32:47], a[96:99], v[96:99], v[32:47]
  ds_read_b128 v[104:107], v17
  ds_read_b64_tr_b16 a[104:105], v20 offset:4096
  v_accvgpr_read_b32 v112, a40
  v_accvgpr_read_b32 v113, a41
  v_accvgpr_read_b32 v114, a42
  s_waitcnt lgkmcnt(3)
  v_mfma_f32_32x32x16_bf16 v[48:63], a[100:103], v[96:99], v[48:63]
  ds_read_b64_tr_b16 a[106:107], v20 offset:5120
  ds_read_b64_tr_b16 a[108:109], v21 offset:4096
  v_accvgpr_read_b32 v115, a43
  v_accvgpr_read_b32 v116, a44
  v_accvgpr_read_b32 v117, a45
  s_waitcnt lgkmcnt(4)
  v_mfma_f32_32x32x16_bf16 v[64:79], a[96:99], v[100:103], v[64:79]
  ds_read_b64_tr_b16 a[110:111], v21 offset:5120
  ds_read_b128 v[108:111], v17 offset:4096
  v_accvgpr_read_b32 v118, a46
  v_accvgpr_read_b32 v119, a47
  v_cvt_pk_bf16_f32 v28, v112, v113
  v_cvt_pk_bf16_f32 v29, v114, v115
  v_mfma_f32_32x32x16_bf16 v[80:95], a[100:103], v[100:103], v[80:95]
  v_cvt_pk_bf16_f32 v30, v116, v117
  v_cvt_pk_bf16_f32 v31, v118, v119
  buffer_store_dwordx4 v[28:31], v11, s[8:11], s58 offen offset:1024 sc1
  s_waitcnt lgkmcnt(3)
  v_mfma_f32_32x32x16_bf16 v[32:47], a[104:107], v[104:107], v[32:47]
  ds_read_b128 v[96:99], v18
  ds_read_b64_tr_b16 a[96:97], v20 offset:8192
  v_accvgpr_read_b32 v112, a48
  v_accvgpr_read_b32 v113, a49
  v_accvgpr_read_b32 v114, a50
  s_waitcnt lgkmcnt(3)
  v_mfma_f32_32x32x16_bf16 v[48:63], a[108:111], v[104:107], v[48:63]
  ds_read_b64_tr_b16 a[98:99], v20 offset:9216
  ds_read_b64_tr_b16 a[100:101], v21 offset:8192
  v_accvgpr_read_b32 v115, a51
  v_accvgpr_read_b32 v116, a52
  v_accvgpr_read_b32 v117, a53
  s_waitcnt lgkmcnt(4)
  v_mfma_f32_32x32x16_bf16 v[64:79], a[104:107], v[108:111], v[64:79]
  ds_read_b64_tr_b16 a[102:103], v21 offset:9216
  ds_read_b128 v[100:103], v18 offset:4096
  v_accvgpr_read_b32 v118, a54
  v_accvgpr_read_b32 v119, a55
  v_cvt_pk_bf16_f32 v28, v112, v113
  v_cvt_pk_bf16_f32 v29, v114, v115
  v_mfma_f32_32x32x16_bf16 v[80:95], a[108:111], v[108:111], v[80:95]
  v_cvt_pk_bf16_f32 v30, v116, v117
  v_cvt_pk_bf16_f32 v31, v118, v119
  buffer_store_dwordx4 v[28:31], v11, s[8:11], s59 offen sc1
  s_waitcnt lgkmcnt(3)
  v_mfma_f32_32x32x16_bf16 v[32:47], a[96:99], v[96:99], v[32:47]
  ds_read_b128 v[104:107], v19
  ds_read_b64_tr_b16 a[104:105], v20 offset:12288
  v_accvgpr_read_b32 v112, a56
  v_accvgpr_read_b32 v113, a57
  v_accvgpr_read_b32 v114, a58
  s_waitcnt lgkmcnt(3)
  v_mfma_f32_32x32x16_bf16 v[48:63], a[100:103], v[96:99], v[48:63]
  ds_read_b64_tr_b16 a[106:107], v20 offset:13312
  ds_read_b64_tr_b16 a[108:109], v21 offset:12288
  v_accvgpr_read_b32 v115, a59
  v_accvgpr_read_b32 v116, a60
  v_accvgpr_read_b32 v117, a61
  s_waitcnt lgkmcnt(4)
  v_mfma_f32_32x32x16_bf16 v[64:79], a[96:99], v[100:103], v[64:79]
  ds_read_b64_tr_b16 a[110:111], v21 offset:13312
  ds_read_b128 v[108:111], v19 offset:4096
  v_accvgpr_read_b32 v118, a62
  v_accvgpr_read_b32 v119, a63
  v_cvt_pk_bf16_f32 v28, v112, v113
  v_cvt_pk_bf16_f32 v29, v114, v115
  v_mfma_f32_32x32x16_bf16 v[80:95], a[100:103], v[100:103], v[80:95]
  v_cvt_pk_bf16_f32 v30, v116, v117
  v_cvt_pk_bf16_f32 v31, v118, v119
  buffer_store_dwordx4 v[28:31], v11, s[8:11], s60 offen sc1
  s_cbranch_vccz Q_G50
  s_waitcnt vmcnt(12)
Q_G50:
  s_waitcnt lgkmcnt(0)
  s_barrier
  v_mfma_f32_32x32x16_bf16 v[32:47], a[104:107], v[104:107], v[32:47]
  v_add_u32 v16, 0xfffe8000, v16
  v_add_u32 v17, 0xfffe8000, v17
  v_add_u32 v18, 0xfffe8000, v18
  v_add_u32 v19, 0xfffe8000, v19
  s_cbranch_vccz Q_G51
  s_add_u32 m0, s42, 0x1c000
  s_mov_b32 s52, 0x200
  buffer_load_dwordx4 v123, s[12:15], s52 offen lds
  buffer_load_dwordx4 v124, s[12:15], s52 offen offset:1024 lds
  buffer_load_dwordx4 v125, s[12:15], s52 offen offset:2048 lds
  buffer_load_dwordx4 v126, s[12:15], s52 offen offset:3072 lds
  s_add_u32 m0, s42, 0x1d000
  s_mov_b32 s52, 0x9200
  buffer_load_dwordx4 v123, s[12:15], s52 offen lds
  buffer_load_dwordx4 v124, s[12:15], s52 offen offset:1024 lds
  buffer_load_dwordx4 v125, s[12:15], s52 offen offset:2048 lds
  buffer_load_dwordx4 v126, s[12:15], s52 offen offset:3072 lds
  s_add_u32 m0, s43, 0x24000
  s_add_u32 s53, s44, 0x200000
  buffer_load_dwordx4 v14, s[16:19], s53 offen lds
  buffer_load_dwordx4 v15, s[16:19], s53 offen offset:1024 lds
  s_add_u32 m0, s43, 0x24800
  s_add_u32 s53, s44, 0x210000
  buffer_load_dwordx4 v14, s[16:19], s53 offen lds
  buffer_load_dwordx4 v15, s[16:19], s53 offen offset:1024 lds
Q_G51:
  v_accvgpr_read_b32 v112, a64
  v_accvgpr_read_b32 v113, a65
  v_accvgpr_read_b32 v114, a66
  v_mfma_f32_32x32x16_bf16 v[48:63], a[108:111], v[104:107], v[48:63]
  v_add_u32 v20, 0xfffe8000, v20
  v_add_u32 v21, 0xfffe8000, v21
  ds_read_b128 v[96:99], v16
  ds_read_b64_tr_b16 a[96:97], v20
  v_accvgpr_read_b32 v115, a67
  v_accvgpr_read_b32 v116, a68
  v_accvgpr_read_b32 v117, a69
  v_mfma_f32_32x32x16_bf16 v[64:79], a[104:107], v[108:111], v[64:79]
  ds_read_b64_tr_b16 a[98:99], v20 offset:1024
  ds_read_b64_tr_b16 a[100:101], v21
  ds_read_b64_tr_b16 a[102:103], v21 offset:1024
  ds_read_b128 v[100:103], v16 offset:4096
  v_accvgpr_read_b32 v118, a70
  v_accvgpr_read_b32 v119, a71
  v_cvt_pk_bf16_f32 v28, v112, v113
  v_cvt_pk_bf16_f32 v29, v114, v115
  v_mfma_f32_32x32x16_bf16 v[80:95], a[108:111], v[108:111], v[80:95]
  v_cvt_pk_bf16_f32 v30, v116, v117
  v_cvt_pk_bf16_f32 v31, v118, v119
  buffer_store_dwordx4 v[28:31], v12, s[8:11], s58 offen sc1
  s_waitcnt lgkmcnt(3)
  v_mfma_f32_32x32x16_bf16 v[32:47], a[96:99], v[96:99], v[32:47]
  ds_read_b128 v[104:107], v17
  ds_read_b64_tr_b16 a[104:105], v20 offset:4096
  v_accvgpr_read_b32 v112, a72
  v_accvgpr_read_b32 v113, a73
  v_accvgpr_read_b32 v114, a74
  s_waitcnt lgkmcnt(3)
  v_mfma_f32_32x32x16_bf16 v[48:63], a[100:103], v[96:99], v[48:63]
  ds_read_b64_tr_b16 a[106:107], v20 offset:5120
  ds_read_b64_tr_b16 a[108:109], v21 offset:4096
  v_accvgpr_read_b32 v115, a75
  v_accvgpr_read_b32 v116, a76
  v_accvgpr_read_b32 v117, a77
  s_waitcnt lgkmcnt(4)
  v_mfma_f32_32x32x16_bf16 v[64:79], a[96:99], v[100:103], v[64:79]
  ds_read_b64_tr_b16 a[110:111], v21 offset:5120
  ds_read_b128 v[108:111], v17 offset:4096
  v_accvgpr_read_b32 v118, a78
  v_accvgpr_read_b32 v119, a79
  v_cvt_pk_bf16_f32 v28, v112, v113
  v_cvt_pk_bf16_f32 v29, v114, v115
  v_mfma_f32_32x32x16_bf16 v[80:95], a[100:103], v[100:103], v[80:95]
  v_cvt_pk_bf16_f32 v30, v116, v117
  v_cvt_pk_bf16_f32 v31, v118, v119
  buffer_store_dwordx4 v[28:31], v12, s[8:11], s58 offen offset:1024 sc1
  s_waitcnt lgkmcnt(3)
  v_mfma_f32_32x32x16_bf16 v[32:47], a[104:107], v[104:107], v[32:47]
  ds_read_b128 v[96:99], v18
  ds_read_b64_tr_b16 a[96:97], v20 offset:8192
  v_accvgpr_read_b32 v112, a80
  v_accvgpr_read_b32 v113, a81
  v_accvgpr_read_b32 v114, a82
  s_waitcnt lgkmcnt(3)
  v_mfma_f32_32x32x16_bf16 v[48:63], a[108:111], v[104:107], v[48:63]
  ds_read_b64_tr_b16 a[98:99], v20 offset:9216
  ds_read_b64_tr_b16 a[100:101], v21 offset:8192
  v_accvgpr_read_b32 v115, a83
  v_accvgpr_read_b32 v116, a84
  v_accvgpr_read_b32 v117, a85
  s_waitcnt lgkmcnt(4)
  v_mfma_f32_32x32x16_bf16 v[64:79], a[104:107], v[108:111], v[64:79]
  ds_read_b64_tr_b16 a[102:103], v21 offset:9216
  ds_read_b128 v[100:103], v18 offset:4096
  v_accvgpr_read_b32 v118, a86
  v_accvgpr_read_b32 v119, a87
  v_cvt_pk_bf16_f32 v28, v112, v113
  v_cvt_pk_bf16_f32 v29, v114, v115
  v_mfma_f32_32x32x16_bf16 v[80:95], a[108:111], v[108:111], v[80:95]
  v_cvt_pk_bf16_f32 v30, v116, v117
  v_cvt_pk_bf16_f32 v31, v118, v119
  buffer_store_dwordx4 v[28:31], v12, s[8:11], s59 offen sc1
  s_waitcnt lgkmcnt(3)
  v_mfma_f32_32x32x16_bf16 v[32:47], a[96:99], v[96:99], v[32:47]
  ds_read_b128 v[104:107], v19
  ds_read_b64_tr_b16 a[104:105], v20 offset:12288
  v_accvgpr_read_b32 v112, a88
  v_accvgpr_read_b32 v113, a89
  v_accvgpr_read_b32 v114, a90
  s_waitcnt lgkmcnt(3)
  v_mfma_f32_32x32x16_bf16 v[48:63], a[100:103], v[96:99], v[48:63]
  ds_read_b64_tr_b16 a[106:107], v20 offset:13312
  ds_read_b64_tr_b16 a[108:109], v21 offset:12288
  v_accvgpr_read_b32 v115, a91
  v_accvgpr_read_b32 v116, a92
  v_accvgpr_read_b32 v117, a93
  s_waitcnt lgkmcnt(4)
  v_mfma_f32_32x32x16_bf16 v[64:79], a[96:99], v[100:103], v[64:79]
  ds_read_b64_tr_b16 a[110:111], v21 offset:13312
  ds_read_b128 v[108:111], v19 offset:4096
  v_accvgpr_read_b32 v118, a94
  v_accvgpr_read_b32 v119, a95
  v_cvt_pk_bf16_f32 v28, v112, v113
  v_cvt_pk_bf16_f32 v29, v114, v115
  v_mfma_f32_32x32x16_bf16 v[80:95], a[100:103], v[100:103], v[80:95]
  v_cvt_pk_bf16_f32 v30, v116, v117
  v_cvt_pk_bf16_f32 v31, v118, v119
  buffer_store_dwordx4 v[28:31], v12, s[8:11], s60 offen sc1
  s_cbranch_vccz Q_G52
  s_waitcnt vmcnt(12)
Q_G52:
  s_waitcnt lgkmcnt(0)
  s_barrier
  v_mfma_f32_32x32x16_bf16 v[32:47], a[104:107], v[104:107], v[32:47]
  v_add_u32 v16, 0xc000, v16
  v_add_u32 v17, 0xc000, v17
  v_add_u32 v18, 0xc000, v18
  v_add_u32 v19, 0xc000, v19
  s_cbranch_vccz Q_G53
  s_add_u32 m0, s42, 0x4000
  s_mov_b32 s52, 0x280
  buffer_load_dwordx4 v123, s[12:15], s52 offen lds
  buffer_load_dwordx4 v124, s[12:15], s52 offen offset:1024 lds
  buffer_load_dwordx4 v125, s[12:15], s52 offen offset:2048 lds
  buffer_load_dwordx4 v126, s[12:15], s52 offen offset:3072 lds
  s_add_u32 m0, s42, 0x5000
  s_mov_b32 s52, 0x9280
  buffer_load_dwordx4 v123, s[12:15], s52 offen lds
  buffer_load_dwordx4 v124, s[12:15], s52 offen offset:1024 lds
  buffer_load_dwordx4 v125, s[12:15], s52 offen offset:2048 lds
  buffer_load_dwordx4 v126, s[12:15], s52 offen offset:3072 lds
  s_add_u32 m0, s43, 0xc000
  s_add_u32 s53, s44, 0x280000
  buffer_load_dwordx4 v14, s[16:19], s53 offen lds
  buffer_load_dwordx4 v15, s[16:19], s53 offen offset:1024 lds
  s_add_u32 m0, s43, 0xc800
  s_add_u32 s53, s44, 0x290000
  buffer_load_dwordx4 v14, s[16:19], s53 offen lds
  buffer_load_dwordx4 v15, s[16:19], s53 offen offset:1024 lds
Q_G53:
  v_accvgpr_read_b32 v112, a112
  v_accvgpr_read_b32 v113, a113
  v_mfma_f32_32x32x16_bf16 v[48:63], a[108:111], v[104:107], v[48:63]
  v_add_u32 v20, 0xc000, v20
  v_add_u32 v21, 0xc000, v21
  ds_read_b128 v[96:99], v16
  ds_read_b64_tr_b16 a[96:97], v20
  v_accvgpr_read_b32 v114, a114
  v_mfma_f32_32x32x16_bf16 v[64:79], a[104:107], v[108:111], v[64:79]
  ds_read_b64_tr_b16 a[98:99], v20 offset:1024
  ds_read_b64_tr_b16 a[100:101], v21
  ds_read_b64_tr_b16 a[102:103], v21 offset:1024
  ds_read_b128 v[100:103], v16 offset:4096
  v_accvgpr_read_b32 v115, a115
  v_accvgpr_read_b32 v116, a116
  v_mfma_f32_32x32x16_bf16 v[80:95], a[108:111], v[108:111], v[80:95]
  v_accvgpr_read_b32 v117, a117
  s_waitcnt lgkmcnt(3)
  v_mfma_f32_32x32x16_bf16 v[32:47], a[96:99], v[96:99], v[32:47]
  ds_read_b128 v[104:107], v17
  ds_read_b64_tr_b16 a[104:105], v20 offset:4096
  v_accvgpr_read_b32 v118, a118
  v_accvgpr_read_b32 v119, a119
  s_waitcnt lgkmcnt(3)
  v_mfma_f32_32x32x16_bf16 v[48:63], a[100:103], v[96:99], v[48:63]
  ds_read_b64_tr_b16 a[106:107], v20 offset:5120
  ds_read_b64_tr_b16 a[108:109], v21 offset:4096
  v_cvt_pk_bf16_f32 v28, v112, v113
  v_cvt_pk_bf16_f32 v29, v114, v115
  s_waitcnt lgkmcnt(4)
  v_mfma_f32_32x32x16_bf16 v[64:79], a[96:99], v[100:103], v[64:79]
  ds_read_b64_tr_b16 a[110:111], v21 offset:5120
  ds_read_b128 v[108:111], v17 offset:4096
  v_cvt_pk_bf16_f32 v30, v116, v117
  v_mfma_f32_32x32x16_bf16 v[80:95], a[100:103], v[100:103], v[80:95]
  v_cvt_pk_bf16_f32 v31, v118, v119
  buffer_store_dwordx4 v[28:31], v13, s[8:11], s59 offen sc1
  s_waitcnt lgkmcnt(3)
  v_mfma_f32_32x32x16_bf16 v[32:47], a[104:107], v[104:107], v[32:47]
  ds_read_b128 v[96:99], v18
  ds_read_b64_tr_b16 a[96:97], v20 offset:8192
  v_accvgpr_read_b32 v112, a120
  v_accvgpr_read_b32 v113, a121
  s_waitcnt lgkmcnt(3)
  v_mfma_f32_32x32x16_bf16 v[48:63], a[108:111], v[104:107], v[48:63]
  ds_read_b64_tr_b16 a[98:99], v20 offset:9216
  ds_read_b64_tr_b16 a[100:101], v21 offset:8192
  v_accvgpr_read_b32 v114, a122
  s_waitcnt lgkmcnt(4)
  v_mfma_f32_32x32x16_bf16 v[64:79], a[104:107], v[108:111], v[64:79]
  ds_read_b64_tr_b16 a[102:103], v21 offset:9216
  ds_read_b128 v[100:103], v18 offset:4096
  v_accvgpr_read_b32 v115, a123
  v_accvgpr_read_b32 v116, a124
  v_mfma_f32_32x32x16_bf16 v[80:95], a[108:111], v[108:111], v[80:95]
  v_accvgpr_read_b32 v117, a125
  s_waitcnt lgkmcnt(3)
  v_mfma_f32_32x32x16_bf16 v[32:47], a[96:99], v[96:99], v[32:47]
  ds_read_b128 v[104:107], v19
  ds_read_b64_tr_b16 a[104:105], v20 offset:12288
  v_accvgpr_read_b32 v118, a126
  v_accvgpr_read_b32 v119, a127
  s_waitcnt lgkmcnt(3)
  v_mfma_f32_32x32x16_bf16 v[48:63], a[100:103], v[96:99], v[48:63]
  ds_read_b64_tr_b16 a[106:107], v20 offset:13312
  ds_read_b64_tr_b16 a[108:109], v21 offset:12288
  v_cvt_pk_bf16_f32 v28, v112, v113
  v_cvt_pk_bf16_f32 v29, v114, v115
  s_waitcnt lgkmcnt(4)
  v_mfma_f32_32x32x16_bf16 v[64:79], a[96:99], v[100:103], v[64:79]
  ds_read_b64_tr_b16 a[110:111], v21 offset:13312
  ds_read_b128 v[108:111], v19 offset:4096
  v_cvt_pk_bf16_f32 v30, v116, v117
  v_mfma_f32_32x32x16_bf16 v[80:95], a[100:103], v[100:103], v[80:95]
  v_cvt_pk_bf16_f32 v31, v118, v119
  buffer_store_dwordx4 v[28:31], v13, s[8:11], s60 offen sc1
  s_cbranch_vccz Q_G54
  s_waitcnt vmcnt(12)
Q_G54:
  s_waitcnt lgkmcnt(0)
  s_barrier
  v_mfma_f32_32x32x16_bf16 v[32:47], a[104:107], v[104:107], v[32:47]
  v_add_u32 v16, 0xc000, v16
  v_add_u32 v17, 0xc000, v17
  v_add_u32 v18, 0xc000, v18
  v_add_u32 v19, 0xc000, v19
  s_cbranch_vccz Q_G55
  s_add_u32 m0, s42, 0x10000
  s_mov_b32 s52, 0x300
  buffer_load_dwordx4 v123, s[12:15], s52 offen lds
  buffer_load_dwordx4 v124, s[12:15], s52 offen offset:1024 lds
  buffer_load_dwordx4 v125, s[12:15], s52 offen offset:2048 lds
  buffer_load_dwordx4 v126, s[12:15], s52 offen offset:3072 lds
  s_add_u32 m0, s42, 0x11000
  s_mov_b32 s52, 0x9300
  buffer_load_dwordx4 v123, s[12:15], s52 offen lds
  buffer_load_dwordx4 v124, s[12:15], s52 offen offset:1024 lds
  buffer_load_dwordx4 v125, s[12:15], s52 offen offset:2048 lds
  buffer_load_dwordx4 v126, s[12:15], s52 offen offset:3072 lds
  s_add_u32 m0, s43, 0x18000
  s_add_u32 s53, s44, 0x300000
  buffer_load_dwordx4 v14, s[16:19], s53 offen lds
  buffer_load_dwordx4 v15, s[16:19], s53 offen offset:1024 lds
  s_add_u32 m0, s43, 0x18800
  s_add_u32 s53, s44, 0x310000
  buffer_load_dwordx4 v14, s[16:19], s53 offen lds
  buffer_load_dwordx4 v15, s[16:19], s53 offen offset:1024 lds
Q_G55:
  v_accvgpr_write_b32 a0, 0
  v_accvgpr_write_b32 a1, 0
  v_mfma_f32_32x32x16_bf16 v[48:63], a[108:111], v[104:107], v[48:63]
  v_add_u32 v20, 0xc000, v20
  v_add_u32 v21, 0xc000, v21
  ds_read_b128 v[96:99], v16
  ds_read_b64_tr_b16 a[96:97], v20
  v_accvgpr_write_b32 a2, 0
  v_accvgpr_write_b32 a3, 0
  v_accvgpr_write_b32 a4, 0
  v_mfma_f32_32x32x16_bf16 v[64:79], a[104:107], v[108:111], v[64:79]
  ds_read_b64_tr_b16 a[98:99], v20 offset:1024
  ds_read_b64_tr_b16 a[100:101], v21
  ds_read_b64_tr_b16 a[102:103], v21 offset:1024
  ds_read_b128 v[100:103], v16 offset:4096
  v_accvgpr_write_b32 a5, 0
  v_accvgpr_write_b32 a6, 0
  v_mfma_f32_32x32x16_bf16 v[80:95], a[108:111], v[108:111], v[80:95]
  v_accvgpr_write_b32 a7, 0
  v_accvgpr_write_b32 a8, 0
  s_waitcnt lgkmcnt(3)
  v_mfma_f32_32x32x16_bf16 v[32:47], a[96:99], v[96:99], v[32:47]
  ds_read_b128 v[104:107], v17
  ds_read_b64_tr_b16 a[104:105], v20 offset:4096
  v_accvgpr_write_b32 a9, 0
  v_accvgpr_write_b32 a10, 0
  v_accvgpr_write_b32 a11, 0
  s_waitcnt lgkmcnt(3)
  v_mfma_f32_32x32x16_bf16 v[48:63], a[100:103], v[96:99], v[48:63]
  ds_read_b64_tr_b16 a[106:107], v20 offset:5120
  ds_read_b64_tr_b16 a[108:109], v21 offset:4096
  v_accvgpr_write_b32 a12, 0
  v_accvgpr_write_b32 a13, 0
  s_waitcnt lgkmcnt(4)
  v_mfma_f32_32x32x16_bf16 v[64:79], a[96:99], v[100:103], v[64:79]
  ds_read_b64_tr_b16 a[110:111], v21 offset:5120
  ds_read_b128 v[108:111], v17 offset:4096
  v_accvgpr_write_b32 a14, 0
  v_accvgpr_write_b32 a15, 0
  v_accvgpr_write_b32 a16, 0
  v_mfma_f32_32x32x16_bf16 v[80:95], a[100:103], v[100:103], v[80:95]
  v_accvgpr_write_b32 a17, 0
  v_accvgpr_write_b32 a18, 0
  s_waitcnt lgkmcnt(3)
  v_mfma_f32_32x32x16_bf16 v[32:47], a[104:107], v[104:107], v[32:47]
  ds_read_b128 v[96:99], v18
  ds_read_b64_tr_b16 a[96:97], v20 offset:8192
  v_accvgpr_write_b32 a19, 0
  v_accvgpr_write_b32 a20, 0
  s_waitcnt lgkmcnt(3)
  v_mfma_f32_32x32x16_bf16 v[48:63], a[108:111], v[104:107], v[48:63]
  ds_read_b64_tr_b16 a[98:99], v20 offset:9216
  ds_read_b64_tr_b16 a[100:101], v21 offset:8192
  v_accvgpr_write_b32 a21, 0
  v_accvgpr_write_b32 a22, 0
  v_accvgpr_write_b32 a23, 0
  s_waitcnt lgkmcnt(4)
  v_mfma_f32_32x32x16_bf16 v[64:79], a[104:107], v[108:111], v[64:79]
  ds_read_b64_tr_b16 a[102:103], v21 offset:9216
  ds_read_b128 v[100:103], v18 offset:4096
  v_accvgpr_write_b32 a24, 0
  v_accvgpr_write_b32 a25, 0
  v_mfma_f32_32x32x16_bf16 v[80:95], a[108:111], v[108:111], v[80:95]
  v_accvgpr_write_b32 a26, 0
  v_accvgpr_write_b32 a27, 0
  s_waitcnt lgkmcnt(3)
  v_mfma_f32_32x32x16_bf16 v[32:47], a[96:99], v[96:99], v[32:47]
  ds_read_b128 v[104:107], v19
  ds_read_b64_tr_b16 a[104:105], v20 offset:12288
  v_accvgpr_write_b32 a28, 0
  v_accvgpr_write_b32 a29, 0
  v_accvgpr_write_b32 a30, 0
  s_waitcnt lgkmcnt(3)
  v_mfma_f32_32x32x16_bf16 v[48:63], a[100:103], v[96:99], v[48:63]
  ds_read_b64_tr_b16 a[106:107], v20 offset:13312
  ds_read_b64_tr_b16 a[108:109], v21 offset:12288
  v_accvgpr_write_b32 a31, 0
  s_cmp_eq_u32 s97, 0
  s_cbranch_scc1 ONLY35
  s_waitcnt vmcnt(0)
ONLY35:
  s_waitcnt lgkmcnt(4)
  v_mfma_f32_32x32x16_bf16 v[64:79], a[96:99], v[100:103], v[64:79]
  ds_read_b64_tr_b16 a[110:111], v21 offset:13312
  ds_read_b128 v[108:111], v19 offset:4096
  s_cmp_eq_u32 s39, 0
  s_cbranch_scc1 ONLY36
  s_waitcnt vmcnt(12)
ONLY36:
  v_mfma_f32_32x32x16_bf16 v[80:95], a[100:103], v[100:103], v[80:95]
  s_cbranch_vccz Q_G56
  s_waitcnt vmcnt(12)
Q_G56:
  s_waitcnt lgkmcnt(0)
  s_barrier
  v_mfma_f32_32x32x16_bf16 v[32:47], a[104:107], v[104:107], v[32:47]
  v_add_u32 v16, 0xfffe8000, v16
  v_add_u32 v17, 0xfffe8000, v17
  v_add_u32 v18, 0xfffe8000, v18
  v_add_u32 v19, 0xfffe8000, v19
  s_cbranch_vccz Q_G57
  s_add_u32 m0, s42, 0x1c000
  s_mov_b32 s52, 0x380
  buffer_load_dwordx4 v123, s[12:15], s52 offen lds
  buffer_load_dwordx4 v124, s[12:15], s52 offen offset:1024 lds
  buffer_load_dwordx4 v125, s[12:15], s52 offen offset:2048 lds
  buffer_load_dwordx4 v126, s[12:15], s52 offen offset:3072 lds
  s_add_u32 m0, s42, 0x1d000
  s_mov_b32 s52, 0x9380
  buffer_load_dwordx4 v123, s[12:15], s52 offen lds
  buffer_load_dwordx4 v124, s[12:15], s52 offen offset:1024 lds
  buffer_load_dwordx4 v125, s[12:15], s52 offen offset:2048 lds
  buffer_load_dwordx4 v126, s[12:15], s52 offen offset:3072 lds
  s_add_u32 m0, s43, 0x24000
  s_add_u32 s53, s44, 0x380000
  buffer_load_dwordx4 v14, s[16:19], s53 offen lds
  buffer_load_dwordx4 v15, s[16:19], s53 offen offset:1024 lds
  s_add_u32 m0, s43, 0x24800
  s_add_u32 s53, s44, 0x390000
  buffer_load_dwordx4 v14, s[16:19], s53 offen lds
  buffer_load_dwordx4 v15, s[16:19], s53 offen offset:1024 lds
Q_G57:
  s_cmp_lg_u32 s3, 0
  s_cbranch_scc1 ONLYW37
  buffer_store_dword v4, v3, s[8:11], s37 offen offset:4 sc1
ONLYW37:
  v_mfma_f32_32x32x16_bf16 v[48:63], a[108:111], v[104:107], v[48:63]
  v_add_u32 v20, 0xfffe8000, v20
  v_add_u32 v21, 0xfffe8000, v21
  ds_read_b128 v[96:99], v16
  ds_read_b64_tr_b16 a[96:97], v20
  v_accvgpr_write_b32 a32, 0
  v_mfma_f32_32x32x16_bf16 v[64:79], a[104:107], v[108:111], v[64:79]
  ds_read_b64_tr_b16 a[98:99], v20 offset:1024
  ds_read_b64_tr_b16 a[100:101], v21
  ds_read_b64_tr_b16 a[102:103], v21 offset:1024
  ds_read_b128 v[100:103], v16 offset:4096
  v_accvgpr_write_b32 a33, 0
  v_accvgpr_write_b32 a34, 0
  v_accvgpr_write_b32 a35, 0
  v_mfma_f32_32x32x16_bf16 v[80:95], a[108:111], v[108:111], v[80:95]
  v_accvgpr_write_b32 a36, 0
  v_accvgpr_write_b32 a37, 0
  s_waitcnt lgkmcnt(3)
  v_mfma_f32_32x32x16_bf16 v[32:47], a[96:99], v[96:99], v[32:47]
  ds_read_b128 v[104:107], v17
  ds_read_b64_tr_b16 a[104:105], v20 offset:4096
  v_accvgpr_write_b32 a38, 0
  v_accvgpr_write_b32 a39, 0
  s_waitcnt lgkmcnt(3)
  v_mfma_f32_32x32x16_bf16 v[48:63], a[100:103], v[96:99], v[48:63]
  ds_read_b64_tr_b16 a[106:107], v20 offset:5120
  ds_read_b64_tr_b16 a[108:109], v21 offset:4096
  v_accvgpr_write_b32 a40, 0
  v_accvgpr_write_b32 a41, 0
  s_waitcnt lgkmcnt(4)
  v_mfma_f32_32x32x16_bf16 v[64:79], a[96:99], v[100:103], v[64:79]
  ds_read_b64_tr_b16 a[110:111], v21 offset:5120
  ds_read_b128 v[108:111], v17 offset:4096
  v_accvgpr_write_b32 a42, 0
  v_accvgpr_write_b32 a43, 0
  v_mfma_f32_32x32x16_bf16 v[80:95], a[100:103], v[100:103], v[80:95]
  v_accvgpr_write_b32 a44, 0
  v_accvgpr_write_b32 a45, 0
  s_waitcnt lgkmcnt(3)
  v_mfma_f32_32x32x16_bf16 v[32:47], a[104:107], v[104:107], v[32:47]
  ds_read_b128 v[96:99], v18
  ds_read_b64_tr_b16 a[96:97], v20 offset:8192
  v_accvgpr_write_b32 a46, 0
  v_accvgpr_write_b32 a47, 0
  v_accvgpr_write_b32 a48, 0
  s_waitcnt lgkmcnt(3)
  v_mfma_f32_32x32x16_bf16 v[48:63], a[108:111], v[104:107], v[48:63]
  ds_read_b64_tr_b16 a[98:99], v20 offset:9216
  ds_read_b64_tr_b16 a[100:101], v21 offset:8192
  v_accvgpr_write_b32 a49, 0
  v_accvgpr_write_b32 a50, 0
  s_waitcnt lgkmcnt(4)
  v_mfma_f32_32x32x16_bf16 v[64:79], a[104:107], v[108:111], v[64:79]
  ds_read_b64_tr_b16 a[102:103], v21 offset:9216
  ds_read_b128 v[100:103], v18 offset:4096
  v_accvgpr_write_b32 a51, 0
  v_accvgpr_write_b32 a52, 0
  v_mfma_f32_32x32x16_bf16 v[80:95], a[108:111], v[108:111], v[80:95]
  v_accvgpr_write_b32 a53, 0
  v_accvgpr_write_b32 a54, 0
  s_waitcnt lgkmcnt(3)
  v_mfma_f32_32x32x16_bf16 v[32:47], a[96:99], v[96:99], v[32:47]
  ds_read_b128 v[104:107], v19
  ds_read_b64_tr_b16 a[104:105], v20 offset:12288
  v_accvgpr_write_b32 a55, 0
  v_accvgpr_write_b32 a56, 0
  s_waitcnt lgkmcnt(3)
  v_mfma_f32_32x32x16_bf16 v[48:63], a[100:103], v[96:99], v[48:63]
  ds_read_b64_tr_b16 a[106:107], v20 offset:13312
  ds_read_b64_tr_b16 a[108:109], v21 offset:12288
  v_accvgpr_write_b32 a57, 0
  v_accvgpr_write_b32 a58, 0
  v_accvgpr_write_b32 a59, 0
  s_waitcnt lgkmcnt(4)
  v_mfma_f32_32x32x16_bf16 v[64:79], a[96:99], v[100:103], v[64:79]
  ds_read_b64_tr_b16 a[110:111], v21 offset:13312
  ds_read_b128 v[108:111], v19 offset:4096
  v_accvgpr_write_b32 a60, 0
  v_accvgpr_write_b32 a61, 0
  v_mfma_f32_32x32x16_bf16 v[80:95], a[100:103], v[100:103], v[80:95]
  v_accvgpr_write_b32 a62, 0
  v_accvgpr_write_b32 a63, 0
  s_cbranch_vccz Q_G58
  s_waitcnt vmcnt(12)
Q_G58:
  s_waitcnt lgkmcnt(0)
  s_barrier
  v_mfma_f32_32x32x16_bf16 v[32:47], a[104:107], v[104:107], v[32:47]
  v_add_u32 v16, 0xc000, v16
  v_add_u32 v17, 0xc000, v17
  v_add_u32 v18, 0xc000, v18
  v_add_u32 v19, 0xc000, v19
  s_cbranch_vccz Q_G59
  s_add_u32 m0, s42, 0x4000
  s_mov_b32 s52, 0x400
  buffer_load_dwordx4 v123, s[12:15], s52 offen lds
  buffer_load_dwordx4 v124, s[12:15], s52 offen offset:1024 lds
  buffer_load_dwordx4 v125, s[12:15], s52 offen offset:2048 lds
  buffer_load_dwordx4 v126, s[12:15], s52 offen offset:3072 lds
  s_add_u32 m0, s42, 0x5000
  s_mov_b32 s52, 0x9400
  buffer_load_dwordx4 v123, s[12:15], s52 offen lds
  buffer_load_dwordx4 v124, s[12:15], s52 offen offset:1024 lds
  buffer_load_dwordx4 v125, s[12:15], s52 offen offset:2048 lds
  buffer_load_dwordx4 v126, s[12:15], s52 offen offset:3072 lds
  s_add_u32 m0, s43, 0xc000
  s_add_u32 s53, s44, 0x400000
  buffer_load_dwordx4 v14, s[16:19], s53 offen lds
  buffer_load_dwordx4 v15, s[16:19], s53 offen offset:1024 lds
  s_add_u32 m0, s43, 0xc800
  s_add_u32 s53, s44, 0x410000
  buffer_load_dwordx4 v14, s[16:19], s53 offen lds
  buffer_load_dwordx4 v15, s[16:19], s53 offen offset:1024 lds
Q_G59:
  v_mfma_f32_32x32x16_bf16 v[48:63], a[108:111], v[104:107], v[48:63]
  v_add_u32 v20, 0xc000, v20
  v_add_u32 v21, 0xc000, v21
  ds_read_b128 v[96:99], v16
  ds_read_b64_tr_b16 a[96:97], v20
  v_mfma_f32_32x32x16_bf16 v[64:79], a[104:107], v[108:111], v[64:79]
  ds_read_b64_tr_b16 a[98:99], v20 offset:1024
  ds_read_b64_tr_b16 a[100:101], v21
  ds_read_b64_tr_b16 a[102:103], v21 offset:1024
  ds_read_b128 v[100:103], v16 offset:4096
  v_mfma_f32_32x32x16_bf16 v[80:95], a[108:111], v[108:111], v[80:95]
  s_waitcnt lgkmcnt(3)
  v_mfma_f32_32x32x16_bf16 v[32:47], a[96:99], v[96:99], v[32:47]
  ds_read_b128 v[104:107], v17
  ds_read_b64_tr_b16 a[104:105], v20 offset:4096
  s_waitcnt lgkmcnt(3)
  v_mfma_f32_32x32x16_bf16 v[48:63], a[100:103], v[96:99], v[48:63]
  ds_read_b64_tr_b16 a[106:107], v20 offset:5120
  ds_read_b64_tr_b16 a[108:109], v21 offset:4096
  s_waitcnt lgkmcnt(4)
  v_mfma_f32_32x32x16_bf16 v[64:79], a[96:99], v[100:103], v[64:79]
  ds_read_b64_tr_b16 a[110:111], v21 offset:5120
  ds_read_b128 v[108:111], v17 offset:4096
  v_mfma_f32_32x32x16_bf16 v[80:95], a[100:103], v[100:103], v[80:95]
  s_waitcnt lgkmcnt(3)
  v_mfma_f32_32x32x16_bf16 v[32:47], a[104:107], v[104:107], v[32:47]
  ds_read_b128 v[96:99], v18
  ds_read_b64_tr_b16 a[96:97], v20 offset:8192
  s_waitcnt lgkmcnt(3)
  v_mfma_f32_32x32x16_bf16 v[48:63], a[108:111], v[104:107], v[48:63]
  ds_read_b64_tr_b16 a[98:99], v20 offset:9216
  ds_read_b64_tr_b16 a[100:101], v21 offset:8192
  s_waitcnt lgkmcnt(4)
  v_mfma_f32_32x32x16_bf16 v[64:79], a[104:107], v[108:111], v[64:79]
  ds_read_b64_tr_b16 a[102:103], v21 offset:9216
  ds_read_b128 v[100:103], v18 offset:4096
  v_mfma_f32_32x32x16_bf16 v[80:95], a[108:111], v[108:111], v[80:95]
  s_waitcnt lgkmcnt(3)
  v_mfma_f32_32x32x16_bf16 v[32:47], a[96:99], v[96:99], v[32:47]
  ds_read_b128 v[104:107], v19
  ds_read_b64_tr_b16 a[104:105], v20 offset:12288
  s_waitcnt lgkmcnt(3)
  v_mfma_f32_32x32x16_bf16 v[48:63], a[100:103], v[96:99], v[48:63]
  ds_read_b64_tr_b16 a[106:107], v20 offset:13312
  ds_read_b64_tr_b16 a[108:109], v21 offset:12288
  s_waitcnt lgkmcnt(4)
  v_mfma_f32_32x32x16_bf16 v[64:79], a[96:99], v[100:103], v[64:79]
  ds_read_b64_tr_b16 a[110:111], v21 offset:13312
  ds_read_b128 v[108:111], v19 offset:4096
  v_mfma_f32_32x32x16_bf16 v[80:95], a[100:103], v[100:103], v[80:95]
  s_cbranch_vccz Q_G60
  s_waitcnt vmcnt(12)
Q_G60:
  s_waitcnt lgkmcnt(0)
  s_barrier
  v_mfma_f32_32x32x16_bf16 v[32:47], a[104:107], v[104:107], v[32:47]
  v_add_u32 v16, 0xc000, v16
  v_add_u32 v17, 0xc000, v17
  v_add_u32 v18, 0xc000, v18
  v_add_u32 v19, 0xc000, v19
  v_mfma_f32_32x32x16_bf16 v[48:63], a[108:111], v[104:107], v[48:63]
  v_add_u32 v20, 0xc000, v20
  v_add_u32 v21, 0xc000, v21
  ds_read_b128 v[96:99], v16
  ds_read_b64_tr_b16 a[96:97], v20
  v_mfma_f32_32x32x16_bf16 v[64:79], a[104:107], v[108:111], v[64:79]
  ds_read_b64_tr_b16 a[98:99], v20 offset:1024
  ds_read_b64_tr_b16 a[100:101], v21
  ds_read_b64_tr_b16 a[102:103], v21 offset:1024
  ds_read_b128 v[100:103], v16 offset:4096
  s_cmp_lg_u32 s3, 0
  s_cbranch_scc1 ONLYW38
  buffer_load_dword v121, v120, s[8:11], 0 offen sc1
ONLYW38:
  v_mfma_f32_32x32x16_bf16 v[80:95], a[108:111], v[108:111], v[80:95]
  s_waitcnt lgkmcnt(3)
  v_mfma_f32_32x32x16_bf16 v[32:47], a[96:99], v[96:99], v[32:47]
  ds_read_b128 v[104:107], v17
  ds_read_b64_tr_b16 a[104:105], v20 offset:4096
  s_waitcnt lgkmcnt(3)
  v_mfma_f32_32x32x16_bf16 v[48:63], a[100:103], v[96:99], v[48:63]
  ds_read_b64_tr_b16 a[106:107], v20 offset:5120
  ds_read_b64_tr_b16 a[108:109], v21 offset:4096
  s_waitcnt lgkmcnt(4)
  v_mfma_f32_32x32x16_bf16 v[64:79], a[96:99], v[100:103], v[64:79]
  ds_read_b64_tr_b16 a[110:111], v21 offset:5120
  ds_read_b128 v[108:111], v17 offset:4096
  v_mfma_f32_32x32x16_bf16 v[80:95], a[100:103], v[100:103], v[80:95]
  s_waitcnt lgkmcnt(3)
  v_mfma_f32_32x32x16_bf16 v[32:47], a[104:107], v[104:107], v[32:47]
  ds_read_b128 v[96:99], v18
  ds_read_b64_tr_b16 a[96:97], v20 offset:8192
  s_waitcnt lgkmcnt(3)
  v_mfma_f32_32x32x16_bf16 v[48:63], a[108:111], v[104:107], v[48:63]
  ds_read_b64_tr_b16 a[98:99], v20 offset:9216
  ds_read_b64_tr_b16 a[100:101], v21 offset:8192
  s_waitcnt lgkmcnt(4)
  v_mfma_f32_32x32x16_bf16 v[64:79], a[104:107], v[108:111], v[64:79]
  ds_read_b64_tr_b16 a[102:103], v21 offset:9216
  ds_read_b128 v[100:103], v18 offset:4096
  v_mfma_f32_32x32x16_bf16 v[80:95], a[108:111], v[108:111], v[80:95]
  s_waitcnt lgkmcnt(3)
  v_mfma_f32_32x32x16_bf16 v[32:47], a[96:99], v[96:99], v[32:47]
  ds_read_b128 v[104:107], v19
  ds_read_b64_tr_b16 a[104:105], v20 offset:12288
  s_waitcnt lgkmcnt(3)
  v_mfma_f32_32x32x16_bf16 v[48:63], a[100:103], v[96:99], v[48:63]
  ds_read_b64_tr_b16 a[106:107], v20 offset:13312
  ds_read_b64_tr_b16 a[108:109], v21 offset:12288
  s_waitcnt lgkmcnt(4)
  v_mfma_f32_32x32x16_bf16 v[64:79], a[96:99], v[100:103], v[64:79]
  ds_read_b64_tr_b16 a[110:111], v21 offset:13312
  ds_read_b128 v[108:111], v19 offset:4096
  v_mfma_f32_32x32x16_bf16 v[80:95], a[100:103], v[100:103], v[80:95]
  s_cmp_lg_u32 s3, 0
  s_cbranch_scc1 ONLYW42
  s_waitcnt vmcnt(0)
  v_cmp_ne_u32 vcc, 1, v121
  s_nop 1
  s_cbranch_vccz Q_OK39
  s_mov_b32 s38, 0
PL40:
  buffer_load_dword v121, v120, s[8:11], 0 offen sc1
  s_waitcnt vmcnt(0)
  v_cmp_ne_u32 vcc, 1, v121
  s_add_u32 s38, s38, 1
  s_cbranch_vccz PD41
  s_sleep 1
  s_cmp_lt_u32 s38, 0x30d40
  s_cbranch_scc1 PL40
PD41:
Q_OK39:
  s_mov_b64 vcc, 0
ONLYW42:
  s_cbranch_vccz Q_G61
  s_waitcnt vmcnt(0)
Q_G61:
  s_waitcnt lgkmcnt(0)
  s_barrier
  v_mfma_f32_32x32x16_bf16 v[32:47], a[104:107], v[104:107], v[32:47]
  v_add_u32 v16, 0xfffe8000, v16
  v_add_u32 v17, 0xfffe8000, v17
  v_add_u32 v18, 0xfffe8000, v18
  v_add_u32 v19, 0xfffe8000, v19
  v_add_u32 v124, s50, v2
  s_lshl_b32 s6, s39, 15
  s_add_u32 s6, s6, s50
  s_add_u32 s6, s6, 0x10000
  s_mov_b32 m0, s6
  v_mfma_f32_32x32x16_bf16 v[48:63], a[108:111], v[104:107], v[48:63]
  v_add_u32 v20, 0xfffe8000, v20
  v_add_u32 v21, 0xfffe8000, v21
  ds_read_b128 v[96:99], v16
  ds_read_b64_tr_b16 a[96:97], v20
  s_lshl_b32 s7, s39, 14
  s_add_u32 s7, s7, s26
  s_add_u32 s7, s7, 0x2000
  buffer_load_dwordx4 v124, s[8:11], s7 offen sc1 lds
  buffer_load_dwordx4 v124, s[8:11], s7 offen offset:1024 sc1 lds
  v_mfma_f32_32x32x16_bf16 v[64:79], a[104:107], v[108:111], v[64:79]
  ds_read_b64_tr_b16 a[98:99], v20 offset:1024
  ds_read_b64_tr_b16 a[100:101], v21
  ds_read_b64_tr_b16 a[102:103], v21 offset:1024
  ds_read_b128 v[100:103], v16 offset:4096
  buffer_load_dwordx4 v124, s[8:11], s7 offen offset:2048 sc1 lds
  buffer_load_dwordx4 v124, s[8:11], s7 offen offset:3072 sc1 lds
  s_add_u32 m0, s6, 0x4000
  s_cmp_ge_u32 s91, 2
  s_cselect_b32 s7, 0xffe000, 0
  s_cmp_eq_u32 s39, 1
  s_cselect_b32 s7, 0x1002000, s7
  v_mfma_f32_32x32x16_bf16 v[80:95], a[108:111], v[108:111], v[80:95]
  s_add_u32 s7, s7, s26
  buffer_load_dwordx4 v124, s[8:11], s7 offen sc1 lds
  buffer_load_dwordx4 v124, s[8:11], s7 offen offset:1024 sc1 lds
  buffer_load_dwordx4 v124, s[8:11], s7 offen offset:2048 sc1 lds
  s_waitcnt lgkmcnt(3)
  v_mfma_f32_32x32x16_bf16 v[32:47], a[96:99], v[96:99], v[32:47]
  ds_read_b128 v[104:107], v17
  ds_read_b64_tr_b16 a[104:105], v20 offset:4096
  buffer_load_dwordx4 v124, s[8:11], s7 offen offset:3072 sc1 lds
  s_add_u32 s6, s47, 0
  s_and_b32 s6, s6, 3
  s_lshl_b32 s7, s46, 2
  s_add_u32 s6, s6, s7
  s_waitcnt lgkmcnt(3)
  v_mfma_f32_32x32x16_bf16 v[48:63], a[100:103], v[96:99], v[48:63]
  ds_read_b64_tr_b16 a[106:107], v20 offset:5120
  ds_read_b64_tr_b16 a[108:109], v21 offset:4096
  s_lshl_b32 s7, s47, 5
  s_add_u32 s6, s6, s7
  s_lshl_b32 s6, s6, 15
  s_add_u32 s6, s6, 0x3000000
  s_lshl_b32 s7, s39, 14
  s_waitcnt lgkmcnt(4)
  v_mfma_f32_32x32x16_bf16 v[64:79], a[96:99], v[100:103], v[64:79]
  ds_read_b64_tr_b16 a[110:111], v21 offset:5120
  ds_read_b128 v[108:111], v17 offset:4096
  s_add_u32 s6, s6, s7
  s_add_u32 s7, s7, s50
  s_add_u32 m0, s7, 0x20000
  s_nop 0
  buffer_load_dwordx4 v124, s[8:11], s6 offen sc1 lds
  buffer_load_dwordx4 v124, s[8:11], s6 offen offset:1024 sc1 lds
  buffer_load_dwordx4 v124, s[8:11], s6 offen offset:2048 sc1 lds
  v_mfma_f32_32x32x16_bf16 v[80:95], a[100:103], v[100:103], v[80:95]
  buffer_load_dwordx4 v124, s[8:11], s6 offen offset:3072 sc1 lds
  s_mov_b32 s42, s50
  s_add_u32 s40, s26, 0xa000
  s_add_u32 s41, s26, 0x1006000
  s_mov_b32 s20, 2
  s_waitcnt lgkmcnt(3)
  v_mfma_f32_32x32x16_bf16 v[32:47], a[104:107], v[104:107], v[32:47]
  ds_read_b128 v[96:99], v18
  ds_read_b64_tr_b16 a[96:97], v20 offset:8192
  s_waitcnt lgkmcnt(3)
  v_mfma_f32_32x32x16_bf16 v[48:63], a[108:111], v[104:107], v[48:63]
  ds_read_b64_tr_b16 a[98:99], v20 offset:9216
  ds_read_b64_tr_b16 a[100:101], v21 offset:8192
  s_waitcnt lgkmcnt(4)
  v_mfma_f32_32x32x16_bf16 v[64:79], a[104:107], v[108:111], v[64:79]
  ds_read_b64_tr_b16 a[102:103], v21 offset:9216
  ds_read_b128 v[100:103], v18 offset:4096
  v_mfma_f32_32x32x16_bf16 v[80:95], a[108:111], v[108:111], v[80:95]
  s_waitcnt lgkmcnt(3)
  v_mfma_f32_32x32x16_bf16 v[32:47], a[96:99], v[96:99], v[32:47]
  ds_read_b128 v[104:107], v19
  ds_read_b64_tr_b16 a[104:105], v20 offset:12288
  s_waitcnt lgkmcnt(3)
  v_mfma_f32_32x32x16_bf16 v[48:63], a[100:103], v[96:99], v[48:63]
  ds_read_b64_tr_b16 a[106:107], v20 offset:13312
  ds_read_b64_tr_b16 a[108:109], v21 offset:12288
  s_waitcnt lgkmcnt(4)
  v_mfma_f32_32x32x16_bf16 v[64:79], a[96:99], v[100:103], v[64:79]
  ds_read_b64_tr_b16 a[110:111], v21 offset:13312
  ds_read_b128 v[108:111], v19 offset:4096
  v_mfma_f32_32x32x16_bf16 v[80:95], a[100:103], v[100:103], v[80:95]
  s_waitcnt lgkmcnt(3)
  v_mfma_f32_32x32x16_bf16 v[32:47], a[104:107], v[104:107], v[32:47]
  s_waitcnt lgkmcnt(1)
  v_mfma_f32_32x32x16_bf16 v[48:63], a[108:111], v[104:107], v[48:63]
  s_waitcnt lgkmcnt(0)
  v_mfma_f32_32x32x16_bf16 v[64:79], a[104:107], v[108:111], v[64:79]
  v_mfma_f32_32x32x16_bf16 v[80:95], a[108:111], v[108:111], v[80:95]
  s_mov_b32 s7, 0x3e0293ee
  s_lshr_b32 s6, s3, 1
  s_lshl_b32 s6, s6, 14
  s_and_b32 s90, s3, 1
  s_lshl_b32 s90, s90, 12
  s_add_u32 s6, s6, s90
  v_add_u32 v5, s6, v2
  s_barrier
  v_mul_f32 v32, s7, v32
  v_mul_f32 v33, s7, v33
  v_mul_f32 v34, s7, v34
  v_mul_f32 v35, s7, v35
  v_mul_f32 v36, s7, v36
  v_mul_f32 v37, s7, v37
  v_mul_f32 v38, s7, v38
  v_mul_f32 v39, s7, v39
  v_mul_f32 v40, s7, v40
  v_mul_f32 v41, s7, v41
  v_mul_f32 v42, s7, v42
  v_mul_f32 v43, s7, v43
  v_mul_f32 v44, s7, v44
  v_mul_f32 v45, s7, v45
  v_mul_f32 v46, s7, v46
  v_mul_f32 v47, s7, v47
  v_cvt_pk_bf16_f32 v32, v32, v33
  v_cvt_pk_bf16_f32 v33, v34, v35
  v_cvt_pk_bf16_f32 v34, v36, v37
  v_cvt_pk_bf16_f32 v35, v38, v39
  v_cvt_pk_bf16_f32 v36, v40, v41
  v_cvt_pk_bf16_f32 v37, v42, v43
  v_cvt_pk_bf16_f32 v38, v44, v45
  v_cvt_pk_bf16_f32 v39, v46, v47
  ds_write_b128 v5, v[32:35] offset:0
  ds_write_b128 v5, v[36:39] offset:1024
  v_mul_f32 v48, s7, v48
  v_mul_f32 v49, s7, v49
  v_mul_f32 v50, s7, v50
  v_mul_f32 v51, s7, v51
  v_mul_f32 v52, s7, v52
  v_mul_f32 v53, s7, v53
  v_mul_f32 v54, s7, v54
  v_mul_f32 v55, s7, v55
  v_mul_f32 v56, s7, v56
  v_mul_f32 v57, s7, v57
  v_mul_f32 v58, s7, v58
  v_mul_f32 v59, s7, v59
  v_mul_f32 v60, s7, v60
  v_mul_f32 v61, s7, v61
  v_mul_f32 v62, s7, v62
  v_mul_f32 v63, s7, v63
  v_cvt_pk_bf16_f32 v48, v48, v49
  v_cvt_pk_bf16_f32 v49, v50, v51
  v_cvt_pk_bf16_f32 v50, v52, v53
  v_cvt_pk_bf16_f32 v51, v54, v55
  v_cvt_pk_bf16_f32 v52, v56, v57
  v_cvt_pk_bf16_f32 v53, v58, v59
  v_cvt_pk_bf16_f32 v54, v60, v61
  v_cvt_pk_bf16_f32 v55, v62, v63
  ds_write_b128 v5, v[48:51] offset:2048
  ds_write_b128 v5, v[52:55] offset:3072
  v_mul_f32 v64, s7, v64
  v_mul_f32 v65, s7, v65
  v_mul_f32 v66, s7, v66
  v_mul_f32 v67, s7, v67
  v_mul_f32 v68, s7, v68
  v_mul_f32 v69, s7, v69
  v_mul_f32 v70, s7, v70
  v_mul_f32 v71, s7, v71
  v_mul_f32 v72, s7, v72
  v_mul_f32 v73, s7, v73
  v_mul_f32 v74, s7, v74
  v_mul_f32 v75, s7, v75
  v_mul_f32 v76, s7, v76
  v_mul_f32 v77, s7, v77
  v_mul_f32 v78, s7, v78
  v_mul_f32 v79, s7, v79
  v_cvt_pk_bf16_f32 v64, v64, v65
  v_cvt_pk_bf16_f32 v65, v66, v67
  v_cvt_pk_bf16_f32 v66, v68, v69
  v_cvt_pk_bf16_f32 v67, v70, v71
  v_cvt_pk_bf16_f32 v68, v72, v73
  v_cvt_pk_bf16_f32 v69, v74, v75
  v_cvt_pk_bf16_f32 v70, v76, v77
  v_cvt_pk_bf16_f32 v71, v78, v79
  ds_write_b128 v5, v[64:67] offset:8192
  ds_write_b128 v5, v[68:71] offset:9216
  v_mul_f32 v80, s7, v80
  v_mul_f32 v81, s7, v81
  v_mul_f32 v82, s7, v82
  v_mul_f32 v83, s7, v83
  v_mul_f32 v84, s7, v84
  v_mul_f32 v85, s7, v85
  v_mul_f32 v86, s7, v86
  v_mul_f32 v87, s7, v87
  v_mul_f32 v88, s7, v88
  v_mul_f32 v89, s7, v89
  v_mul_f32 v90, s7, v90
  v_mul_f32 v91, s7, v91
  v_mul_f32 v92, s7, v92
  v_mul_f32 v93, s7, v93
  v_mul_f32 v94, s7, v94
  v_mul_f32 v95, s7, v95
  v_cvt_pk_bf16_f32 v80, v80, v81
  v_cvt_pk_bf16_f32 v81, v82, v83
  v_cvt_pk_bf16_f32 v82, v84, v85
  v_cvt_pk_bf16_f32 v83, v86, v87
  v_cvt_pk_bf16_f32 v84, v88, v89
  v_cvt_pk_bf16_f32 v85, v90, v91
  v_cvt_pk_bf16_f32 v86, v92, v93
  v_cvt_pk_bf16_f32 v87, v94, v95
  ds_write_b128 v5, v[80:83] offset:10240
  ds_write_b128 v5, v[84:87] offset:11264
  s_lshl_b32 s6, s3, 13
  v_add_u32 v122, s6, v2
  s_mov_b32 s27, 1
  s_lshl_b32 s6, s35, 5
  s_add_u32 s6, s6, s46
  s_lshl_b32 s6, s6, 8
  s_lshl_b32 s7, s3, 2
  s_add_u32 s6, s6, s7
  s_add_u32 s6, s6, 0x7c00040
  v_and_b32 v5, 3, v1
  v_lshlrev_b32 v5, 11, v5
  v_add_u32 v20, s6, v5
  v_add_u32 v22, 0x20000, v2
  s_add_u32 s6, s21, 3
  s_and_b32 s6, s6, 3
  s_lshl_b32 s6, s6, 15
  v_add_u32 v23, s6, v2
  s_add_u32 s6, s21, 4
  s_and_b32 s6, s6, 3
  s_lshl_b32 s6, s6, 15
  v_add_u32 v24, s6, v2
  s_add_u32 s6, s21, 5
  s_and_b32 s6, s6, 3
  s_lshl_b32 s6, s6, 15
  v_add_u32 v25, s6, v2
  s_mov_b32 s48, s6
  s_add_u32 s6, s21, 2
  s_and_b32 s6, s6, 3
  s_lshl_b32 s6, s6, 15
  v_and_b32 v5, 15, v1
  v_lshrrev_b32 v6, 5, v1
  v_lshlrev_b32 v6, 8, v6
  v_lshl_add_u32 v5, v5, 4, v6
  v_add_u32 v26, s6, v5
  v_mov_b32 v10, 0
  v_mov_b32 v11, 0x5d800000
  v_mov_b32 v14, 0xff800000
  v_and_b32 v5, 31, v1
  v_lshrrev_b32 v6, 5, v1
  v_lshlrev_b32 v6, 2, v6
  v_sub_u32 v5, v5, v6
  v_add_u32 v13, s96, v5
  s_lshl_b32 s6, s3, 2
  v_mov_b32 v5, s6
  v_mov_b32 v6, 0x7fffff00
  v_cmp_eq_u32 vcc, 0, v1
  s_nop 1
  v_cndmask_b32 v19, v6, v5, vcc
  s_waitcnt vmcnt(0) lgkmcnt(0)
  s_barrier
  v_add_u32 v125, 0x10000, v2
  ds_read_b128 a[64:67], v122
  ds_read_b128 a[68:71], v122 offset:1024
  ds_read_b128 a[72:75], v122 offset:2048
  ds_read_b128 a[76:79], v122 offset:3072
  ds_read_b128 a[80:83], v122 offset:4096
  ds_read_b128 a[84:87], v122 offset:5120
  ds_read_b128 a[88:91], v122 offset:6144
  ds_read_b128 a[92:95], v122 offset:7168
  ds_read_b128 a[96:99], v125 offset:16384
  ds_read_b128 a[100:103], v125 offset:17408
  ds_read_b128 a[104:107], v125 offset:18432
  ds_read_b128 a[108:111], v125 offset:19456
  ds_read_b128 a[112:115], v125 offset:20480
  ds_read_b128 a[116:119], v125 offset:21504
  ds_read_b128 a[120:123], v125 offset:22528
  ds_read_b128 a[124:127], v125 offset:23552
  s_waitcnt lgkmcnt(8)
  s_barrier
  s_cmp_lg_u32 s39, 0
  s_cbranch_scc1 A_ND43
  s_mov_b32 m0, s42
  s_nop 0
  buffer_load_dwordx4 v124, s[8:11], s40 offen sc1 lds
  buffer_load_dwordx4 v124, s[8:11], s40 offen offset:1024 sc1 lds
  buffer_load_dwordx4 v124, s[8:11], s40 offen offset:2048 sc1 lds
  buffer_load_dwordx4 v124, s[8:11], s40 offen offset:3072 sc1 lds
  s_add_u32 m0, s42, 0x4000
  s_nop 0
  buffer_load_dwordx4 v124, s[8:11], s41 offen sc1 lds
  buffer_load_dwordx4 v124, s[8:11], s41 offen offset:1024 sc1 lds
  buffer_load_dwordx4 v124, s[8:11], s41 offen offset:2048 sc1 lds
  buffer_load_dwordx4 v124, s[8:11], s41 offen offset:3072 sc1 lds
  s_add_u32 s40, s40, 0x4000
  s_add_u32 s41, s41, 0x4000
  s_add_u32 s42, s42, 0x8000
  s_and_b32 s42, s42, 0x1ffff
  s_add_u32 s20, s20, 1
  s_cmp_eq_u32 s20, s21
  s_cselect_b32 s40, s22, s40
  s_sub_u32 s6, s20, 1
  s_cmp_eq_u32 s6, s21
  s_cselect_b32 s40, s23, s40
  s_sub_u32 s6, s20, 2
  s_cmp_eq_u32 s6, s21
  s_cselect_b32 s40, s24, s40
  s_add_u32 s6, s40, 0x4000
  s_cmp_gt_u32 s20, s21
  s_cselect_b32 s41, s6, s41
A_ND43:
  s_waitcnt lgkmcnt(7)
  v_mfma_f32_32x32x16_bf16 v[32:47], a[96:99], a[64:67], 0
  s_waitcnt lgkmcnt(6)
  v_mfma_f32_32x32x16_bf16 v[32:47], a[100:103], a[68:71], v[32:47]
  s_waitcnt lgkmcnt(5)
  v_mfma_f32_32x32x16_bf16 v[32:47], a[104:107], a[72:75], v[32:47]
  s_waitcnt lgkmcnt(4)
  v_mfma_f32_32x32x16_bf16 v[32:47], a[108:111], a[76:79], v[32:47]
  s_waitcnt lgkmcnt(3)
  v_mfma_f32_32x32x16_bf16 v[32:47], a[112:115], a[80:83], v[32:47]
  s_waitcnt lgkmcnt(2)
  v_mfma_f32_32x32x16_bf16 v[32:47], a[116:119], a[84:87], v[32:47]
  s_waitcnt lgkmcnt(1)
  v_mfma_f32_32x32x16_bf16 v[32:47], a[120:123], a[88:91], v[32:47]
  s_waitcnt lgkmcnt(0)
  v_mfma_f32_32x32x16_bf16 v[32:47], a[124:127], a[92:95], v[32:47]
  s_mov_b32 s43, 0x10000
  ds_read_b128 a[96:99], v125
  ds_read_b128 a[100:103], v125 offset:1024
  ds_read_b128 a[104:107], v125 offset:2048
  ds_read_b128 a[108:111], v125 offset:3072
  ds_read_b128 a[112:115], v125 offset:4096
  ds_read_b128 a[116:119], v125 offset:5120
  v_cmp_lt_i32 s[56:57], v13, 0
  v_cmp_lt_i32 s[58:59], v13, 1
  v_cmp_lt_i32 s[60:61], v13, 2
  v_cmp_lt_i32 s[62:63], v13, 3
  s_nop 0
  v_cndmask_b32 v32, v32, v14, s[56:57]
  v_cndmask_b32 v33, v33, v14, s[58:59]
  v_cndmask_b32 v34, v34, v14, s[60:61]
  v_cndmask_b32 v35, v35, v14, s[62:63]
  v_cmp_lt_i32 s[56:57], v13, 8
  v_cmp_lt_i32 s[58:59], v13, 9
  v_cmp_lt_i32 s[60:61], v13, 10
  v_cmp_lt_i32 s[62:63], v13, 11
  v_cndmask_b32 v36, v36, v14, s[56:57]
  v_cndmask_b32 v37, v37, v14, s[58:59]
  v_cndmask_b32 v38, v38, v14, s[60:61]
  v_cndmask_b32 v39, v39, v14, s[62:63]
  v_cmp_lt_i32 s[56:57], v13, 16
  v_cmp_lt_i32 s[58:59], v13, 17
  v_cmp_lt_i32 s[60:61], v13, 18
  v_cmp_lt_i32 s[62:63], v13, 19
  v_cndmask_b32 v40, v40, v14, s[56:57]
  v_cndmask_b32 v41, v41, v14, s[58:59]
  v_cndmask_b32 v42, v42, v14, s[60:61]
  v_cndmask_b32 v43, v43, v14, s[62:63]
  v_cmp_lt_i32 s[56:57], v13, 24
  v_cmp_lt_i32 s[58:59], v13, 25
  v_cmp_lt_i32 s[60:61], v13, 26
  v_cmp_lt_i32 s[62:63], v13, 27
  v_cndmask_b32 v44, v44, v14, s[56:57]
  v_cndmask_b32 v45, v45, v14, s[58:59]
  v_cndmask_b32 v46, v46, v14, s[60:61]
  v_cndmask_b32 v47, v47, v14, s[62:63]
  v_subrev_u32 v13, 32, v13
  v_max3_f32 v18, v32, v33, v34
  v_max3_f32 v18, v18, v35, v36
  v_max3_f32 v18, v18, v37, v38
  v_max3_f32 v18, v18, v39, v40
  v_max3_f32 v18, v18, v41, v42
  v_max3_f32 v18, v18, v43, v44
  v_max3_f32 v18, v18, v45, v46
  v_max_f32 v18, v18, v47
  v_mov_b32 v6, v18
  s_nop 1
  v_permlane32_swap_b32 v18, v6
  v_max_f32 v18, v18, v6
  v_add_f32 v18, 0x42200000, v18
  v_sub_f32 v64, 0, v18
  v_sub_f32 v65, 0, v18
  v_sub_f32 v66, 0, v18
  v_sub_f32 v67, 0, v18
  v_sub_f32 v68, 0, v18
  v_sub_f32 v69, 0, v18
  v_sub_f32 v70, 0, v18
  v_sub_f32 v71, 0, v18
  v_sub_f32 v72, 0, v18
  v_sub_f32 v73, 0, v18
  v_sub_f32 v74, 0, v18
  v_sub_f32 v75, 0, v18
  v_sub_f32 v76, 0, v18
  v_sub_f32 v77, 0, v18
  v_sub_f32 v78, 0, v18
  v_sub_f32 v79, 0, v18
  v_sub_f32 v32, v32, v18
  v_sub_f32 v33, v33, v18
  v_sub_f32 v34, v34, v18
  v_sub_f32 v35, v35, v18
  v_sub_f32 v36, v36, v18
  v_sub_f32 v37, v37, v18
  v_sub_f32 v38, v38, v18
  v_sub_f32 v39, v39, v18
  v_sub_f32 v40, v40, v18
  v_sub_f32 v41, v41, v18
  v_sub_f32 v42, v42, v18
  v_sub_f32 v43, v43, v18
  v_sub_f32 v44, v44, v18
  v_sub_f32 v45, v45, v18
  v_sub_f32 v46, v46, v18
  v_sub_f32 v47, v47, v18
  s_waitcnt lgkmcnt(5)
  v_mfma_f32_32x32x16_bf16 v[48:63], a[96:99], a[64:67], v[64:79]
  ds_read_b128 a[120:123], v125 offset:6144
  s_waitcnt vmcnt(8)
  s_barrier
  s_waitcnt lgkmcnt(5)
  v_mfma_f32_32x32x16_bf16 v[48:63], a[100:103], a[68:71], v[48:63]
  ds_read_b128 a[124:127], v125 offset:7168
  s_cmp_lg_u32 s39, 0
  s_cbranch_scc1 A_ND44
  s_mov_b32 m0, s42
  s_nop 0
  buffer_load_dwordx4 v124, s[8:11], s40 offen sc1 lds
  buffer_load_dwordx4 v124, s[8:11], s40 offen offset:1024 sc1 lds
  buffer_load_dwordx4 v124, s[8:11], s40 offen offset:2048 sc1 lds
  buffer_load_dwordx4 v124, s[8:11], s40 offen offset:3072 sc1 lds
  s_add_u32 m0, s42, 0x4000
  s_nop 0
  buffer_load_dwordx4 v124, s[8:11], s41 offen sc1 lds
  buffer_load_dwordx4 v124, s[8:11], s41 offen offset:1024 sc1 lds
  buffer_load_dwordx4 v124, s[8:11], s41 offen offset:2048 sc1 lds
  buffer_load_dwordx4 v124, s[8:11], s41 offen offset:3072 sc1 lds
  s_add_u32 s40, s40, 0x4000
  s_add_u32 s41, s41, 0x4000
  s_add_u32 s42, s42, 0x8000
  s_and_b32 s42, s42, 0x1ffff
  s_add_u32 s20, s20, 1
  s_cmp_eq_u32 s20, s21
  s_cselect_b32 s40, s22, s40
  s_sub_u32 s6, s20, 1
  s_cmp_eq_u32 s6, s21
  s_cselect_b32 s40, s23, s40
  s_sub_u32 s6, s20, 2
  s_cmp_eq_u32 s6, s21
  s_cselect_b32 s40, s24, s40
  s_add_u32 s6, s40, 0x4000
  s_cmp_gt_u32 s20, s21
  s_cselect_b32 s41, s6, s41
A_ND44:
  v_exp_f32 v96, v32
  v_exp_f32 v97, v33
  v_exp_f32 v98, v34
  v_exp_f32 v99, v35
  v_mov_b32 v15, v96
  v_mov_b32 v16, v97
  s_waitcnt lgkmcnt(4)
  v_mfma_f32_32x32x16_bf16 v[48:63], a[104:107], a[72:75], v[48:63]
  ds_read_b128 a[96:99], v125 offset:24576
  v_cvt_pk_bf16_f32 v80, v96, v97
  v_exp_f32 v100, v36
  v_exp_f32 v101, v37
  v_add_f32 v15, v15, v98
  v_add_f32 v16, v16, v99
  v_cvt_pk_bf16_f32 v81, v98, v99
  v_exp_f32 v102, v38
  v_mfma_f32_32x32x16_bf16 v[48:63], a[108:111], a[76:79], v[48:63]
  ds_read_b128 a[100:103], v125 offset:25600
  v_exp_f32 v103, v39
  v_add_f32 v15, v15, v100
  v_add_f32 v16, v16, v101
  v_cvt_pk_bf16_f32 v82, v100, v101
  v_exp_f32 v96, v40
  v_exp_f32 v97, v41
  s_waitcnt lgkmcnt(4)
  v_mfma_f32_32x32x16_bf16 v[48:63], a[112:115], a[80:83], v[48:63]
  ds_read_b128 a[104:107], v125 offset:26624
  v_add_f32 v15, v15, v102
  v_add_f32 v16, v16, v103
  v_cvt_pk_bf16_f32 v83, v102, v103
  v_exp_f32 v98, v42
  v_exp_f32 v99, v43
  v_add_f32 v15, v15, v96
  v_add_f32 v16, v16, v97
  v_cvt_pk_bf16_f32 v84, v96, v97
  v_mfma_f32_32x32x16_bf16 v[48:63], a[116:119], a[84:87], v[48:63]
  ds_read_b128 a[108:111], v125 offset:27648
  v_exp_f32 v100, v44
  v_exp_f32 v101, v45
  v_add_f32 v15, v15, v98
  v_add_f32 v16, v16, v99
  v_cvt_pk_bf16_f32 v85, v98, v99
  v_exp_f32 v102, v46
  s_waitcnt lgkmcnt(4)
  v_mfma_f32_32x32x16_bf16 v[48:63], a[120:123], a[88:91], v[48:63]
  ds_read_b128 a[112:115], v125 offset:28672
  v_exp_f32 v103, v47
  v_add_f32 v15, v15, v100
  v_add_f32 v16, v16, v101
  v_cvt_pk_bf16_f32 v86, v100, v101
  v_add_f32 v15, v15, v102
  v_add_f32 v16, v16, v103
  v_cvt_pk_bf16_f32 v87, v102, v103
  v_add_f32 v15, v15, v16
  v_cmp_gt_f32 vcc, v15, v11
  v_mfma_f32_32x32x16_bf16 v[48:63], a[124:127], a[92:95], v[48:63]
  ds_read_b128 a[116:119], v125 offset:29696
  s_cbranch_vccnz A_SLOW45
A_RET46:
  s_waitcnt lgkmcnt(5)
  v_mfma_f32_32x32x16_bf16 a[0:15], a[96:99], v[80:83], a[0:15]
  ds_read_b128 a[120:123], v125 offset:30720
  v_add_f32 v10, v10, v15
  s_add_u32 s43, s43, 0x8000
  s_and_b32 s43, s43, 0x1ffff
  s_waitcnt lgkmcnt(5)
  v_mfma_f32_32x32x16_bf16 a[16:31], a[100:103], v[80:83], a[16:31]
  ds_read_b128 a[124:127], v125 offset:31744
  s_waitcnt lgkmcnt(4)
  v_mfma_f32_32x32x16_bf16 a[32:47], a[104:107], v[80:83], a[32:47]
  ds_read_b128 a[96:99], v125 offset:8192
  v_cmp_lt_i32 s[56:57], v13, 0
  v_cmp_lt_i32 s[58:59], v13, 1
  v_cmp_lt_i32 s[60:61], v13, 2
  v_cmp_lt_i32 s[62:63], v13, 3
  v_cndmask_b32 v48, v48, v14, s[56:57]
  v_cndmask_b32 v49, v49, v14, s[58:59]
  v_cndmask_b32 v50, v50, v14, s[60:61]
  v_mfma_f32_32x32x16_bf16 a[48:63], a[108:111], v[80:83], a[48:63]
  ds_read_b128 a[100:103], v125 offset:9216
  v_cndmask_b32 v51, v51, v14, s[62:63]
  v_cmp_lt_i32 s[56:57], v13, 8
  v_cmp_lt_i32 s[58:59], v13, 9
  v_cmp_lt_i32 s[60:61], v13, 10
  v_cmp_lt_i32 s[62:63], v13, 11
  v_cndmask_b32 v52, v52, v14, s[56:57]
  v_cndmask_b32 v53, v53, v14, s[58:59]
  s_waitcnt lgkmcnt(4)
  v_mfma_f32_32x32x16_bf16 a[0:15], a[112:115], v[84:87], a[0:15]
  ds_read_b128 a[104:107], v125 offset:10240
  v_cndmask_b32 v54, v54, v14, s[60:61]
  v_cndmask_b32 v55, v55, v14, s[62:63]
  v_cmp_lt_i32 s[56:57], v13, 16
  v_cmp_lt_i32 s[58:59], v13, 17
  v_cmp_lt_i32 s[60:61], v13, 18
  v_cmp_lt_i32 s[62:63], v13, 19
  v_cndmask_b32 v56, v56, v14, s[56:57]
  v_mfma_f32_32x32x16_bf16 a[16:31], a[116:119], v[84:87], a[16:31]
  ds_read_b128 a[108:111], v125 offset:11264
  v_cndmask_b32 v57, v57, v14, s[58:59]
  v_cndmask_b32 v58, v58, v14, s[60:61]
  v_cndmask_b32 v59, v59, v14, s[62:63]
  v_cmp_lt_i32 s[56:57], v13, 24
  v_cmp_lt_i32 s[58:59], v13, 25
  v_cmp_lt_i32 s[60:61], v13, 26
  v_cmp_lt_i32 s[62:63], v13, 27
  s_waitcnt lgkmcnt(4)
  v_mfma_f32_32x32x16_bf16 a[32:47], a[120:123], v[84:87], a[32:47]
  ds_read_b128 a[112:115], v125 offset:12288
  v_cndmask_b32 v60, v60, v14, s[56:57]
  v_cndmask_b32 v61, v61, v14, s[58:59]
  v_cndmask_b32 v62, v62, v14, s[60:61]
  v_cndmask_b32 v63, v63, v14, s[62:63]
  v_subrev_u32 v13, 32, v13
  v_exp_f32 v96, v48
  v_mfma_f32_32x32x16_bf16 a[48:63], a[124:127], v[84:87], a[48:63]
  ds_read_b128 a[116:119], v125 offset:13312
  v_exp_f32 v97, v49
  v_exp_f32 v98, v50
  v_exp_f32 v99, v51
  v_mov_b32 v15, v96
  s_waitcnt lgkmcnt(4)
  v_mfma_f32_32x32x16_bf16 v[32:47], a[96:99], a[64:67], v[64:79]
  ds_read_b128 a[120:123], v125 offset:14336
  v_mov_b32 v16, v97
  v_cvt_pk_bf16_f32 v88, v96, v97
  v_exp_f32 v100, v52
  v_exp_f32 v101, v53
  v_add_f32 v15, v15, v98
  v_mfma_f32_32x32x16_bf16 v[32:47], a[100:103], a[68:71], v[32:47]
  ds_read_b128 a[124:127], v125 offset:15360
  v_add_f32 v16, v16, v99
  v_cvt_pk_bf16_f32 v89, v98, v99
  v_exp_f32 v102, v54
  v_exp_f32 v103, v55
  v_add_f32 v15, v15, v100
  s_waitcnt lgkmcnt(4)
  v_mfma_f32_32x32x16_bf16 v[32:47], a[104:107], a[72:75], v[32:47]
  v_add_u32 v125, s43, v2
  ds_read_b128 a[96:99], v125 offset:16384
  v_add_f32 v16, v16, v101
  v_cvt_pk_bf16_f32 v90, v100, v101
  v_exp_f32 v96, v56
  v_exp_f32 v97, v57
  v_add_f32 v15, v15, v102
  v_mfma_f32_32x32x16_bf16 v[32:47], a[108:111], a[76:79], v[32:47]
  ds_read_b128 a[100:103], v125 offset:17408
  v_add_f32 v16, v16, v103
  v_cvt_pk_bf16_f32 v91, v102, v103
  v_exp_f32 v98, v58
  v_exp_f32 v99, v59
  v_add_f32 v15, v15, v96
  s_waitcnt lgkmcnt(4)
  v_mfma_f32_32x32x16_bf16 v[32:47], a[112:115], a[80:83], v[32:47]
  ds_read_b128 a[104:107], v125 offset:18432
  v_add_f32 v16, v16, v97
  v_cvt_pk_bf16_f32 v92, v96, v97
  v_exp_f32 v100, v60
  v_exp_f32 v101, v61
  v_add_f32 v15, v15, v98
  v_mfma_f32_32x32x16_bf16 v[32:47], a[116:119], a[84:87], v[32:47]
  ds_read_b128 a[108:111], v125 offset:19456
  v_add_f32 v16, v16, v99
  v_cvt_pk_bf16_f32 v93, v98, v99
  v_exp_f32 v102, v62
  v_exp_f32 v103, v63
  v_add_f32 v15, v15, v100
  s_waitcnt lgkmcnt(4)
  v_mfma_f32_32x32x16_bf16 v[32:47], a[120:123], a[88:91], v[32:47]
  ds_read_b128 a[112:115], v125 offset:20480
  v_add_f32 v16, v16, v101
  v_cvt_pk_bf16_f32 v94, v100, v101
  v_add_f32 v15, v15, v102
  v_add_f32 v16, v16, v103
  v_cvt_pk_bf16_f32 v95, v102, v103
  v_add_f32 v15, v15, v16
  v_cmp_gt_f32 vcc, v15, v11
  v_mfma_f32_32x32x16_bf16 v[32:47], a[124:127], a[92:95], v[32:47]
  ds_read_b128 a[116:119], v125 offset:21504
  s_cbranch_vccnz A_SLOW47
A_RET48:
  s_sub_u32 s45, s95, s94
  s_lshr_b32 s45, s45, 1
  s_add_u32 s45, s45, 1
  s_cmp_eq_u32 s94, 4
  s_cbranch_scc1 A_PF
  s_sub_u32 s6, s94, 6
  s_lshl_b32 s6, s6, 5
  v_subrev_u32 v13, s6, v13
  s_lshr_b32 s44, s94, 1
  s_sub_u32 s44, s44, 3
A_LOOP:
  s_waitcnt lgkmcnt(5)
  v_mfma_f32_32x32x16_bf16 a[0:15], a[96:99], v[88:91], a[0:15]
  ds_read_b128 a[120:123], v125 offset:22528
  v_add_f32 v10, v10, v15
  s_waitcnt vmcnt(8)
  s_barrier
  s_waitcnt lgkmcnt(5)
  v_mfma_f32_32x32x16_bf16 a[16:31], a[100:103], v[88:91], a[16:31]
  ds_read_b128 a[124:127], v125 offset:23552
  s_cmp_lg_u32 s39, 0
  s_cbranch_scc1 A_ND49
  s_mov_b32 m0, s42
  s_nop 0
  buffer_load_dwordx4 v124, s[8:11], s40 offen sc1 lds
  buffer_load_dwordx4 v124, s[8:11], s40 offen offset:1024 sc1 lds
  buffer_load_dwordx4 v124, s[8:11], s40 offen offset:2048 sc1 lds
  buffer_load_dwordx4 v124, s[8:11], s40 offen offset:3072 sc1 lds
  s_add_u32 m0, s42, 0x4000
  s_nop 0
  buffer_load_dwordx4 v124, s[8:11], s41 offen sc1 lds
  buffer_load_dwordx4 v124, s[8:11], s41 offen offset:1024 sc1 lds
  buffer_load_dwordx4 v124, s[8:11], s41 offen offset:2048 sc1 lds
  buffer_load_dwordx4 v124, s[8:11], s41 offen offset:3072 sc1 lds
  s_add_u32 s40, s40, 0x4000
  s_add_u32 s41, s41, 0x4000
  s_add_u32 s42, s42, 0x8000
  s_and_b32 s42, s42, 0x1ffff
  s_add_u32 s20, s20, 1
  s_cmp_eq_u32 s20, s21
  s_cselect_b32 s40, s22, s40
  s_sub_u32 s6, s20, 1
  s_cmp_eq_u32 s6, s21
  s_cselect_b32 s40, s23, s40
  s_sub_u32 s6, s20, 2
  s_cmp_eq_u32 s6, s21
  s_cselect_b32 s40, s24, s40
  s_add_u32 s6, s40, 0x4000
  s_cmp_gt_u32 s20, s21
  s_cselect_b32 s41, s6, s41
A_ND49:
  s_waitcnt lgkmcnt(4)
  v_mfma_f32_32x32x16_bf16 a[32:47], a[104:107], v[88:91], a[32:47]
  ds_read_b128 a[96:99], v125
  v_exp_f32 v96, v32
  v_exp_f32 v97, v33
  v_mfma_f32_32x32x16_bf16 a[48:63], a[108:111], v[88:91], a[48:63]
  ds_read_b128 a[100:103], v125 offset:1024
  v_exp_f32 v98, v34
  v_exp_f32 v99, v35
  v_mov_b32 v15, v96
  s_waitcnt lgkmcnt(4)
  v_mfma_f32_32x32x16_bf16 a[0:15], a[112:115], v[92:95], a[0:15]
  ds_read_b128 a[104:107], v125 offset:2048
  v_mov_b32 v16, v97
  v_cvt_pk_bf16_f32 v80, v96, v97
  v_exp_f32 v100, v36
  v_mfma_f32_32x32x16_bf16 a[16:31], a[116:119], v[92:95], a[16:31]
  ds_read_b128 a[108:111], v125 offset:3072
  v_exp_f32 v101, v37
  v_add_f32 v15, v15, v98
  v_add_f32 v16, v16, v99
  v_cvt_pk_bf16_f32 v81, v98, v99
  s_waitcnt lgkmcnt(4)
  v_mfma_f32_32x32x16_bf16 a[32:47], a[120:123], v[92:95], a[32:47]
  ds_read_b128 a[112:115], v125 offset:4096
  v_exp_f32 v102, v38
  v_exp_f32 v103, v39
  v_mfma_f32_32x32x16_bf16 a[48:63], a[124:127], v[92:95], a[48:63]
  ds_read_b128 a[116:119], v125 offset:5120
  v_add_f32 v15, v15, v100
  v_add_f32 v16, v16, v101
  v_cvt_pk_bf16_f32 v82, v100, v101
  v_exp_f32 v96, v40
  s_waitcnt lgkmcnt(4)
  v_mfma_f32_32x32x16_bf16 v[48:63], a[96:99], a[64:67], v[64:79]
  ds_read_b128 a[120:123], v125 offset:6144
  v_exp_f32 v97, v41
  v_add_f32 v15, v15, v102
  v_add_f32 v16, v16, v103
  v_mfma_f32_32x32x16_bf16 v[48:63], a[100:103], a[68:71], v[48:63]
  ds_read_b128 a[124:127], v125 offset:7168
  v_cvt_pk_bf16_f32 v83, v102, v103
  v_exp_f32 v98, v42
  v_exp_f32 v99, v43
  s_waitcnt lgkmcnt(4)
  v_mfma_f32_32x32x16_bf16 v[48:63], a[104:107], a[72:75], v[48:63]
  ds_read_b128 a[96:99], v125 offset:24576
  v_add_f32 v15, v15, v96
  v_add_f32 v16, v16, v97
  v_cvt_pk_bf16_f32 v84, v96, v97
  v_exp_f32 v100, v44
  v_mfma_f32_32x32x16_bf16 v[48:63], a[108:111], a[76:79], v[48:63]
  ds_read_b128 a[100:103], v125 offset:25600
  v_exp_f32 v101, v45
  v_add_f32 v15, v15, v98
  v_add_f32 v16, v16, v99
  s_waitcnt lgkmcnt(4)
  v_mfma_f32_32x32x16_bf16 v[48:63], a[112:115], a[80:83], v[48:63]
  ds_read_b128 a[104:107], v125 offset:26624
  v_cvt_pk_bf16_f32 v85, v98, v99
  v_exp_f32 v102, v46
  v_exp_f32 v103, v47
  v_mfma_f32_32x32x16_bf16 v[48:63], a[116:119], a[84:87], v[48:63]
  ds_read_b128 a[108:111], v125 offset:27648
  v_add_f32 v15, v15, v100
  v_add_f32 v16, v16, v101
  v_cvt_pk_bf16_f32 v86, v100, v101
  v_add_f32 v15, v15, v102
  s_waitcnt lgkmcnt(4)
  v_mfma_f32_32x32x16_bf16 v[48:63], a[120:123], a[88:91], v[48:63]
  ds_read_b128 a[112:115], v125 offset:28672
  v_add_f32 v16, v16, v103
  v_cvt_pk_bf16_f32 v87, v102, v103
  v_add_f32 v15, v15, v16
  v_cmp_gt_f32 vcc, v15, v11
  v_mfma_f32_32x32x16_bf16 v[48:63], a[124:127], a[92:95], v[48:63]
  ds_read_b128 a[116:119], v125 offset:29696
  s_cbranch_vccnz A_SLOW50
A_RET51:
  s_waitcnt lgkmcnt(5)
  v_mfma_f32_32x32x16_bf16 a[0:15], a[96:99], v[80:83], a[0:15]
  ds_read_b128 a[120:123], v125 offset:30720
  v_add_f32 v10, v10, v15
  s_add_u32 s43, s43, 0x8000
  s_and_b32 s43, s43, 0x1ffff
  s_waitcnt lgkmcnt(5)
  v_mfma_f32_32x32x16_bf16 a[16:31], a[100:103], v[80:83], a[16:31]
  ds_read_b128 a[124:127], v125 offset:31744
  s_sub_u32 s44, s44, 1
  s_cmp_lg_u32 s44, 0
  s_waitcnt lgkmcnt(4)
  v_mfma_f32_32x32x16_bf16 a[32:47], a[104:107], v[80:83], a[32:47]
  ds_read_b128 a[96:99], v125 offset:8192
  v_exp_f32 v96, v48
  v_exp_f32 v97, v49
  v_mfma_f32_32x32x16_bf16 a[48:63], a[108:111], v[80:83], a[48:63]
  ds_read_b128 a[100:103], v125 offset:9216
  v_exp_f32 v98, v50
  v_exp_f32 v99, v51
  v_mov_b32 v15, v96
  s_waitcnt lgkmcnt(4)
  v_mfma_f32_32x32x16_bf16 a[0:15], a[112:115], v[84:87], a[0:15]
  ds_read_b128 a[104:107], v125 offset:10240
  v_mov_b32 v16, v97
  v_cvt_pk_bf16_f32 v88, v96, v97
  v_exp_f32 v100, v52
  v_mfma_f32_32x32x16_bf16 a[16:31], a[116:119], v[84:87], a[16:31]
  ds_read_b128 a[108:111], v125 offset:11264
  v_exp_f32 v101, v53
  v_add_f32 v15, v15, v98
  v_add_f32 v16, v16, v99
  v_cvt_pk_bf16_f32 v89, v98, v99
  s_waitcnt lgkmcnt(4)
  v_mfma_f32_32x32x16_bf16 a[32:47], a[120:123], v[84:87], a[32:47]
  ds_read_b128 a[112:115], v125 offset:12288
  v_exp_f32 v102, v54
  v_exp_f32 v103, v55
  v_mfma_f32_32x32x16_bf16 a[48:63], a[124:127], v[84:87], a[48:63]
  ds_read_b128 a[116:119], v125 offset:13312
  v_add_f32 v15, v15, v100
  v_add_f32 v16, v16, v101
  v_cvt_pk_bf16_f32 v90, v100, v101
  v_exp_f32 v96, v56
  s_waitcnt lgkmcnt(4)
  v_mfma_f32_32x32x16_bf16 v[32:47], a[96:99], a[64:67], v[64:79]
  ds_read_b128 a[120:123], v125 offset:14336
  v_exp_f32 v97, v57
  v_add_f32 v15, v15, v102
  v_add_f32 v16, v16, v103
  v_mfma_f32_32x32x16_bf16 v[32:47], a[100:103], a[68:71], v[32:47]
  ds_read_b128 a[124:127], v125 offset:15360
  v_cvt_pk_bf16_f32 v91, v102, v103
  v_exp_f32 v98, v58
  v_exp_f32 v99, v59
  s_waitcnt lgkmcnt(4)
  v_mfma_f32_32x32x16_bf16 v[32:47], a[104:107], a[72:75], v[32:47]
  v_add_u32 v125, s43, v2
  ds_read_b128 a[96:99], v125 offset:16384
  v_add_f32 v15, v15, v96
  v_add_f32 v16, v16, v97
  v_cvt_pk_bf16_f32 v92, v96, v97
  v_exp_f32 v100, v60
  v_mfma_f32_32x32x16_bf16 v[32:47], a[108:111], a[76:79], v[32:47]
  ds_read_b128 a[100:103], v125 offset:17408
  v_exp_f32 v101, v61
  v_add_f32 v15, v15, v98
  v_add_f32 v16, v16, v99
  s_waitcnt lgkmcnt(4)
  v_mfma_f32_32x32x16_bf16 v[32:47], a[112:115], a[80:83], v[32:47]
  ds_read_b128 a[104:107], v125 offset:18432
  v_cvt_pk_bf16_f32 v93, v98, v99
  v_exp_f32 v102, v62
  v_exp_f32 v103, v63
  v_mfma_f32_32x32x16_bf16 v[32:47], a[116:119], a[84:87], v[32:47]
  ds_read_b128 a[108:111], v125 offset:19456
  v_add_f32 v15, v15, v100
  v_add_f32 v16, v16, v101
  v_cvt_pk_bf16_f32 v94, v100, v101
  v_add_f32 v15, v15, v102
  s_waitcnt lgkmcnt(4)
  v_mfma_f32_32x32x16_bf16 v[32:47], a[120:123], a[88:91], v[32:47]
  ds_read_b128 a[112:115], v125 offset:20480
  v_add_f32 v16, v16, v103
  v_cvt_pk_bf16_f32 v95, v102, v103
  v_add_f32 v15, v15, v16
  v_cmp_gt_f32 vcc, v15, v11
  v_mfma_f32_32x32x16_bf16 v[32:47], a[124:127], a[92:95], v[32:47]
  ds_read_b128 a[116:119], v125 offset:21504
  s_cbranch_vccnz A_SLOW52
A_RET53:
  s_cbranch_scc1 A_LOOP
  s_cmp_eq_u32 s91, 0
  s_cbranch_scc1 A_E0
  s_waitcnt lgkmcnt(5)
  v_mfma_f32_32x32x16_bf16 a[0:15], a[96:99], v[88:91], a[0:15]
  ds_read_b128 a[120:123], v125 offset:22528
  v_add_f32 v10, v10, v15
  s_waitcnt vmcnt(8)
  s_barrier
  s_waitcnt lgkmcnt(5)
  v_mfma_f32_32x32x16_bf16 a[16:31], a[100:103], v[88:91], a[16:31]
  ds_read_b128 a[124:127], v125 offset:23552
  s_cmp_lg_u32 s39, 0
  s_cbranch_scc1 A_ND54
  s_mov_b32 m0, s42
  s_nop 0
  buffer_load_dwordx4 v124, s[8:11], s40 offen sc1 lds
  buffer_load_dwordx4 v124, s[8:11], s40 offen offset:1024 sc1 lds
  buffer_load_dwordx4 v124, s[8:11], s40 offen offset:2048 sc1 lds
  buffer_load_dwordx4 v124, s[8:11], s40 offen offset:3072 sc1 lds
  s_add_u32 m0, s42, 0x4000
  s_nop 0
  buffer_load_dwordx4 v124, s[8:11], s41 offen sc1 lds
  buffer_load_dwordx4 v124, s[8:11], s41 offen offset:1024 sc1 lds
  buffer_load_dwordx4 v124, s[8:11], s41 offen offset:2048 sc1 lds
  buffer_load_dwordx4 v124, s[8:11], s41 offen offset:3072 sc1 lds
  s_add_u32 s40, s40, 0x4000
  s_add_u32 s41, s41, 0x4000
  s_add_u32 s42, s42, 0x8000
  s_and_b32 s42, s42, 0x1ffff
  s_add_u32 s20, s20, 1
  s_cmp_eq_u32 s20, s21
  s_cselect_b32 s40, s22, s40
  s_sub_u32 s6, s20, 1
  s_cmp_eq_u32 s6, s21
  s_cselect_b32 s40, s23, s40
  s_sub_u32 s6, s20, 2
  s_cmp_eq_u32 s6, s21
  s_cselect_b32 s40, s24, s40
  s_add_u32 s6, s40, 0x4000
  s_cmp_gt_u32 s20, s21
  s_cselect_b32 s41, s6, s41
A_ND54:
  s_waitcnt lgkmcnt(4)
  v_mfma_f32_32x32x16_bf16 a[32:47], a[104:107], v[88:91], a[32:47]
  ds_read_b128 a[96:99], v125
  v_cmp_lt_i32 s[56:57], v13, 0
  v_cmp_lt_i32 s[58:59], v13, 1
  v_cmp_lt_i32 s[60:61], v13, 2
  v_cmp_lt_i32 s[62:63], v13, 3
  v_cndmask_b32 v32, v32, v14, s[56:57]
  v_cndmask_b32 v33, v33, v14, s[58:59]
  v_cndmask_b32 v34, v34, v14, s[60:61]
  v_mfma_f32_32x32x16_bf16 a[48:63], a[108:111], v[88:91], a[48:63]
  ds_read_b128 a[100:103], v125 offset:1024
  v_cndmask_b32 v35, v35, v14, s[62:63]
  v_cmp_lt_i32 s[56:57], v13, 8
  v_cmp_lt_i32 s[58:59], v13, 9
  v_cmp_lt_i32 s[60:61], v13, 10
  v_cmp_lt_i32 s[62:63], v13, 11
  v_cndmask_b32 v36, v36, v14, s[56:57]
  v_cndmask_b32 v37, v37, v14, s[58:59]
  s_waitcnt lgkmcnt(4)
  v_mfma_f32_32x32x16_bf16 a[0:15], a[112:115], v[92:95], a[0:15]
  ds_read_b128 a[104:107], v125 offset:2048
  v_cndmask_b32 v38, v38, v14, s[60:61]
  v_cndmask_b32 v39, v39, v14, s[62:63]
  v_cmp_lt_i32 s[56:57], v13, 16
  v_cmp_lt_i32 s[58:59], v13, 17
  v_cmp_lt_i32 s[60:61], v13, 18
  v_cmp_lt_i32 s[62:63], v13, 19
  v_cndmask_b32 v40, v40, v14, s[56:57]
  v_mfma_f32_32x32x16_bf16 a[16:31], a[116:119], v[92:95], a[16:31]
  ds_read_b128 a[108:111], v125 offset:3072
  v_cndmask_b32 v41, v41, v14, s[58:59]
  v_cndmask_b32 v42, v42, v14, s[60:61]
  v_cndmask_b32 v43, v43, v14, s[62:63]
  v_cmp_lt_i32 s[56:57], v13, 24
  v_cmp_lt_i32 s[58:59], v13, 25
  v_cmp_lt_i32 s[60:61], v13, 26
  v_cmp_lt_i32 s[62:63], v13, 27
  s_waitcnt lgkmcnt(4)
  v_mfma_f32_32x32x16_bf16 a[32:47], a[120:123], v[92:95], a[32:47]
  ds_read_b128 a[112:115], v125 offset:4096
  v_cndmask_b32 v44, v44, v14, s[56:57]
  v_cndmask_b32 v45, v45, v14, s[58:59]
  v_cndmask_b32 v46, v46, v14, s[60:61]
  v_cndmask_b32 v47, v47, v14, s[62:63]
  v_subrev_u32 v13, 32, v13
  v_exp_f32 v96, v32
  v_mfma_f32_32x32x16_bf16 a[48:63], a[124:127], v[92:95], a[48:63]
  ds_read_b128 a[116:119], v125 offset:5120
  v_exp_f32 v97, v33
  v_exp_f32 v98, v34
  v_exp_f32 v99, v35
  v_mov_b32 v15, v96
  s_waitcnt lgkmcnt(4)
  v_mfma_f32_32x32x16_bf16 v[48:63], a[96:99], a[64:67], v[64:79]
  ds_read_b128 a[120:123], v125 offset:6144
  v_mov_b32 v16, v97
  v_cvt_pk_bf16_f32 v80, v96, v97
  v_exp_f32 v100, v36
  v_exp_f32 v101, v37
  v_add_f32 v15, v15, v98
  v_mfma_f32_32x32x16_bf16 v[48:63], a[100:103], a[68:71], v[48:63]
  ds_read_b128 a[124:127], v125 offset:7168
  v_add_f32 v16, v16, v99
  v_cvt_pk_bf16_f32 v81, v98, v99
  v_exp_f32 v102, v38
  v_exp_f32 v103, v39
  v_add_f32 v15, v15, v100
  s_waitcnt lgkmcnt(4)
  v_mfma_f32_32x32x16_bf16 v[48:63], a[104:107], a[72:75], v[48:63]
  ds_read_b128 a[96:99], v125 offset:24576
  v_add_f32 v16, v16, v101
  v_cvt_pk_bf16_f32 v82, v100, v101
  v_exp_f32 v96, v40
  v_exp_f32 v97, v41
  v_add_f32 v15, v15, v102
  v_mfma_f32_32x32x16_bf16 v[48:63], a[108:111], a[76:79], v[48:63]
  ds_read_b128 a[100:103], v125 offset:25600
  v_add_f32 v16, v16, v103
  v_cvt_pk_bf16_f32 v83, v102, v103
  v_exp_f32 v98, v42
  v_exp_f32 v99, v43
  v_add_f32 v15, v15, v96
  s_waitcnt lgkmcnt(4)
  v_mfma_f32_32x32x16_bf16 v[48:63], a[112:115], a[80:83], v[48:63]
  ds_read_b128 a[104:107], v125 offset:26624
  v_add_f32 v16, v16, v97
  v_cvt_pk_bf16_f32 v84, v96, v97
  v_exp_f32 v100, v44
  v_exp_f32 v101, v45
  v_add_f32 v15, v15, v98
  v_mfma_f32_32x32x16_bf16 v[48:63], a[116:119], a[84:87], v[48:63]
  ds_read_b128 a[108:111], v125 offset:27648
  v_add_f32 v16, v16, v99
  v_cvt_pk_bf16_f32 v85, v98, v99
  v_exp_f32 v102, v46
  v_exp_f32 v103, v47
  v_add_f32 v15, v15, v100
  s_waitcnt lgkmcnt(4)
  v_mfma_f32_32x32x16_bf16 v[48:63], a[120:123], a[88:91], v[48:63]
  ds_read_b128 a[112:115], v125 offset:28672
  v_add_f32 v16, v16, v101
  v_cvt_pk_bf16_f32 v86, v100, v101
  v_add_f32 v15, v15, v102
  v_add_f32 v16, v16, v103
  v_cvt_pk_bf16_f32 v87, v102, v103
  v_add_f32 v15, v15, v16
  v_cmp_gt_f32 vcc, v15, v11
  v_mfma_f32_32x32x16_bf16 v[48:63], a[124:127], a[92:95], v[48:63]
  ds_read_b128 a[116:119], v125 offset:29696
  s_cbranch_vccnz A_SLOW55
A_RET56:
  s_cmp_eq_u32 s91, 1
  s_cbranch_scc1 A_E1
  s_waitcnt lgkmcnt(5)
  v_mfma_f32_32x32x16_bf16 a[0:15], a[96:99], v[80:83], a[0:15]
  ds_read_b128 a[120:123], v125 offset:30720
  v_add_f32 v10, v10, v15
  s_add_u32 s43, s43, 0x8000
  s_and_b32 s43, s43, 0x1ffff
  s_waitcnt lgkmcnt(5)
  v_mfma_f32_32x32x16_bf16 a[16:31], a[100:103], v[80:83], a[16:31]
  ds_read_b128 a[124:127], v125 offset:31744
  s_waitcnt lgkmcnt(4)
  v_mfma_f32_32x32x16_bf16 a[32:47], a[104:107], v[80:83], a[32:47]
  ds_read_b128 a[96:99], v125 offset:8192
  v_cmp_lt_i32 s[56:57], v13, 0
  v_cmp_lt_i32 s[58:59], v13, 1
  v_cmp_lt_i32 s[60:61], v13, 2
  v_cmp_lt_i32 s[62:63], v13, 3
  v_cndmask_b32 v48, v48, v14, s[56:57]
  v_cndmask_b32 v49, v49, v14, s[58:59]
  v_cndmask_b32 v50, v50, v14, s[60:61]
  v_mfma_f32_32x32x16_bf16 a[48:63], a[108:111], v[80:83], a[48:63]
  ds_read_b128 a[100:103], v125 offset:9216
  v_cndmask_b32 v51, v51, v14, s[62:63]
  v_cmp_lt_i32 s[56:57], v13, 8
  v_cmp_lt_i32 s[58:59], v13, 9
  v_cmp_lt_i32 s[60:61], v13, 10
  v_cmp_lt_i32 s[62:63], v13, 11
  v_cndmask_b32 v52, v52, v14, s[56:57]
  v_cndmask_b32 v53, v53, v14, s[58:59]
  s_waitcnt lgkmcnt(4)
  v_mfma_f32_32x32x16_bf16 a[0:15], a[112:115], v[84:87], a[0:15]
  ds_read_b128 a[104:107], v125 offset:10240
  v_cndmask_b32 v54, v54, v14, s[60:61]
  v_cndmask_b32 v55, v55, v14, s[62:63]
  v_cmp_lt_i32 s[56:57], v13, 16
  v_cmp_lt_i32 s[58:59], v13, 17
  v_cmp_lt_i32 s[60:61], v13, 18
  v_cmp_lt_i32 s[62:63], v13, 19
  v_cndmask_b32 v56, v56, v14, s[56:57]
  v_mfma_f32_32x32x16_bf16 a[16:31], a[116:119], v[84:87], a[16:31]
  ds_read_b128 a[108:111], v125 offset:11264
  v_cndmask_b32 v57, v57, v14, s[58:59]
  v_cndmask_b32 v58, v58, v14, s[60:61]
  v_cndmask_b32 v59, v59, v14, s[62:63]
  v_cmp_lt_i32 s[56:57], v13, 24
  v_cmp_lt_i32 s[58:59], v13, 25
  v_cmp_lt_i32 s[60:61], v13, 26
  v_cmp_lt_i32 s[62:63], v13, 27
  s_waitcnt lgkmcnt(4)
  v_mfma_f32_32x32x16_bf16 a[32:47], a[120:123], v[84:87], a[32:47]
  ds_read_b128 a[112:115], v125 offset:12288
  v_cndmask_b32 v60, v60, v14, s[56:57]
  v_cndmask_b32 v61, v61, v14, s[58:59]
  v_cndmask_b32 v62, v62, v14, s[60:61]
  v_cndmask_b32 v63, v63, v14, s[62:63]
  v_subrev_u32 v13, 32, v13
  v_exp_f32 v96, v48
  v_mfma_f32_32x32x16_bf16 a[48:63], a[124:127], v[84:87], a[48:63]
  ds_read_b128 a[116:119], v125 offset:13312
  v_exp_f32 v97, v49
  v_exp_f32 v98, v50
  v_exp_f32 v99, v51
  v_mov_b32 v15, v96
  s_waitcnt lgkmcnt(4)
  v_mfma_f32_32x32x16_bf16 v[32:47], a[96:99], a[64:67], v[64:79]
  ds_read_b128 a[120:123], v125 offset:14336
  v_mov_b32 v16, v97
  v_cvt_pk_bf16_f32 v88, v96, v97
  v_exp_f32 v100, v52
  v_exp_f32 v101, v53
  v_add_f32 v15, v15, v98
  v_mfma_f32_32x32x16_bf16 v[32:47], a[100:103], a[68:71], v[32:47]
  ds_read_b128 a[124:127], v125 offset:15360
  v_add_f32 v16, v16, v99
  v_cvt_pk_bf16_f32 v89, v98, v99
  v_exp_f32 v102, v54
  v_exp_f32 v103, v55
  v_add_f32 v15, v15, v100
  s_waitcnt lgkmcnt(4)
  v_mfma_f32_32x32x16_bf16 v[32:47], a[104:107], a[72:75], v[32:47]
  v_add_u32 v125, s43, v2
  ds_read_b128 a[96:99], v125 offset:16384
  v_add_f32 v16, v16, v101
  v_cvt_pk_bf16_f32 v90, v100, v101
  v_exp_f32 v96, v56
  v_exp_f32 v97, v57
  v_add_f32 v15, v15, v102
  v_mfma_f32_32x32x16_bf16 v[32:47], a[108:111], a[76:79], v[32:47]
  ds_read_b128 a[100:103], v125 offset:17408
  v_add_f32 v16, v16, v103
  v_cvt_pk_bf16_f32 v91, v102, v103
  v_exp_f32 v98, v58
  v_exp_f32 v99, v59
  v_add_f32 v15, v15, v96
  s_waitcnt lgkmcnt(4)
  v_mfma_f32_32x32x16_bf16 v[32:47], a[112:115], a[80:83], v[32:47]
  ds_read_b128 a[104:107], v125 offset:18432
  v_add_f32 v16, v16, v97
  v_cvt_pk_bf16_f32 v92, v96, v97
  v_exp_f32 v100, v60
  v_exp_f32 v101, v61
  v_add_f32 v15, v15, v98
  v_mfma_f32_32x32x16_bf16 v[32:47], a[116:119], a[84:87], v[32:47]
  ds_read_b128 a[108:111], v125 offset:19456
  v_add_f32 v16, v16, v99
  v_cvt_pk_bf16_f32 v93, v98, v99
  v_exp_f32 v102, v62
  v_exp_f32 v103, v63
  v_add_f32 v15, v15, v100
  s_waitcnt lgkmcnt(4)
  v_mfma_f32_32x32x16_bf16 v[32:47], a[120:123], a[88:91], v[32:47]
  ds_read_b128 a[112:115], v125 offset:20480
  v_add_f32 v16, v16, v101
  v_cvt_pk_bf16_f32 v94, v100, v101
  v_add_f32 v15, v15, v102
  v_add_f32 v16, v16, v103
  v_cvt_pk_bf16_f32 v95, v102, v103
  v_add_f32 v15, v15, v16
  v_cmp_gt_f32 vcc, v15, v11
  v_mfma_f32_32x32x16_bf16 v[32:47], a[124:127], a[92:95], v[32:47]
  ds_read_b128 a[116:119], v125 offset:21504
  s_cbranch_vccnz A_SLOW57
A_RET58:
A_PF:
  s_sub_u32 s45, s45, 1
  s_cmp_le_u32 s91, 2
  s_cbranch_scc1 A_E0
  s_waitcnt lgkmcnt(5)
  v_mfma_f32_32x32x16_bf16 a[0:15], a[96:99], v[88:91], a[0:15]
  ds_read_b128 a[120:123], v125 offset:22528
  v_add_f32 v10, v10, v15
  s_waitcnt vmcnt(8)
  s_barrier
  s_waitcnt lgkmcnt(5)
  v_mfma_f32_32x32x16_bf16 a[16:31], a[100:103], v[88:91], a[16:31]
  ds_read_b128 a[124:127], v125 offset:23552
  s_cmp_lg_u32 s39, 0
  s_cbranch_scc1 A_ND59
  s_mov_b32 m0, s42
  s_nop 0
  buffer_load_dwordx4 v124, s[8:11], s40 offen sc1 lds
  buffer_load_dwordx4 v124, s[8:11], s40 offen offset:1024 sc1 lds
  buffer_load_dwordx4 v124, s[8:11], s40 offen offset:2048 sc1 lds
  buffer_load_dwordx4 v124, s[8:11], s40 offen offset:3072 sc1 lds
  s_add_u32 m0, s42, 0x4000
  s_nop 0
  buffer_load_dwordx4 v124, s[8:11], s41 offen sc1 lds
  buffer_load_dwordx4 v124, s[8:11], s41 offen offset:1024 sc1 lds
  buffer_load_dwordx4 v124, s[8:11], s41 offen offset:2048 sc1 lds
  buffer_load_dwordx4 v124, s[8:11], s41 offen offset:3072 sc1 lds
  s_add_u32 s40, s40, 0x4000
  s_add_u32 s41, s41, 0x4000
  s_add_u32 s42, s42, 0x8000
  s_and_b32 s42, s42, 0x1ffff
  s_add_u32 s20, s20, 1
  s_cmp_eq_u32 s20, s21
  s_cselect_b32 s40, s22, s40
  s_sub_u32 s6, s20, 1
  s_cmp_eq_u32 s6, s21
  s_cselect_b32 s40, s23, s40
  s_sub_u32 s6, s20, 2
  s_cmp_eq_u32 s6, s21
  s_cselect_b32 s40, s24, s40
  s_add_u32 s6, s40, 0x4000
  s_cmp_gt_u32 s20, s21
  s_cselect_b32 s41, s6, s41
A_ND59:
  s_waitcnt lgkmcnt(4)
  v_mfma_f32_32x32x16_bf16 a[32:47], a[104:107], v[88:91], a[32:47]
  ds_read_b128 a[96:99], v125
  v_cmp_lt_i32 s[56:57], v13, 0
  v_cmp_lt_i32 s[58:59], v13, 1
  v_cmp_lt_i32 s[60:61], v13, 2
  v_cmp_lt_i32 s[62:63], v13, 3
  v_cndmask_b32 v32, v32, v14, s[56:57]
  v_cndmask_b32 v33, v33, v14, s[58:59]
  v_cndmask_b32 v34, v34, v14, s[60:61]
  v_mfma_f32_32x32x16_bf16 a[48:63], a[108:111], v[88:91], a[48:63]
  ds_read_b128 a[100:103], v125 offset:1024
  v_cndmask_b32 v35, v35, v14, s[62:63]
  v_cmp_lt_i32 s[56:57], v13, 8
  v_cmp_lt_i32 s[58:59], v13, 9
  v_cmp_lt_i32 s[60:61], v13, 10
  v_cmp_lt_i32 s[62:63], v13, 11
  v_cndmask_b32 v36, v36, v14, s[56:57]
  v_cndmask_b32 v37, v37, v14, s[58:59]
  s_waitcnt lgkmcnt(4)
  v_mfma_f32_32x32x16_bf16 a[0:15], a[112:115], v[92:95], a[0:15]
  ds_read_b128 a[104:107], v125 offset:2048
  v_cndmask_b32 v38, v38, v14, s[60:61]
  v_cndmask_b32 v39, v39, v14, s[62:63]
  v_cmp_lt_i32 s[56:57], v13, 16
  v_cmp_lt_i32 s[58:59], v13, 17
  v_cmp_lt_i32 s[60:61], v13, 18
  v_cmp_lt_i32 s[62:63], v13, 19
  v_cndmask_b32 v40, v40, v14, s[56:57]
  v_mfma_f32_32x32x16_bf16 a[16:31], a[116:119], v[92:95], a[16:31]
  ds_read_b128 a[108:111], v125 offset:3072
  v_cndmask_b32 v41, v41, v14, s[58:59]
  v_cndmask_b32 v42, v42, v14, s[60:61]
  v_cndmask_b32 v43, v43, v14, s[62:63]
  v_cmp_lt_i32 s[56:57], v13, 24
  v_cmp_lt_i32 s[58:59], v13, 25
  v_cmp_lt_i32 s[60:61], v13, 26
  v_cmp_lt_i32 s[62:63], v13, 27
  s_waitcnt lgkmcnt(4)
  v_mfma_f32_32x32x16_bf16 a[32:47], a[120:123], v[92:95], a[32:47]
  ds_read_b128 a[112:115], v125 offset:4096
  v_cndmask_b32 v44, v44, v14, s[56:57]
  v_cndmask_b32 v45, v45, v14, s[58:59]
  v_cndmask_b32 v46, v46, v14, s[60:61]
  v_cndmask_b32 v47, v47, v14, s[62:63]
  v_subrev_u32 v13, 32, v13
  v_exp_f32 v96, v32
  v_mfma_f32_32x32x16_bf16 a[48:63], a[124:127], v[92:95], a[48:63]
  ds_read_b128 a[116:119], v125 offset:5120
  v_exp_f32 v97, v33
  v_exp_f32 v98, v34
  v_exp_f32 v99, v35
  v_mov_b32 v15, v96
  s_waitcnt lgkmcnt(4)
  v_mfma_f32_32x32x16_bf16 v[48:63], a[96:99], a[64:67], v[64:79]
  ds_read_b128 a[120:123], v125 offset:6144
  v_mov_b32 v16, v97
  v_cvt_pk_bf16_f32 v80, v96, v97
  v_exp_f32 v100, v36
  v_exp_f32 v101, v37
  v_add_f32 v15, v15, v98
  v_mfma_f32_32x32x16_bf16 v[48:63], a[100:103], a[68:71], v[48:63]
  ds_read_b128 a[124:127], v125 offset:7168
  v_add_f32 v16, v16, v99
  v_cvt_pk_bf16_f32 v81, v98, v99
  v_exp_f32 v102, v38
  v_exp_f32 v103, v39
  v_add_f32 v15, v15, v100
  s_waitcnt lgkmcnt(4)
  v_mfma_f32_32x32x16_bf16 v[48:63], a[104:107], a[72:75], v[48:63]
  ds_read_b128 a[96:99], v125 offset:24576
  v_add_f32 v16, v16, v101
  v_cvt_pk_bf16_f32 v82, v100, v101
  v_exp_f32 v96, v40
  v_exp_f32 v97, v41
  v_add_f32 v15, v15, v102
  v_mfma_f32_32x32x16_bf16 v[48:63], a[108:111], a[76:79], v[48:63]
  ds_read_b128 a[100:103], v125 offset:25600
  v_add_f32 v16, v16, v103
  v_cvt_pk_bf16_f32 v83, v102, v103
  v_exp_f32 v98, v42
  v_exp_f32 v99, v43
  v_add_f32 v15, v15, v96
  s_waitcnt lgkmcnt(4)
  v_mfma_f32_32x32x16_bf16 v[48:63], a[112:115], a[80:83], v[48:63]
  ds_read_b128 a[104:107], v125 offset:26624
  v_add_f32 v16, v16, v97
  v_cvt_pk_bf16_f32 v84, v96, v97
  v_exp_f32 v100, v44
  v_exp_f32 v101, v45
  v_add_f32 v15, v15, v98
  v_mfma_f32_32x32x16_bf16 v[48:63], a[116:119], a[84:87], v[48:63]
  ds_read_b128 a[108:111], v125 offset:27648
  v_add_f32 v16, v16, v99
  v_cvt_pk_bf16_f32 v85, v98, v99
  v_exp_f32 v102, v46
  v_exp_f32 v103, v47
  v_add_f32 v15, v15, v100
  s_waitcnt lgkmcnt(4)
  v_mfma_f32_32x32x16_bf16 v[48:63], a[120:123], a[88:91], v[48:63]
  ds_read_b128 a[112:115], v125 offset:28672
  v_add_f32 v16, v16, v101
  v_cvt_pk_bf16_f32 v86, v100, v101
  v_add_f32 v15, v15, v102
  v_add_f32 v16, v16, v103
  v_cvt_pk_bf16_f32 v87, v102, v103
  v_add_f32 v15, v15, v16
  v_cmp_gt_f32 vcc, v15, v11
  v_mfma_f32_32x32x16_bf16 v[48:63], a[124:127], a[92:95], v[48:63]
  ds_read_b128 a[116:119], v125 offset:29696
  s_cbranch_vccnz A_SLOW60
A_RET61:
A_E1:
  s_waitcnt lgkmcnt(5)
  v_mfma_f32_32x32x16_bf16 a[0:15], a[96:99], v[80:83], a[0:15]
  ds_read_b128 a[120:123], v125 offset:30720
  v_add_f32 v10, v10, v15
  s_add_u32 s43, s43, 0x8000
  s_and_b32 s43, s43, 0x1ffff
  s_waitcnt lgkmcnt(5)
  v_mfma_f32_32x32x16_bf16 a[16:31], a[100:103], v[80:83], a[16:31]
  ds_read_b128 a[124:127], v125 offset:31744
  s_waitcnt lgkmcnt(4)
  v_mfma_f32_32x32x16_bf16 a[32:47], a[104:107], v[80:83], a[32:47]
  v_add_u32 v125, s43, v2
  ds_read_b128 a[96:99], v125 offset:16384
  v_cmp_lt_i32 s[56:57], v13, 0
  v_cmp_lt_i32 s[58:59], v13, 1
  v_cmp_lt_i32 s[60:61], v13, 2
  v_cmp_lt_i32 s[62:63], v13, 3
  v_cndmask_b32 v48, v48, v14, s[56:57]
  v_cndmask_b32 v49, v49, v14, s[58:59]
  v_cndmask_b32 v50, v50, v14, s[60:61]
  v_cndmask_b32 v51, v51, v14, s[62:63]
  v_cmp_lt_i32 s[56:57], v13, 8
  v_cmp_lt_i32 s[58:59], v13, 9
  v_cmp_lt_i32 s[60:61], v13, 10
  v_cmp_lt_i32 s[62:63], v13, 11
  v_cndmask_b32 v52, v52, v14, s[56:57]
  v_cndmask_b32 v53, v53, v14, s[58:59]
  v_cndmask_b32 v54, v54, v14, s[60:61]
  v_cndmask_b32 v55, v55, v14, s[62:63]
  v_cmp_lt_i32 s[56:57], v13, 16
  v_cmp_lt_i32 s[58:59], v13, 17
  v_mfma_f32_32x32x16_bf16 a[48:63], a[108:111], v[80:83], a[48:63]
  ds_read_b128 a[100:103], v125 offset:17408
  v_cmp_lt_i32 s[60:61], v13, 18
  v_cmp_lt_i32 s[62:63], v13, 19
  v_cndmask_b32 v56, v56, v14, s[56:57]
  v_cndmask_b32 v57, v57, v14, s[58:59]
  v_cndmask_b32 v58, v58, v14, s[60:61]
  v_cndmask_b32 v59, v59, v14, s[62:63]
  v_cmp_lt_i32 s[56:57], v13, 24
  v_cmp_lt_i32 s[58:59], v13, 25
  v_cmp_lt_i32 s[60:61], v13, 26
  v_cmp_lt_i32 s[62:63], v13, 27
  v_cndmask_b32 v60, v60, v14, s[56:57]
  v_cndmask_b32 v61, v61, v14, s[58:59]
  v_cndmask_b32 v62, v62, v14, s[60:61]
  v_cndmask_b32 v63, v63, v14, s[62:63]
  v_subrev_u32 v13, 32, v13
  v_exp_f32 v96, v48
  v_exp_f32 v97, v49
  s_waitcnt lgkmcnt(4)
  v_mfma_f32_32x32x16_bf16 a[0:15], a[112:115], v[84:87], a[0:15]
  ds_read_b128 a[104:107], v125 offset:18432
  v_exp_f32 v98, v50
  v_exp_f32 v99, v51
  v_mov_b32 v15, v96
  v_mov_b32 v16, v97
  v_cvt_pk_bf16_f32 v88, v96, v97
  v_exp_f32 v100, v52
  v_exp_f32 v101, v53
  v_add_f32 v15, v15, v98
  v_add_f32 v16, v16, v99
  v_cvt_pk_bf16_f32 v89, v98, v99
  v_exp_f32 v102, v54
  v_exp_f32 v103, v55
  v_mfma_f32_32x32x16_bf16 a[16:31], a[116:119], v[84:87], a[16:31]
  ds_read_b128 a[108:111], v125 offset:19456
  v_add_f32 v15, v15, v100
  v_add_f32 v16, v16, v101
  v_cvt_pk_bf16_f32 v90, v100, v101
  v_exp_f32 v96, v56
  v_exp_f32 v97, v57
  v_add_f32 v15, v15, v102
  v_add_f32 v16, v16, v103
  v_cvt_pk_bf16_f32 v91, v102, v103
  v_exp_f32 v98, v58
  v_exp_f32 v99, v59
  v_add_f32 v15, v15, v96
  v_add_f32 v16, v16, v97
  v_cvt_pk_bf16_f32 v92, v96, v97
  s_waitcnt lgkmcnt(4)
  v_mfma_f32_32x32x16_bf16 a[32:47], a[120:123], v[84:87], a[32:47]
  ds_read_b128 a[112:115], v125 offset:20480
  v_exp_f32 v100, v60
  v_exp_f32 v101, v61
  v_add_f32 v15, v15, v98
  v_add_f32 v16, v16, v99
  v_cvt_pk_bf16_f32 v93, v98, v99
  v_exp_f32 v102, v62
  v_exp_f32 v103, v63
  v_add_f32 v15, v15, v100
  v_add_f32 v16, v16, v101
  v_cvt_pk_bf16_f32 v94, v100, v101
  v_add_f32 v15, v15, v102
  v_add_f32 v16, v16, v103
  v_cvt_pk_bf16_f32 v95, v102, v103
  v_add_f32 v15, v15, v16
  v_cmp_gt_f32 vcc, v15, v11
  v_mfma_f32_32x32x16_bf16 a[48:63], a[124:127], v[84:87], a[48:63]
  ds_read_b128 a[116:119], v125 offset:21504
  s_cbranch_vccnz A_SLOW62
A_RET63:
  v_add_f32 v10, v10, v15
  s_cmp_eq_u32 s45, 0
  s_cbranch_scc1 A_FIN
  s_waitcnt vmcnt(8)
  s_barrier
  s_cmp_lg_u32 s39, 0
  s_cbranch_scc1 A_ND64
  s_mov_b32 m0, s42
  s_nop 0
  buffer_load_dwordx4 v124, s[8:11], s40 offen sc1 lds
  buffer_load_dwordx4 v124, s[8:11], s40 offen offset:1024 sc1 lds
  buffer_load_dwordx4 v124, s[8:11], s40 offen offset:2048 sc1 lds
  buffer_load_dwordx4 v124, s[8:11], s40 offen offset:3072 sc1 lds
  s_add_u32 m0, s42, 0x4000
  s_nop 0
  buffer_load_dwordx4 v124, s[8:11], s41 offen sc1 lds
  buffer_load_dwordx4 v124, s[8:11], s41 offen offset:1024 sc1 lds
  buffer_load_dwordx4 v124, s[8:11], s41 offen offset:2048 sc1 lds
  buffer_load_dwordx4 v124, s[8:11], s41 offen offset:3072 sc1 lds
  s_add_u32 s40, s40, 0x4000
  s_add_u32 s41, s41, 0x4000
  s_add_u32 s42, s42, 0x8000
  s_and_b32 s42, s42, 0x1ffff
  s_add_u32 s20, s20, 1
  s_cmp_eq_u32 s20, s21
  s_cselect_b32 s40, s22, s40
  s_sub_u32 s6, s20, 1
  s_cmp_eq_u32 s6, s21
  s_cselect_b32 s40, s23, s40
  s_sub_u32 s6, s20, 2
  s_cmp_eq_u32 s6, s21
  s_cselect_b32 s40, s24, s40
  s_add_u32 s6, s40, 0x4000
  s_cmp_gt_u32 s20, s21
  s_cselect_b32 s41, s6, s41
A_ND64:
  s_sub_u32 s45, s45, 1
A_FIN:
  s_waitcnt lgkmcnt(5)
  v_mfma_f32_32x32x16_bf16 a[0:15], a[96:99], v[88:91], a[0:15]
  ds_read_b128 a[120:123], v125 offset:22528
  s_waitcnt lgkmcnt(5)
  v_mfma_f32_32x32x16_bf16 a[16:31], a[100:103], v[88:91], a[16:31]
  ds_read_b128 a[124:127], v125 offset:23552
  s_waitcnt lgkmcnt(5)
  v_mfma_f32_32x32x16_bf16 a[32:47], a[104:107], v[88:91], a[32:47]
  s_waitcnt lgkmcnt(4)
  v_mfma_f32_32x32x16_bf16 a[48:63], a[108:111], v[88:91], a[48:63]
  s_waitcnt lgkmcnt(3)
  v_mfma_f32_32x32x16_bf16 a[0:15], a[112:115], v[92:95], a[0:15]
  s_waitcnt lgkmcnt(2)
  v_mfma_f32_32x32x16_bf16 a[16:31], a[116:119], v[92:95], a[16:31]
  s_waitcnt lgkmcnt(1)
  v_mfma_f32_32x32x16_bf16 a[32:47], a[120:123], v[92:95], a[32:47]
  s_waitcnt lgkmcnt(0)
  v_mfma_f32_32x32x16_bf16 a[48:63], a[124:127], v[92:95], a[48:63]
  s_branch A_EPI
A_E0:
  s_waitcnt lgkmcnt(5)
  v_mfma_f32_32x32x16_bf16 a[0:15], a[96:99], v[88:91], a[0:15]
  ds_read_b128 a[120:123], v125 offset:22528
  v_add_f32 v10, v10, v15
  s_waitcnt vmcnt(8)
  s_barrier
  s_waitcnt lgkmcnt(5)
  v_mfma_f32_32x32x16_bf16 a[16:31], a[100:103], v[88:91], a[16:31]
  ds_read_b128 a[124:127], v125 offset:23552
  s_cmp_lg_u32 s39, 0
  s_cbranch_scc1 A_ND65
  s_mov_b32 m0, s42
  s_nop 0
  buffer_load_dwordx4 v124, s[8:11], s40 offen sc1 lds
  buffer_load_dwordx4 v124, s[8:11], s40 offen offset:1024 sc1 lds
  buffer_load_dwordx4 v124, s[8:11], s40 offen offset:2048 sc1 lds
  buffer_load_dwordx4 v124, s[8:11], s40 offen offset:3072 sc1 lds
  s_add_u32 m0, s42, 0x4000
  s_nop 0
  buffer_load_dwordx4 v124, s[8:11], s41 offen sc1 lds
  buffer_load_dwordx4 v124, s[8:11], s41 offen offset:1024 sc1 lds
  buffer_load_dwordx4 v124, s[8:11], s41 offen offset:2048 sc1 lds
  buffer_load_dwordx4 v124, s[8:11], s41 offen offset:3072 sc1 lds
  s_add_u32 s40, s40, 0x4000
  s_add_u32 s41, s41, 0x4000
  s_add_u32 s42, s42, 0x8000
  s_and_b32 s42, s42, 0x1ffff
  s_add_u32 s20, s20, 1
  s_cmp_eq_u32 s20, s21
  s_cselect_b32 s40, s22, s40
  s_sub_u32 s6, s20, 1
  s_cmp_eq_u32 s6, s21
  s_cselect_b32 s40, s23, s40
  s_sub_u32 s6, s20, 2
  s_cmp_eq_u32 s6, s21
  s_cselect_b32 s40, s24, s40
  s_add_u32 s6, s40, 0x4000
  s_cmp_gt_u32 s20, s21
  s_cselect_b32 s41, s6, s41
A_ND65:
  s_waitcnt lgkmcnt(4)
  v_mfma_f32_32x32x16_bf16 a[32:47], a[104:107], v[88:91], a[32:47]
  ds_read_b128 a[96:99], v125 offset:24576
  v_cmp_lt_i32 s[56:57], v13, 0
  v_cmp_lt_i32 s[58:59], v13, 1
  v_cmp_lt_i32 s[60:61], v13, 2
  v_cmp_lt_i32 s[62:63], v13, 3
  v_cndmask_b32 v32, v32, v14, s[56:57]
  v_cndmask_b32 v33, v33, v14, s[58:59]
  v_cndmask_b32 v34, v34, v14, s[60:61]
  v_cndmask_b32 v35, v35, v14, s[62:63]
  v_cmp_lt_i32 s[56:57], v13, 8
  v_cmp_lt_i32 s[58:59], v13, 9
  v_cmp_lt_i32 s[60:61], v13, 10
  v_cmp_lt_i32 s[62:63], v13, 11
  v_cndmask_b32 v36, v36, v14, s[56:57]
  v_cndmask_b32 v37, v37, v14, s[58:59]
  v_cndmask_b32 v38, v38, v14, s[60:61]
  v_cndmask_b32 v39, v39, v14, s[62:63]
  v_cmp_lt_i32 s[56:57], v13, 16
  v_cmp_lt_i32 s[58:59], v13, 17
  v_mfma_f32_32x32x16_bf16 a[48:63], a[108:111], v[88:91], a[48:63]
  ds_read_b128 a[100:103], v125 offset:25600
  v_cmp_lt_i32 s[60:61], v13, 18
  v_cmp_lt_i32 s[62:63], v13, 19
  v_cndmask_b32 v40, v40, v14, s[56:57]
  v_cndmask_b32 v41, v41, v14, s[58:59]
  v_cndmask_b32 v42, v42, v14, s[60:61]
  v_cndmask_b32 v43, v43, v14, s[62:63]
  v_cmp_lt_i32 s[56:57], v13, 24
  v_cmp_lt_i32 s[58:59], v13, 25
  v_cmp_lt_i32 s[60:61], v13, 26
  v_cmp_lt_i32 s[62:63], v13, 27
  v_cndmask_b32 v44, v44, v14, s[56:57]
  v_cndmask_b32 v45, v45, v14, s[58:59]
  v_cndmask_b32 v46, v46, v14, s[60:61]
  v_cndmask_b32 v47, v47, v14, s[62:63]
  v_subrev_u32 v13, 32, v13
  v_exp_f32 v96, v32
  v_exp_f32 v97, v33
  s_waitcnt lgkmcnt(4)
  v_mfma_f32_32x32x16_bf16 a[0:15], a[112:115], v[92:95], a[0:15]
  ds_read_b128 a[104:107], v125 offset:26624
  v_exp_f32 v98, v34
  v_exp_f32 v99, v35
  v_mov_b32 v15, v96
  v_mov_b32 v16, v97
  v_cvt_pk_bf16_f32 v80, v96, v97
  v_exp_f32 v100, v36
  v_exp_f32 v101, v37
  v_add_f32 v15, v15, v98
  v_add_f32 v16, v16, v99
  v_cvt_pk_bf16_f32 v81, v98, v99
  v_exp_f32 v102, v38
  v_exp_f32 v103, v39
  v_mfma_f32_32x32x16_bf16 a[16:31], a[116:119], v[92:95], a[16:31]
  ds_read_b128 a[108:111], v125 offset:27648
  v_add_f32 v15, v15, v100
  v_add_f32 v16, v16, v101
  v_cvt_pk_bf16_f32 v82, v100, v101
  v_exp_f32 v96, v40
  v_exp_f32 v97, v41
  v_add_f32 v15, v15, v102
  v_add_f32 v16, v16, v103
  v_cvt_pk_bf16_f32 v83, v102, v103
  v_exp_f32 v98, v42
  v_exp_f32 v99, v43
  v_add_f32 v15, v15, v96
  v_add_f32 v16, v16, v97
  v_cvt_pk_bf16_f32 v84, v96, v97
  s_waitcnt lgkmcnt(4)
  v_mfma_f32_32x32x16_bf16 a[32:47], a[120:123], v[92:95], a[32:47]
  ds_read_b128 a[112:115], v125 offset:28672
  v_exp_f32 v100, v44
  v_exp_f32 v101, v45
  v_add_f32 v15, v15, v98
  v_add_f32 v16, v16, v99
  v_cvt_pk_bf16_f32 v85, v98, v99
  v_exp_f32 v102, v46
  v_exp_f32 v103, v47
  v_add_f32 v15, v15, v100
  v_add_f32 v16, v16, v101
  v_cvt_pk_bf16_f32 v86, v100, v101
  v_add_f32 v15, v15, v102
  v_add_f32 v16, v16, v103
  v_cvt_pk_bf16_f32 v87, v102, v103
  v_add_f32 v15, v15, v16
  v_cmp_gt_f32 vcc, v15, v11
  v_mfma_f32_32x32x16_bf16 a[48:63], a[124:127], v[92:95], a[48:63]
  ds_read_b128 a[116:119], v125 offset:29696
  s_cbranch_vccnz A_SLOW66
A_RET67:
  v_add_f32 v10, v10, v15
  s_waitcnt lgkmcnt(5)
  v_mfma_f32_32x32x16_bf16 a[0:15], a[96:99], v[80:83], a[0:15]
  ds_read_b128 a[120:123], v125 offset:30720
  s_waitcnt lgkmcnt(5)
  v_mfma_f32_32x32x16_bf16 a[16:31], a[100:103], v[80:83], a[16:31]
  ds_read_b128 a[124:127], v125 offset:31744
  s_waitcnt lgkmcnt(5)
  v_mfma_f32_32x32x16_bf16 a[32:47], a[104:107], v[80:83], a[32:47]
  s_waitcnt lgkmcnt(4)
  v_mfma_f32_32x32x16_bf16 a[48:63], a[108:111], v[80:83], a[48:63]
  s_waitcnt lgkmcnt(3)
  v_mfma_f32_32x32x16_bf16 a[0:15], a[112:115], v[84:87], a[0:15]
  s_waitcnt lgkmcnt(2)
  v_mfma_f32_32x32x16_bf16 a[16:31], a[116:119], v[84:87], a[16:31]
  s_waitcnt lgkmcnt(1)
  v_mfma_f32_32x32x16_bf16 a[32:47], a[120:123], v[84:87], a[32:47]
  s_waitcnt lgkmcnt(0)
  v_mfma_f32_32x32x16_bf16 a[48:63], a[124:127], v[84:87], a[48:63]
A_EPI:
  v_mov_b32 v5, v10
  s_nop 1
  v_permlane32_swap_b32 v5, v10
  v_add_f32 v5, v5, v10
  v_rcp_f32 v17, v5
  s_lshl_b32 s6, s96, 13
  s_lshl_b32 s7, s34, 13
  s_add_u32 s6, s6, s7
  s_add_u32 s6, s6, 0x2000000
  s_add_u32 s7, s6, 0x1000
  v_accvgpr_read_b32 v32, a0
  v_accvgpr_read_b32 v33, a1
  v_accvgpr_read_b32 v34, a2
  v_accvgpr_read_b32 v35, a3
  v_accvgpr_read_b32 v36, a4
  v_accvgpr_read_b32 v37, a5
  v_accvgpr_read_b32 v38, a6
  v_accvgpr_read_b32 v39, a7
  v_accvgpr_read_b32 v40, a8
  v_accvgpr_read_b32 v41, a9
  v_accvgpr_read_b32 v42, a10
  v_accvgpr_read_b32 v43, a11
  v_accvgpr_read_b32 v44, a12
  v_accvgpr_read_b32 v45, a13
  v_accvgpr_read_b32 v46, a14
  v_accvgpr_read_b32 v47, a15
  v_mul_f32 v32, v32, v17
  v_mul_f32 v33, v33, v17
  v_mul_f32 v34, v34, v17
  v_mul_f32 v35, v35, v17
  v_mul_f32 v36, v36, v17
  v_mul_f32 v37, v37, v17
  v_mul_f32 v38, v38, v17
  v_mul_f32 v39, v39, v17
  v_mul_f32 v40, v40, v17
  v_mul_f32 v41, v41, v17
  v_mul_f32 v42, v42, v17
  v_mul_f32 v43, v43, v17
  v_mul_f32 v44, v44, v17
  v_mul_f32 v45, v45, v17
  v_mul_f32 v46, v46, v17
  v_mul_f32 v47, v47, v17
  v_cvt_pk_bf16_f32 v80, v32, v33
  v_cvt_pk_bf16_f32 v81, v34, v35
  v_cvt_pk_bf16_f32 v82, v36, v37
  v_cvt_pk_bf16_f32 v83, v38, v39
  v_cvt_pk_bf16_f32 v84, v40, v41
  v_cvt_pk_bf16_f32 v85, v42, v43
  v_cvt_pk_bf16_f32 v86, v44, v45
  v_cvt_pk_bf16_f32 v87, v46, v47
  buffer_store_dwordx4 v[80:83], v2, s[8:11], s6 offen sc1
  buffer_store_dwordx4 v[84:87], v2, s[8:11], s6 offen offset:1024 sc1
  v_accvgpr_write_b32 a64, v80
  v_accvgpr_write_b32 a65, v81
  v_accvgpr_write_b32 a66, v82
  v_accvgpr_write_b32 a67, v83
  v_accvgpr_write_b32 a68, v84
  v_accvgpr_write_b32 a69, v85
  v_accvgpr_write_b32 a70, v86
  v_accvgpr_write_b32 a71, v87
  v_accvgpr_read_b32 v48, a16
  v_accvgpr_read_b32 v49, a17
  v_accvgpr_read_b32 v50, a18
  v_accvgpr_read_b32 v51, a19
  v_accvgpr_read_b32 v52, a20
  v_accvgpr_read_b32 v53, a21
  v_accvgpr_read_b32 v54, a22
  v_accvgpr_read_b32 v55, a23
  v_accvgpr_read_b32 v56, a24
  v_accvgpr_read_b32 v57, a25
  v_accvgpr_read_b32 v58, a26
  v_accvgpr_read_b32 v59, a27
  v_accvgpr_read_b32 v60, a28
  v_accvgpr_read_b32 v61, a29
  v_accvgpr_read_b32 v62, a30
  v_accvgpr_read_b32 v63, a31
  v_mul_f32 v48, v48, v17
  v_mul_f32 v49, v49, v17
  v_mul_f32 v50, v50, v17
  v_mul_f32 v51, v51, v17
  v_mul_f32 v52, v52, v17
  v_mul_f32 v53, v53, v17
  v_mul_f32 v54, v54, v17
  v_mul_f32 v55, v55, v17
  v_mul_f32 v56, v56, v17
  v_mul_f32 v57, v57, v17
  v_mul_f32 v58, v58, v17
  v_mul_f32 v59, v59, v17
  v_mul_f32 v60, v60, v17
  v_mul_f32 v61, v61, v17
  v_mul_f32 v62, v62, v17
  v_mul_f32 v63, v63, v17
  v_cvt_pk_bf16_f32 v88, v48, v49
  v_cvt_pk_bf16_f32 v89, v50, v51
  v_cvt_pk_bf16_f32 v90, v52, v53
  v_cvt_pk_bf16_f32 v91, v54, v55
  v_cvt_pk_bf16_f32 v92, v56, v57
  v_cvt_pk_bf16_f32 v93, v58, v59
  v_cvt_pk_bf16_f32 v94, v60, v61
  v_cvt_pk_bf16_f32 v95, v62, v63
  buffer_store_dwordx4 v[88:91], v2, s[8:11], s6 offen offset:2048 sc1
  buffer_store_dwordx4 v[92:95], v2, s[8:11], s6 offen offset:3072 sc1
  v_accvgpr_write_b32 a72, v88
  v_accvgpr_write_b32 a73, v89
  v_accvgpr_write_b32 a74, v90
  v_accvgpr_write_b32 a75, v91
  v_accvgpr_write_b32 a76, v92
  v_accvgpr_write_b32 a77, v93
  v_accvgpr_write_b32 a78, v94
  v_accvgpr_write_b32 a79, v95
  v_accvgpr_read_b32 v32, a32
  v_accvgpr_read_b32 v33, a33
  v_accvgpr_read_b32 v34, a34
  v_accvgpr_read_b32 v35, a35
  v_accvgpr_read_b32 v36, a36
  v_accvgpr_read_b32 v37, a37
  v_accvgpr_read_b32 v38, a38
  v_accvgpr_read_b32 v39, a39
  v_accvgpr_read_b32 v40, a40
  v_accvgpr_read_b32 v41, a41
  v_accvgpr_read_b32 v42, a42
  v_accvgpr_read_b32 v43, a43
  v_accvgpr_read_b32 v44, a44
  v_accvgpr_read_b32 v45, a45
  v_accvgpr_read_b32 v46, a46
  v_accvgpr_read_b32 v47, a47
  v_mul_f32 v32, v32, v17
  v_mul_f32 v33, v33, v17
  v_mul_f32 v34, v34, v17
  v_mul_f32 v35, v35, v17
  v_mul_f32 v36, v36, v17
  v_mul_f32 v37, v37, v17
  v_mul_f32 v38, v38, v17
  v_mul_f32 v39, v39, v17
  v_mul_f32 v40, v40, v17
  v_mul_f32 v41, v41, v17
  v_mul_f32 v42, v42, v17
  v_mul_f32 v43, v43, v17
  v_mul_f32 v44, v44, v17
  v_mul_f32 v45, v45, v17
  v_mul_f32 v46, v46, v17
  v_mul_f32 v47, v47, v17
  v_cvt_pk_bf16_f32 v80, v32, v33
  v_cvt_pk_bf16_f32 v81, v34, v35
  v_cvt_pk_bf16_f32 v82, v36, v37
  v_cvt_pk_bf16_f32 v83, v38, v39
  v_cvt_pk_bf16_f32 v84, v40, v41
  v_cvt_pk_bf16_f32 v85, v42, v43
  v_cvt_pk_bf16_f32 v86, v44, v45
  v_cvt_pk_bf16_f32 v87, v46, v47
  buffer_store_dwordx4 v[80:83], v2, s[8:11], s7 offen sc1
  buffer_store_dwordx4 v[84:87], v2, s[8:11], s7 offen offset:1024 sc1
  v_accvgpr_write_b32 a80, v80
  v_accvgpr_write_b32 a81, v81
  v_accvgpr_write_b32 a82, v82
  v_accvgpr_write_b32 a83, v83
  v_accvgpr_write_b32 a84, v84
  v_accvgpr_write_b32 a85, v85
  v_accvgpr_write_b32 a86, v86
  v_accvgpr_write_b32 a87, v87
  v_accvgpr_read_b32 v48, a48
  v_accvgpr_read_b32 v49, a49
  v_accvgpr_read_b32 v50, a50
  v_accvgpr_read_b32 v51, a51
  v_accvgpr_read_b32 v52, a52
  v_accvgpr_read_b32 v53, a53
  v_accvgpr_read_b32 v54, a54
  v_accvgpr_read_b32 v55, a55
  v_accvgpr_read_b32 v56, a56
  v_accvgpr_read_b32 v57, a57
  v_accvgpr_read_b32 v58, a58
  v_accvgpr_read_b32 v59, a59
  v_accvgpr_read_b32 v60, a60
  v_accvgpr_read_b32 v61, a61
  v_accvgpr_read_b32 v62, a62
  v_accvgpr_read_b32 v63, a63
  v_mul_f32 v48, v48, v17
  v_mul_f32 v49, v49, v17
  v_mul_f32 v50, v50, v17
  v_mul_f32 v51, v51, v17
  v_mul_f32 v52, v52, v17
  v_mul_f32 v53, v53, v17
  v_mul_f32 v54, v54, v17
  v_mul_f32 v55, v55, v17
  v_mul_f32 v56, v56, v17
  v_mul_f32 v57, v57, v17
  v_mul_f32 v58, v58, v17
  v_mul_f32 v59, v59, v17
  v_mul_f32 v60, v60, v17
  v_mul_f32 v61, v61, v17
  v_mul_f32 v62, v62, v17
  v_mul_f32 v63, v63, v17
  v_cvt_pk_bf16_f32 v88, v48, v49
  v_cvt_pk_bf16_f32 v89, v50, v51
  v_cvt_pk_bf16_f32 v90, v52, v53
  v_cvt_pk_bf16_f32 v91, v54, v55
  v_cvt_pk_bf16_f32 v92, v56, v57
  v_cvt_pk_bf16_f32 v93, v58, v59
  v_cvt_pk_bf16_f32 v94, v60, v61
  v_cvt_pk_bf16_f32 v95, v62, v63
  buffer_store_dwordx4 v[88:91], v2, s[8:11], s7 offen offset:2048 sc1
  buffer_store_dwordx4 v[92:95], v2, s[8:11], s7 offen offset:3072 sc1
  v_accvgpr_write_b32 a88, v88
  v_accvgpr_write_b32 a89, v89
  v_accvgpr_write_b32 a90, v90
  v_accvgpr_write_b32 a91, v91
  v_accvgpr_write_b32 a92, v92
  v_accvgpr_write_b32 a93, v93
  v_accvgpr_write_b32 a94, v94
  v_accvgpr_write_b32 a95, v95
  s_cmp_eq_u32 s39, 0
  s_cbranch_scc1 A_SHORT
  s_cmp_eq_u32 s45, 0
  s_cbranch_scc1 A_DONE
  s_barrier
  s_branch A_DONE
A_SHORT:
  s_sub_u32 s56, s95, s94
  s_lshr_b32 s56, s56, 1
A_AL:
  s_cmp_lt_u32 s45, s56
  s_cbranch_scc1 A_AL1
  s_waitcnt vmcnt(8)
  s_barrier
  s_mov_b32 m0, s42
  s_nop 0
  buffer_load_dwordx4 v124, s[8:11], s40 offen sc1 lds
  buffer_load_dwordx4 v124, s[8:11], s40 offen offset:1024 sc1 lds
  buffer_load_dwordx4 v124, s[8:11], s40 offen offset:2048 sc1 lds
  buffer_load_dwordx4 v124, s[8:11], s40 offen offset:3072 sc1 lds
  s_add_u32 m0, s42, 0x4000
  s_nop 0
  buffer_load_dwordx4 v124, s[8:11], s41 offen sc1 lds
  buffer_load_dwordx4 v124, s[8:11], s41 offen offset:1024 sc1 lds
  buffer_load_dwordx4 v124, s[8:11], s41 offen offset:2048 sc1 lds
  buffer_load_dwordx4 v124, s[8:11], s41 offen offset:3072 sc1 lds
  s_add_u32 s40, s40, 0x4000
  s_add_u32 s41, s41, 0x4000
  s_add_u32 s42, s42, 0x8000
  s_and_b32 s42, s42, 0x1ffff
  s_add_u32 s20, s20, 1
  s_cmp_eq_u32 s20, s21
  s_cselect_b32 s40, s22, s40
  s_sub_u32 s6, s20, 1
  s_cmp_eq_u32 s6, s21
  s_cselect_b32 s40, s23, s40
  s_sub_u32 s6, s20, 2
  s_cmp_eq_u32 s6, s21
  s_cselect_b32 s40, s24, s40
  s_add_u32 s6, s40, 0x4000
  s_cmp_gt_u32 s20, s21
  s_cselect_b32 s41, s6, s41
  s_sub_u32 s45, s45, 1
  s_branch A_AL
A_AL1:
  s_cmp_ge_u32 s2, 48
  s_cbranch_scc1 A_NKVR
  s_lshl_b32 s56, s2, 2
  s_add_u32 s56, s56, s91
  s_mul_i32 s6, s56, 0xaaab
  s_lshr_b32 s6, s6, 20
  s_lshr_b32 s7, s6, 2
  s_and_b32 s6, s6, 3
  s_lshl_b32 s6, s6, 6
  s_add_u32 s6, s6, s7
  v_bfe_u32 v5, v1, 3, 2
  v_lshlrev_b32 v5, 1, v5
  v_and_b32 v6, 7, v1
  v_lshl_add_u32 v5, v6, 3, v5
  v_add_u32 v5, s6, v5
  v_lshlrev_b32 v5, 8, v5
  v_add_u32 v116, 0x7c00000, v5
  s_lshl_b32 s57, s56, 10
  s_add_u32 s57, s57, 0x6800000
  s_waitcnt vmcnt(8)
  s_barrier
  buffer_load_dword v117, v116, s[8:11], 0 offen sc1
  s_mov_b32 m0, s42
  s_nop 0
  buffer_load_dwordx4 v124, s[8:11], s40 offen sc1 lds
  buffer_load_dwordx4 v124, s[8:11], s40 offen offset:1024 sc1 lds
  buffer_load_dwordx4 v124, s[8:11], s40 offen offset:2048 sc1 lds
  buffer_load_dwordx4 v124, s[8:11], s40 offen offset:3072 sc1 lds
  s_add_u32 m0, s42, 0x4000
  s_nop 0
  buffer_load_dwordx4 v124, s[8:11], s41 offen sc1 lds
  buffer_load_dwordx4 v124, s[8:11], s41 offen offset:1024 sc1 lds
  buffer_load_dwordx4 v124, s[8:11], s41 offen offset:2048 sc1 lds
  buffer_load_dwordx4 v124, s[8:11], s41 offen offset:3072 sc1 lds
  s_add_u32 s40, s40, 0x4000
  s_add_u32 s41, s41, 0x4000
  s_add_u32 s42, s42, 0x8000
  s_and_b32 s42, s42, 0x1ffff
  s_add_u32 s20, s20, 1
  s_cmp_eq_u32 s20, s21
  s_cselect_b32 s40, s22, s40
  s_sub_u32 s6, s20, 1
  s_cmp_eq_u32 s6, s21
  s_cselect_b32 s40, s23, s40
  s_sub_u32 s6, s20, 2
  s_cmp_eq_u32 s6, s21
  s_cselect_b32 s40, s24, s40
  s_add_u32 s6, s40, 0x4000
  s_cmp_gt_u32 s20, s21
  s_cselect_b32 s41, s6, s41
  s_waitcnt vmcnt(8)
  s_barrier
  buffer_store_dword v4, v19, s[8:11], s37 offen offset:64 sc1
  v_cmp_ne_u32 vcc, 1, v117
  s_nop 1
  s_cbranch_vccz SJ_OK68
  s_mov_b32 s38, 0
PL69:
  buffer_load_dword v117, v116, s[8:11], 0 offen sc1
  s_waitcnt vmcnt(0)
  v_cmp_ne_u32 vcc, 1, v117
  s_add_u32 s38, s38, 1
  s_cbranch_vccz PD70
  s_sleep 1
  s_cmp_lt_u32 s38, 0x30d40
  s_cbranch_scc1 PL69
PD70:
SJ_OK68:
  buffer_load_dwordx4 v[32:35], v2, s[8:11], s57 offen sc1
  s_add_u32 s57, s57, 0x30000
  buffer_load_dwordx4 v[36:39], v2, s[8:11], s57 offen sc1
  s_add_u32 s57, s57, 0x30000
  buffer_load_dwordx4 v[40:43], v2, s[8:11], s57 offen sc1
  s_add_u32 s57, s57, 0x30000
  buffer_load_dwordx4 v[44:47], v2, s[8:11], s57 offen sc1
  s_add_u32 s57, s57, 0x30000
  buffer_load_dwordx4 v[48:51], v2, s[8:11], s57 offen sc1
  s_add_u32 s57, s57, 0x30000
  buffer_load_dwordx4 v[52:55], v2, s[8:11], s57 offen sc1
  s_add_u32 s57, s57, 0x30000
  buffer_load_dwordx4 v[56:59], v2, s[8:11], s57 offen sc1
  s_add_u32 s57, s57, 0x30000
  buffer_load_dwordx4 v[60:63], v2, s[8:11], s57 offen sc1
  s_add_u32 s57, s57, 0x30000
  buffer_load_dwordx4 v[64:67], v2, s[8:11], s57 offen sc1
  s_add_u32 s57, s57, 0x30000
  buffer_load_dwordx4 v[68:71], v2, s[8:11], s57 offen sc1
  s_add_u32 s57, s57, 0x30000
  buffer_load_dwordx4 v[72:75], v2, s[8:11], s57 offen sc1
  s_add_u32 s57, s57, 0x30000
  buffer_load_dwordx4 v[76:79], v2, s[8:11], s57 offen sc1
  s_add_u32 s57, s57, 0x30000
  buffer_load_dwordx4 v[80:83], v2, s[8:11], s57 offen sc1
  s_add_u32 s57, s57, 0x30000
  buffer_load_dwordx4 v[84:87], v2, s[8:11], s57 offen sc1
  s_add_u32 s57, s57, 0x30000
  buffer_load_dwordx4 v[88:91], v2, s[8:11], s57 offen sc1
  s_add_u32 s57, s57, 0x30000
  buffer_load_dwordx4 v[92:95], v2, s[8:11], s57 offen sc1
  s_add_u32 s57, s57, 0x30000
  s_mov_b32 m0, s42
  s_nop 0
  buffer_load_dwordx4 v124, s[8:11], s40 offen sc1 lds
  buffer_load_dwordx4 v124, s[8:11], s40 offen offset:1024 sc1 lds
  buffer_load_dwordx4 v124, s[8:11], s40 offen offset:2048 sc1 lds
  buffer_load_dwordx4 v124, s[8:11], s40 offen offset:3072 sc1 lds
  s_add_u32 m0, s42, 0x4000
  s_nop 0
  buffer_load_dwordx4 v124, s[8:11], s41 offen sc1 lds
  buffer_load_dwordx4 v124, s[8:11], s41 offen offset:1024 sc1 lds
  buffer_load_dwordx4 v124, s[8:11], s41 offen offset:2048 sc1 lds
  buffer_load_dwordx4 v124, s[8:11], s41 offen offset:3072 sc1 lds
  s_add_u32 s40, s40, 0x4000
  s_add_u32 s41, s41, 0x4000
  s_add_u32 s42, s42, 0x8000
  s_and_b32 s42, s42, 0x1ffff
  s_add_u32 s20, s20, 1
  s_cmp_eq_u32 s20, s21
  s_cselect_b32 s40, s22, s40
  s_sub_u32 s6, s20, 1
  s_cmp_eq_u32 s6, s21
  s_cselect_b32 s40, s23, s40
  s_sub_u32 s6, s20, 2
  s_cmp_eq_u32 s6, s21
  s_cselect_b32 s40, s24, s40
  s_add_u32 s6, s40, 0x4000
  s_cmp_gt_u32 s20, s21
  s_cselect_b32 s41, s6, s41
  s_waitcnt vmcnt(8)
  s_barrier
  v_add_f32 v32, v32, v36
  v_add_f32 v33, v33, v37
  v_add_f32 v34, v34, v38
  v_add_f32 v35, v35, v39
  v_add_f32 v40, v40, v44
  v_add_f32 v41, v41, v45
  v_add_f32 v42, v42, v46
  v_add_f32 v43, v43, v47
  v_add_f32 v48, v48, v52
  v_add_f32 v49, v49, v53
  v_add_f32 v50, v50, v54
  v_add_f32 v51, v51, v55
  v_add_f32 v56, v56, v60
  v_add_f32 v57, v57, v61
  v_add_f32 v58, v58, v62
  v_add_f32 v59, v59, v63
  v_add_f32 v64, v64, v68
  v_add_f32 v65, v65, v69
  v_add_f32 v66, v66, v70
  v_add_f32 v67, v67, v71
  v_add_f32 v72, v72, v76
  v_add_f32 v73, v73, v77
  v_add_f32 v74, v74, v78
  v_add_f32 v75, v75, v79
  v_add_f32 v80, v80, v84
  v_add_f32 v81, v81, v85
  v_add_f32 v82, v82, v86
  v_add_f32 v83, v83, v87
  v_add_f32 v88, v88, v92
  v_add_f32 v89, v89, v93
  v_add_f32 v90, v90, v94
  v_add_f32 v91, v91, v95
  v_add_f32 v32, v32, v40
  v_add_f32 v33, v33, v41
  v_add_f32 v34, v34, v42
  v_add_f32 v35, v35, v43
  v_add_f32 v48, v48, v56
  v_add_f32 v49, v49, v57
  v_add_f32 v50, v50, v58
  v_add_f32 v51, v51, v59
  v_add_f32 v64, v64, v72
  v_add_f32 v65, v65, v73
  v_add_f32 v66, v66, v74
  v_add_f32 v67, v67, v75
  v_add_f32 v80, v80, v88
  v_add_f32 v81, v81, v89
  v_add_f32 v82, v82, v90
  v_add_f32 v83, v83, v91
  v_add_f32 v32, v32, v48
  v_add_f32 v33, v33, v49
  v_add_f32 v34, v34, v50
  v_add_f32 v35, v35, v51
  v_add_f32 v64, v64, v80
  v_add_f32 v65, v65, v81
  v_add_f32 v66, v66, v82
  v_add_f32 v67, v67, v83
  v_add_f32 v32, v32, v64
  v_add_f32 v33, v33, v65
  v_add_f32 v34, v34, v66
  v_add_f32 v35, v35, v67
  v_mov_b32 v96, v32
  v_mov_b32 v97, v33
  v_mov_b32 v98, v34
  v_mov_b32 v99, v35
  buffer_load_dwordx4 v[32:35], v2, s[8:11], s57 offen sc1
  s_add_u32 s57, s57, 0x30000
  buffer_load_dwordx4 v[36:39], v2, s[8:11], s57 offen sc1
  s_add_u32 s57, s57, 0x30000
  buffer_load_dwordx4 v[40:43], v2, s[8:11], s57 offen sc1
  s_add_u32 s57, s57, 0x30000
  buffer_load_dwordx4 v[44:47], v2, s[8:11], s57 offen sc1
  s_add_u32 s57, s57, 0x30000
  buffer_load_dwordx4 v[48:51], v2, s[8:11], s57 offen sc1
  s_add_u32 s57, s57, 0x30000
  buffer_load_dwordx4 v[52:55], v2, s[8:11], s57 offen sc1
  s_add_u32 s57, s57, 0x30000
  buffer_load_dwordx4 v[56:59], v2, s[8:11], s57 offen sc1
  s_add_u32 s57, s57, 0x30000
  buffer_load_dwordx4 v[60:63], v2, s[8:11], s57 offen sc1
  s_add_u32 s57, s57, 0x30000
  buffer_load_dwordx4 v[64:67], v2, s[8:11], s57 offen sc1
  s_add_u32 s57, s57, 0x30000
  buffer_load_dwordx4 v[68:71], v2, s[8:11], s57 offen sc1
  s_add_u32 s57, s57, 0x30000
  buffer_load_dwordx4 v[72:75], v2, s[8:11], s57 offen sc1
  s_add_u32 s57, s57, 0x30000
  buffer_load_dwordx4 v[76:79], v2, s[8:11], s57 offen sc1
  s_add_u32 s57, s57, 0x30000
  buffer_load_dwordx4 v[80:83], v2, s[8:11], s57 offen sc1
  s_add_u32 s57, s57, 0x30000
  buffer_load_dwordx4 v[84:87], v2, s[8:11], s57 offen sc1
  s_add_u32 s57, s57, 0x30000
  buffer_load_dwordx4 v[88:91], v2, s[8:11], s57 offen sc1
  s_add_u32 s57, s57, 0x30000
  buffer_load_dwordx4 v[92:95], v2, s[8:11], s57 offen sc1
  s_add_u32 s57, s57, 0x30000
  s_mov_b32 m0, s42
  s_nop 0
  buffer_load_dwordx4 v124, s[8:11], s40 offen sc1 lds
  buffer_load_dwordx4 v124, s[8:11], s40 offen offset:1024 sc1 lds
  buffer_load_dwordx4 v124, s[8:11], s40 offen offset:2048 sc1 lds
  buffer_load_dwordx4 v124, s[8:11], s40 offen offset:3072 sc1 lds
  s_add_u32 m0, s42, 0x4000
  s_nop 0
  buffer_load_dwordx4 v124, s[8:11], s41 offen sc1 lds
  buffer_load_dwordx4 v124, s[8:11], s41 offen offset:1024 sc1 lds
  buffer_load_dwordx4 v124, s[8:11], s41 offen offset:2048 sc1 lds
  buffer_load_dwordx4 v124, s[8:11], s41 offen offset:3072 sc1 lds
  s_add_u32 s40, s40, 0x4000
  s_add_u32 s41, s41, 0x4000
  s_add_u32 s42, s42, 0x8000
  s_and_b32 s42, s42, 0x1ffff
  s_add_u32 s20, s20, 1
  s_cmp_eq_u32 s20, s21
  s_cselect_b32 s40, s22, s40
  s_sub_u32 s6, s20, 1
  s_cmp_eq_u32 s6, s21
  s_cselect_b32 s40, s23, s40
  s_sub_u32 s6, s20, 2
  s_cmp_eq_u32 s6, s21
  s_cselect_b32 s40, s24, s40
  s_add_u32 s6, s40, 0x4000
  s_cmp_gt_u32 s20, s21
  s_cselect_b32 s41, s6, s41
  s_waitcnt vmcnt(8)
  s_barrier
  v_add_f32 v32, v32, v36
  v_add_f32 v33, v33, v37
  v_add_f32 v34, v34, v38
  v_add_f32 v35, v35, v39
  v_add_f32 v40, v40, v44
  v_add_f32 v41, v41, v45
  v_add_f32 v42, v42, v46
  v_add_f32 v43, v43, v47
  v_add_f32 v48, v48, v52
  v_add_f32 v49, v49, v53
  v_add_f32 v50, v50, v54
  v_add_f32 v51, v51, v55
  v_add_f32 v56, v56, v60
  v_add_f32 v57, v57, v61
  v_add_f32 v58, v58, v62
  v_add_f32 v59, v59, v63
  v_add_f32 v64, v64, v68
  v_add_f32 v65, v65, v69
  v_add_f32 v66, v66, v70
  v_add_f32 v67, v67, v71
  v_add_f32 v72, v72, v76
  v_add_f32 v73, v73, v77
  v_add_f32 v74, v74, v78
  v_add_f32 v75, v75, v79
  v_add_f32 v80, v80, v84
  v_add_f32 v81, v81, v85
  v_add_f32 v82, v82, v86
  v_add_f32 v83, v83, v87
  v_add_f32 v88, v88, v92
  v_add_f32 v89, v89, v93
  v_add_f32 v90, v90, v94
  v_add_f32 v91, v91, v95
  v_add_f32 v32, v32, v40
  v_add_f32 v33, v33, v41
  v_add_f32 v34, v34, v42
  v_add_f32 v35, v35, v43
  v_add_f32 v48, v48, v56
  v_add_f32 v49, v49, v57
  v_add_f32 v50, v50, v58
  v_add_f32 v51, v51, v59
  v_add_f32 v64, v64, v72
  v_add_f32 v65, v65, v73
  v_add_f32 v66, v66, v74
  v_add_f32 v67, v67, v75
  v_add_f32 v80, v80, v88
  v_add_f32 v81, v81, v89
  v_add_f32 v82, v82, v90
  v_add_f32 v83, v83, v91
  v_add_f32 v32, v32, v48
  v_add_f32 v33, v33, v49
  v_add_f32 v34, v34, v50
  v_add_f32 v35, v35, v51
  v_add_f32 v64, v64, v80
  v_add_f32 v65, v65, v81
  v_add_f32 v66, v66, v82
  v_add_f32 v67, v67, v83
  v_add_f32 v32, v32, v64
  v_add_f32 v33, v33, v65
  v_add_f32 v34, v34, v66
  v_add_f32 v35, v35, v67
  v_add_f32 v96, v96, v32
  v_add_f32 v97, v97, v33
  v_add_f32 v98, v98, v34
  v_add_f32 v99, v99, v35
  v_cvt_pk_bf16_f32 v96, v96, v97
  v_cvt_pk_bf16_f32 v97, v98, v99
  s_lshr_b32 s6, s56, 1
  s_lshl_b32 s6, s6, 10
  s_and_b32 s7, s56, 1
  s_lshl_b32 s7, s7, 3
  s_add_u32 s6, s6, s7
  s_add_u32 s6, s6, 0x6f00000
  buffer_store_dwordx2 v[96:97], v2, s[8:11], s6 offen sc1
  s_mov_b32 m0, s42
  s_nop 0
  buffer_load_dwordx4 v124, s[8:11], s40 offen sc1 lds
  buffer_load_dwordx4 v124, s[8:11], s40 offen offset:1024 sc1 lds
  buffer_load_dwordx4 v124, s[8:11], s40 offen offset:2048 sc1 lds
  buffer_load_dwordx4 v124, s[8:11], s40 offen offset:3072 sc1 lds
  s_add_u32 m0, s42, 0x4000
  s_nop 0
  buffer_load_dwordx4 v124, s[8:11], s41 offen sc1 lds
  buffer_load_dwordx4 v124, s[8:11], s41 offen offset:1024 sc1 lds
  buffer_load_dwordx4 v124, s[8:11], s41 offen offset:2048 sc1 lds
  buffer_load_dwordx4 v124, s[8:11], s41 offen offset:3072 sc1 lds
  s_add_u32 s40, s40, 0x4000
  s_add_u32 s41, s41, 0x4000
  s_add_u32 s42, s42, 0x8000
  s_and_b32 s42, s42, 0x1ffff
  s_add_u32 s20, s20, 1
  s_cmp_eq_u32 s20, s21
  s_cselect_b32 s40, s22, s40
  s_sub_u32 s6, s20, 1
  s_cmp_eq_u32 s6, s21
  s_cselect_b32 s40, s23, s40
  s_sub_u32 s6, s20, 2
  s_cmp_eq_u32 s6, s21
  s_cselect_b32 s40, s24, s40
  s_add_u32 s6, s40, 0x4000
  s_cmp_gt_u32 s20, s21
  s_cselect_b32 s41, s6, s41
  s_waitcnt vmcnt(8)
  s_barrier
  buffer_store_dword v4, v19, s[8:11], s37 offen offset:16 sc1
  s_mov_b32 m0, s42
  s_nop 0
  buffer_load_dwordx4 v124, s[8:11], s40 offen sc1 lds
  buffer_load_dwordx4 v124, s[8:11], s40 offen offset:1024 sc1 lds
  buffer_load_dwordx4 v124, s[8:11], s40 offen offset:2048 sc1 lds
  buffer_load_dwordx4 v124, s[8:11], s40 offen offset:3072 sc1 lds
  s_add_u32 m0, s42, 0x4000
  s_nop 0
  buffer_load_dwordx4 v124, s[8:11], s41 offen sc1 lds
  buffer_load_dwordx4 v124, s[8:11], s41 offen offset:1024 sc1 lds
  buffer_load_dwordx4 v124, s[8:11], s41 offen offset:2048 sc1 lds
  buffer_load_dwordx4 v124, s[8:11], s41 offen offset:3072 sc1 lds
  s_add_u32 s40, s40, 0x4000
  s_add_u32 s41, s41, 0x4000
  s_add_u32 s42, s42, 0x8000
  s_and_b32 s42, s42, 0x1ffff
  s_add_u32 s20, s20, 1
  s_cmp_eq_u32 s20, s21
  s_cselect_b32 s40, s22, s40
  s_sub_u32 s6, s20, 1
  s_cmp_eq_u32 s6, s21
  s_cselect_b32 s40, s23, s40
  s_sub_u32 s6, s20, 2
  s_cmp_eq_u32 s6, s21
  s_cselect_b32 s40, s24, s40
  s_add_u32 s6, s40, 0x4000
  s_cmp_gt_u32 s20, s21
  s_cselect_b32 s41, s6, s41
  s_sub_u32 s45, s45, 5
  s_branch A_DL0
A_NKVR:
  s_sub_u32 s58, s2, 0x60
  s_cmp_ge_u32 s58, 0x80
  s_cbranch_scc1 A_DL0
  s_lshr_b32 s56, s58, 1
  s_and_b32 s57, s58, 1
  s_lshl_b32 s57, s57, 4
  s_lshl_b32 s6, s91, 2
  s_add_u32 s57, s57, s6
  s_mul_i32 s6, s57, 6
  v_min_u32 v5, 23, v1
  v_add_u32 v5, s6, v5
  v_and_b32 v6, 3, v5
  v_lshrrev_b32 v5, 2, v5
  v_lshlrev_b32 v5, 8, v5
  v_lshl_add_u32 v5, v6, 2, v5
  v_add_u32 v116, 0x7c00010, v5
  s_waitcnt vmcnt(8)
  s_barrier
  buffer_load_dword v117, v116, s[8:11], 0 offen sc1
  s_mov_b32 m0, s42
  s_nop 0
  buffer_load_dwordx4 v124, s[8:11], s40 offen sc1 lds
  buffer_load_dwordx4 v124, s[8:11], s40 offen offset:1024 sc1 lds
  buffer_load_dwordx4 v124, s[8:11], s40 offen offset:2048 sc1 lds
  buffer_load_dwordx4 v124, s[8:11], s40 offen offset:3072 sc1 lds
  s_add_u32 m0, s42, 0x4000
  s_nop 0
  buffer_load_dwordx4 v124, s[8:11], s41 offen sc1 lds
  buffer_load_dwordx4 v124, s[8:11], s41 offen offset:1024 sc1 lds
  buffer_load_dwordx4 v124, s[8:11], s41 offen offset:2048 sc1 lds
  buffer_load_dwordx4 v124, s[8:11], s41 offen offset:3072 sc1 lds
  s_add_u32 s40, s40, 0x4000
  s_add_u32 s41, s41, 0x4000
  s_add_u32 s42, s42, 0x8000
  s_and_b32 s42, s42, 0x1ffff
  s_add_u32 s20, s20, 1
  s_cmp_eq_u32 s20, s21
  s_cselect_b32 s40, s22, s40
  s_sub_u32 s6, s20, 1
  s_cmp_eq_u32 s6, s21
  s_cselect_b32 s40, s23, s40
  s_sub_u32 s6, s20, 2
  s_cmp_eq_u32 s6, s21
  s_cselect_b32 s40, s24, s40
  s_add_u32 s6, s40, 0x4000
  s_cmp_gt_u32 s20, s21
  s_cselect_b32 s41, s6, s41
  s_waitcnt vmcnt(8)
  s_barrier
  buffer_store_dword v4, v19, s[8:11], s37 offen offset:64 sc1
  v_cmp_ne_u32 vcc, 1, v117
  s_nop 1
  s_cbranch_vccz SJ_OK71
  s_mov_b32 s38, 0
PL72:
  buffer_load_dword v117, v116, s[8:11], 0 offen sc1
  s_waitcnt vmcnt(0)
  v_cmp_ne_u32 vcc, 1, v117
  s_add_u32 s38, s38, 1
  s_cbranch_vccz PD73
  s_sleep 1
  s_cmp_lt_u32 s38, 0x30d40
  s_cbranch_scc1 PL72
PD73:
SJ_OK71:
  s_lshl_b32 s6, s56, 5
  s_add_u32 s6, s6, s57
  s_mul_i32 s6, s6, 0xc00
  s_add_u32 s6, s6, 0x6000000
  s_mul_i32 s7, s57, 0xc00
  s_add_u32 s7, s7, 0x6f00000
  buffer_load_dwordx4 v[32:35], v2, s[8:11], s6 offen sc1
  buffer_load_dwordx4 a[0:3], v2, s[8:11], s7 offen sc1
  buffer_load_dwordx4 v[36:39], v2, s[8:11], s6 offen offset:1024 sc1
  buffer_load_dwordx4 a[4:7], v2, s[8:11], s7 offen offset:1024 sc1
  buffer_load_dwordx4 v[40:43], v2, s[8:11], s6 offen offset:2048 sc1
  buffer_load_dwordx4 a[8:11], v2, s[8:11], s7 offen offset:2048 sc1
  s_add_u32 s6, s6, 0xc00
  s_add_u32 s7, s7, 0xc00
  buffer_load_dwordx4 v[44:47], v2, s[8:11], s6 offen sc1
  buffer_load_dwordx4 a[12:15], v2, s[8:11], s7 offen sc1
  buffer_load_dwordx4 v[48:51], v2, s[8:11], s6 offen offset:1024 sc1
  buffer_load_dwordx4 a[16:19], v2, s[8:11], s7 offen offset:1024 sc1
  buffer_load_dwordx4 v[52:55], v2, s[8:11], s6 offen offset:2048 sc1
  buffer_load_dwordx4 a[20:23], v2, s[8:11], s7 offen offset:2048 sc1
  s_add_u32 s6, s6, 0xc00
  s_add_u32 s7, s7, 0xc00
  buffer_load_dwordx4 v[56:59], v2, s[8:11], s6 offen sc1
  buffer_load_dwordx4 a[24:27], v2, s[8:11], s7 offen sc1
  buffer_load_dwordx4 v[60:63], v2, s[8:11], s6 offen offset:1024 sc1
  buffer_load_dwordx4 a[28:31], v2, s[8:11], s7 offen offset:1024 sc1
  buffer_load_dwordx4 v[64:67], v2, s[8:11], s6 offen offset:2048 sc1
  buffer_load_dwordx4 a[32:35], v2, s[8:11], s7 offen offset:2048 sc1
  s_add_u32 s6, s6, 0xc00
  s_add_u32 s7, s7, 0xc00
  buffer_load_dwordx4 v[68:71], v2, s[8:11], s6 offen sc1
  buffer_load_dwordx4 a[36:39], v2, s[8:11], s7 offen sc1
  buffer_load_dwordx4 v[72:75], v2, s[8:11], s6 offen offset:1024 sc1
  buffer_load_dwordx4 a[40:43], v2, s[8:11], s7 offen offset:1024 sc1
  buffer_load_dwordx4 v[76:79], v2, s[8:11], s6 offen offset:2048 sc1
  buffer_load_dwordx4 a[44:47], v2, s[8:11], s7 offen offset:2048 sc1
  s_add_u32 s6, s6, 0xc00
  s_add_u32 s7, s7, 0xc00
  s_mov_b32 m0, s42
  s_nop 0
  buffer_load_dwordx4 v124, s[8:11], s40 offen sc1 lds
  buffer_load_dwordx4 v124, s[8:11], s40 offen offset:1024 sc1 lds
  buffer_load_dwordx4 v124, s[8:11], s40 offen offset:2048 sc1 lds
  buffer_load_dwordx4 v124, s[8:11], s40 offen offset:3072 sc1 lds
  s_add_u32 m0, s42, 0x4000
  s_nop 0
  buffer_load_dwordx4 v124, s[8:11], s41 offen sc1 lds
  buffer_load_dwordx4 v124, s[8:11], s41 offen offset:1024 sc1 lds
  buffer_load_dwordx4 v124, s[8:11], s41 offen offset:2048 sc1 lds
  buffer_load_dwordx4 v124, s[8:11], s41 offen offset:3072 sc1 lds
  s_add_u32 s40, s40, 0x4000
  s_add_u32 s41, s41, 0x4000
  s_add_u32 s42, s42, 0x8000
  s_and_b32 s42, s42, 0x1ffff
  s_add_u32 s20, s20, 1
  s_cmp_eq_u32 s20, s21
  s_cselect_b32 s40, s22, s40
  s_sub_u32 s6, s20, 1
  s_cmp_eq_u32 s6, s21
  s_cselect_b32 s40, s23, s40
  s_sub_u32 s6, s20, 2
  s_cmp_eq_u32 s6, s21
  s_cselect_b32 s40, s24, s40
  s_add_u32 s6, s40, 0x4000
  s_cmp_gt_u32 s20, s21
  s_cselect_b32 s41, s6, s41
  s_waitcnt vmcnt(8)
  s_barrier
  s_mul_i32 s90, s56, 36
  s_add_u32 s6, s90, s57
  s_lshl_b32 s6, s6, 10
  s_add_u32 s6, s6, 0x7000000
  s_lshr_b32 s7, s57, 3
  s_add_u32 s7, s7, s90
  s_lshl_b32 s7, s7, 10
  s_add_u32 s7, s7, 0x7008000
  s_and_b32 s90, s57, 7
  s_lshl_b32 s90, s90, 1
  s_add_u32 s7, s7, s90
  v_mfma_f32_32x32x16_bf16 v[80:95], a[0:3], v[32:35], 0
  v_mfma_f32_32x32x16_bf16 v[80:95], a[4:7], v[36:39], v[80:95]
  v_mfma_f32_32x32x16_bf16 v[80:95], a[8:11], v[40:43], v[80:95]
  s_nop 11
  v_add_f32 v5, 0x358637bd, v89
  v_rcp_f32 v5, v5
  s_nop 0
  v_mul_f32 v80, v80, v5
  v_mul_f32 v81, v81, v5
  v_mul_f32 v82, v82, v5
  v_mul_f32 v83, v83, v5
  v_mul_f32 v84, v84, v5
  v_mul_f32 v85, v85, v5
  v_mul_f32 v86, v86, v5
  v_mul_f32 v87, v87, v5
  v_mul_f32 v88, v88, v5
  v_cvt_pk_bf16_f32 v32, v80, v81
  v_cvt_pk_bf16_f32 v33, v82, v83
  v_cvt_pk_bf16_f32 v34, v84, v85
  v_cvt_pk_bf16_f32 v35, v86, v87
  v_mov_b32 v112, v88
  buffer_store_dwordx4 v[32:35], v2, s[8:11], s6 offen sc1
  v_mfma_f32_32x32x16_bf16 v[96:111], a[12:15], v[44:47], 0
  v_mfma_f32_32x32x16_bf16 v[96:111], a[16:19], v[48:51], v[96:111]
  v_mfma_f32_32x32x16_bf16 v[96:111], a[20:23], v[52:55], v[96:111]
  s_nop 11
  v_add_f32 v5, 0x358637bd, v105
  v_rcp_f32 v5, v5
  s_nop 0
  v_mul_f32 v96, v96, v5
  v_mul_f32 v97, v97, v5
  v_mul_f32 v98, v98, v5
  v_mul_f32 v99, v99, v5
  v_mul_f32 v100, v100, v5
  v_mul_f32 v101, v101, v5
  v_mul_f32 v102, v102, v5
  v_mul_f32 v103, v103, v5
  v_mul_f32 v104, v104, v5
  v_cvt_pk_bf16_f32 v44, v96, v97
  v_cvt_pk_bf16_f32 v45, v98, v99
  v_cvt_pk_bf16_f32 v46, v100, v101
  v_cvt_pk_bf16_f32 v47, v102, v103
  v_mov_b32 v113, v104
  buffer_store_dwordx4 v[44:47], v2, s[8:11], s6 offen offset:1024 sc1
  v_mfma_f32_32x32x16_bf16 v[80:95], a[24:27], v[56:59], 0
  v_mfma_f32_32x32x16_bf16 v[80:95], a[28:31], v[60:63], v[80:95]
  v_mfma_f32_32x32x16_bf16 v[80:95], a[32:35], v[64:67], v[80:95]
  s_nop 11
  v_add_f32 v5, 0x358637bd, v89
  v_rcp_f32 v5, v5
  s_nop 0
  v_mul_f32 v80, v80, v5
  v_mul_f32 v81, v81, v5
  v_mul_f32 v82, v82, v5
  v_mul_f32 v83, v83, v5
  v_mul_f32 v84, v84, v5
  v_mul_f32 v85, v85, v5
  v_mul_f32 v86, v86, v5
  v_mul_f32 v87, v87, v5
  v_mul_f32 v88, v88, v5
  v_cvt_pk_bf16_f32 v56, v80, v81
  v_cvt_pk_bf16_f32 v57, v82, v83
  v_cvt_pk_bf16_f32 v58, v84, v85
  v_cvt_pk_bf16_f32 v59, v86, v87
  v_mov_b32 v114, v88
  buffer_store_dwordx4 v[56:59], v2, s[8:11], s6 offen offset:2048 sc1
  v_mfma_f32_32x32x16_bf16 v[96:111], a[36:39], v[68:71], 0
  v_mfma_f32_32x32x16_bf16 v[96:111], a[40:43], v[72:75], v[96:111]
  v_mfma_f32_32x32x16_bf16 v[96:111], a[44:47], v[76:79], v[96:111]
  s_nop 11
  v_add_f32 v5, 0x358637bd, v105
  v_rcp_f32 v5, v5
  s_nop 0
  v_mul_f32 v96, v96, v5
  v_mul_f32 v97, v97, v5
  v_mul_f32 v98, v98, v5
  v_mul_f32 v99, v99, v5
  v_mul_f32 v100, v100, v5
  v_mul_f32 v101, v101, v5
  v_mul_f32 v102, v102, v5
  v_mul_f32 v103, v103, v5
  v_mul_f32 v104, v104, v5
  v_cvt_pk_bf16_f32 v68, v96, v97
  v_cvt_pk_bf16_f32 v69, v98, v99
  v_cvt_pk_bf16_f32 v70, v100, v101
  v_cvt_pk_bf16_f32 v71, v102, v103
  v_mov_b32 v115, v104
  buffer_store_dwordx4 v[68:71], v2, s[8:11], s6 offen offset:3072 sc1
  v_cvt_pk_bf16_f32 v112, v112, v113
  v_cvt_pk_bf16_f32 v113, v114, v115
  buffer_store_dwordx2 v[112:113], v2, s[8:11], s7 offen sc1
  s_mov_b32 m0, s42
  s_nop 0
  buffer_load_dwordx4 v124, s[8:11], s40 offen sc1 lds
  buffer_load_dwordx4 v124, s[8:11], s40 offen offset:1024 sc1 lds
  buffer_load_dwordx4 v124, s[8:11], s40 offen offset:2048 sc1 lds
  buffer_load_dwordx4 v124, s[8:11], s40 offen offset:3072 sc1 lds
  s_add_u32 m0, s42, 0x4000
  s_nop 0
  buffer_load_dwordx4 v124, s[8:11], s41 offen sc1 lds
  buffer_load_dwordx4 v124, s[8:11], s41 offen offset:1024 sc1 lds
  buffer_load_dwordx4 v124, s[8:11], s41 offen offset:2048 sc1 lds
  buffer_load_dwordx4 v124, s[8:11], s41 offen offset:3072 sc1 lds
  s_add_u32 s40, s40, 0x4000
  s_add_u32 s41, s41, 0x4000
  s_add_u32 s42, s42, 0x8000
  s_and_b32 s42, s42, 0x1ffff
  s_add_u32 s20, s20, 1
  s_cmp_eq_u32 s20, s21
  s_cselect_b32 s40, s22, s40
  s_sub_u32 s6, s20, 1
  s_cmp_eq_u32 s6, s21
  s_cselect_b32 s40, s23, s40
  s_sub_u32 s6, s20, 2
  s_cmp_eq_u32 s6, s21
  s_cselect_b32 s40, s24, s40
  s_add_u32 s6, s40, 0x4000
  s_cmp_gt_u32 s20, s21
  s_cselect_b32 s41, s6, s41
  s_waitcnt vmcnt(8)
  s_barrier
  buffer_store_dword v4, v19, s[8:11], s37 offen offset:32 sc1
  s_mov_b32 m0, s42
  s_nop 0
  buffer_load_dwordx4 v124, s[8:11], s40 offen sc1 lds
  buffer_load_dwordx4 v124, s[8:11], s40 offen offset:1024 sc1 lds
  buffer_load_dwordx4 v124, s[8:11], s40 offen offset:2048 sc1 lds
  buffer_load_dwordx4 v124, s[8:11], s40 offen offset:3072 sc1 lds
  s_add_u32 m0, s42, 0x4000
  s_nop 0
  buffer_load_dwordx4 v124, s[8:11], s41 offen sc1 lds
  buffer_load_dwordx4 v124, s[8:11], s41 offen offset:1024 sc1 lds
  buffer_load_dwordx4 v124, s[8:11], s41 offen offset:2048 sc1 lds
  buffer_load_dwordx4 v124, s[8:11], s41 offen offset:3072 sc1 lds
  s_add_u32 s40, s40, 0x4000
  s_add_u32 s41, s41, 0x4000
  s_add_u32 s42, s42, 0x8000
  s_and_b32 s42, s42, 0x1ffff
  s_add_u32 s20, s20, 1
  s_cmp_eq_u32 s20, s21
  s_cselect_b32 s40, s22, s40
  s_sub_u32 s6, s20, 1
  s_cmp_eq_u32 s6, s21
  s_cselect_b32 s40, s23, s40
  s_sub_u32 s6, s20, 2
  s_cmp_eq_u32 s6, s21
  s_cselect_b32 s40, s24, s40
  s_add_u32 s6, s40, 0x4000
  s_cmp_gt_u32 s20, s21
  s_cselect_b32 s41, s6, s41
  s_sub_u32 s45, s45, 4
A_DL0:
  s_cmp_lt_u32 s45, 0x3e8
  s_cbranch_scc1 A_DL1
  s_waitcnt vmcnt(8)
  s_barrier
  s_mov_b32 m0, s42
  s_nop 0
  buffer_load_dwordx4 v124, s[8:11], s40 offen sc1 lds
  buffer_load_dwordx4 v124, s[8:11], s40 offen offset:1024 sc1 lds
  buffer_load_dwordx4 v124, s[8:11], s40 offen offset:2048 sc1 lds
  buffer_load_dwordx4 v124, s[8:11], s40 offen offset:3072 sc1 lds
  s_add_u32 m0, s42, 0x4000
  s_nop 0
  buffer_load_dwordx4 v124, s[8:11], s41 offen sc1 lds
  buffer_load_dwordx4 v124, s[8:11], s41 offen offset:1024 sc1 lds
  buffer_load_dwordx4 v124, s[8:11], s41 offen offset:2048 sc1 lds
  buffer_load_dwordx4 v124, s[8:11], s41 offen offset:3072 sc1 lds
  s_add_u32 s40, s40, 0x4000
  s_add_u32 s41, s41, 0x4000
  s_add_u32 s42, s42, 0x8000
  s_and_b32 s42, s42, 0x1ffff
  s_add_u32 s20, s20, 1
  s_cmp_eq_u32 s20, s21
  s_cselect_b32 s40, s22, s40
  s_sub_u32 s6, s20, 1
  s_cmp_eq_u32 s6, s21
  s_cselect_b32 s40, s23, s40
  s_sub_u32 s6, s20, 2
  s_cmp_eq_u32 s6, s21
  s_cselect_b32 s40, s24, s40
  s_add_u32 s6, s40, 0x4000
  s_cmp_gt_u32 s20, s21
  s_cselect_b32 s41, s6, s41
  s_waitcnt vmcnt(8)
  s_barrier
  buffer_store_dword v4, v19, s[8:11], s37 offen offset:64 sc1
  s_mov_b32 m0, s42
  s_nop 0
  buffer_load_dwordx4 v124, s[8:11], s40 offen sc1 lds
  buffer_load_dwordx4 v124, s[8:11], s40 offen offset:1024 sc1 lds
  buffer_load_dwordx4 v124, s[8:11], s40 offen offset:2048 sc1 lds
  buffer_load_dwordx4 v124, s[8:11], s40 offen offset:3072 sc1 lds
  s_add_u32 m0, s42, 0x4000
  s_nop 0
  buffer_load_dwordx4 v124, s[8:11], s41 offen sc1 lds
  buffer_load_dwordx4 v124, s[8:11], s41 offen offset:1024 sc1 lds
  buffer_load_dwordx4 v124, s[8:11], s41 offen offset:2048 sc1 lds
  buffer_load_dwordx4 v124, s[8:11], s41 offen offset:3072 sc1 lds
  s_add_u32 s40, s40, 0x4000
  s_add_u32 s41, s41, 0x4000
  s_add_u32 s42, s42, 0x8000
  s_and_b32 s42, s42, 0x1ffff
  s_add_u32 s20, s20, 1
  s_cmp_eq_u32 s20, s21
  s_cselect_b32 s40, s22, s40
  s_sub_u32 s6, s20, 1
  s_cmp_eq_u32 s6, s21
  s_cselect_b32 s40, s23, s40
  s_sub_u32 s6, s20, 2
  s_cmp_eq_u32 s6, s21
  s_cselect_b32 s40, s24, s40
  s_add_u32 s6, s40, 0x4000
  s_cmp_gt_u32 s20, s21
  s_cselect_b32 s41, s6, s41
  s_waitcnt vmcnt(8)
  s_barrier
  s_mov_b32 s38, 0
PL74:
  buffer_load_dword v21, v20, s[8:11], 0 offen sc1
  s_waitcnt vmcnt(0)
  v_cmp_ne_u32 vcc, 1, v21
  s_add_u32 s38, s38, 1
  s_cbranch_vccz PD75
  s_sleep 1
  s_cmp_lt_u32 s38, 0x30d40
  s_cbranch_scc1 PL74
PD75:
  s_add_u32 s6, s47, 1
  s_and_b32 s6, s6, 3
  s_lshl_b32 s7, s46, 2
  s_add_u32 s6, s6, s7
  s_add_u32 s6, s6, s96
  s_lshl_b32 s6, s6, 13
  s_add_u32 s6, s6, 0x2000000
  s_add_u32 s7, s6, 0x1000
  buffer_load_dwordx4 a[0:3], v2, s[8:11], s6 offen offset:0 sc1
  buffer_load_dwordx4 a[4:7], v2, s[8:11], s6 offen offset:1024 sc1
  buffer_load_dwordx4 a[8:11], v2, s[8:11], s6 offen offset:2048 sc1
  buffer_load_dwordx4 a[12:15], v2, s[8:11], s6 offen offset:3072 sc1
  buffer_load_dwordx4 a[16:19], v2, s[8:11], s7 offen offset:0 sc1
  buffer_load_dwordx4 a[20:23], v2, s[8:11], s7 offen offset:1024 sc1
  buffer_load_dwordx4 a[24:27], v2, s[8:11], s7 offen offset:2048 sc1
  buffer_load_dwordx4 a[28:31], v2, s[8:11], s7 offen offset:3072 sc1
  s_add_u32 s6, s47, 2
  s_and_b32 s6, s6, 3
  s_lshl_b32 s7, s46, 2
  s_add_u32 s6, s6, s7
  s_add_u32 s6, s6, s96
  s_lshl_b32 s6, s6, 13
  s_add_u32 s6, s6, 0x2000000
  s_add_u32 s7, s6, 0x1000
  buffer_load_dwordx4 a[32:35], v2, s[8:11], s6 offen offset:0 sc1
  buffer_load_dwordx4 a[36:39], v2, s[8:11], s6 offen offset:1024 sc1
  buffer_load_dwordx4 a[40:43], v2, s[8:11], s6 offen offset:2048 sc1
  buffer_load_dwordx4 a[44:47], v2, s[8:11], s6 offen offset:3072 sc1
  buffer_load_dwordx4 a[48:51], v2, s[8:11], s7 offen offset:0 sc1
  buffer_load_dwordx4 a[52:55], v2, s[8:11], s7 offen offset:1024 sc1
  buffer_load_dwordx4 a[56:59], v2, s[8:11], s7 offen offset:2048 sc1
  buffer_load_dwordx4 a[60:63], v2, s[8:11], s7 offen offset:3072 sc1
  s_add_u32 s6, s47, 3
  s_and_b32 s6, s6, 3
  s_lshl_b32 s7, s46, 2
  s_add_u32 s6, s6, s7
  s_add_u32 s6, s6, s96
  s_lshl_b32 s6, s6, 13
  s_add_u32 s6, s6, 0x2000000
  s_add_u32 s7, s6, 0x1000
  buffer_load_dwordx4 a[96:99], v2, s[8:11], s6 offen offset:0 sc1
  buffer_load_dwordx4 a[100:103], v2, s[8:11], s6 offen offset:1024 sc1
  buffer_load_dwordx4 a[104:107], v2, s[8:11], s6 offen offset:2048 sc1
  buffer_load_dwordx4 a[108:111], v2, s[8:11], s6 offen offset:3072 sc1
  buffer_load_dwordx4 a[112:115], v2, s[8:11], s7 offen offset:0 sc1
  buffer_load_dwordx4 a[116:119], v2, s[8:11], s7 offen offset:1024 sc1
  buffer_load_dwordx4 a[120:123], v2, s[8:11], s7 offen offset:2048 sc1
  buffer_load_dwordx4 a[124:127], v2, s[8:11], s7 offen offset:3072 sc1
  s_mov_b32 m0, s42
  s_nop 0
  buffer_load_dwordx4 v124, s[8:11], s40 offen sc1 lds
  buffer_load_dwordx4 v124, s[8:11], s40 offen offset:1024 sc1 lds
  buffer_load_dwordx4 v124, s[8:11], s40 offen offset:2048 sc1 lds
  buffer_load_dwordx4 v124, s[8:11], s40 offen offset:3072 sc1 lds
  s_add_u32 m0, s42, 0x4000
  s_nop 0
  buffer_load_dwordx4 v124, s[8:11], s41 offen sc1 lds
  buffer_load_dwordx4 v124, s[8:11], s41 offen offset:1024 sc1 lds
  buffer_load_dwordx4 v124, s[8:11], s41 offen offset:2048 sc1 lds
  buffer_load_dwordx4 v124, s[8:11], s41 offen offset:3072 sc1 lds
  s_add_u32 s40, s40, 0x4000
  s_add_u32 s41, s41, 0x4000
  s_add_u32 s42, s42, 0x8000
  s_and_b32 s42, s42, 0x1ffff
  s_add_u32 s20, s20, 1
  s_cmp_eq_u32 s20, s21
  s_cselect_b32 s40, s22, s40
  s_sub_u32 s6, s20, 1
  s_cmp_eq_u32 s6, s21
  s_cselect_b32 s40, s23, s40
  s_sub_u32 s6, s20, 2
  s_cmp_eq_u32 s6, s21
  s_cselect_b32 s40, s24, s40
  s_add_u32 s6, s40, 0x4000
  s_cmp_gt_u32 s20, s21
  s_cselect_b32 s41, s6, s41
  s_sub_u32 s45, s45, 3
  s_mov_b32 s27, 0
A_DL1:
A_DL:
  s_waitcnt vmcnt(8)
  s_barrier
  s_mov_b32 m0, s42
  s_nop 0
  buffer_load_dwordx4 v124, s[8:11], s40 offen sc1 lds
  buffer_load_dwordx4 v124, s[8:11], s40 offen offset:1024 sc1 lds
  buffer_load_dwordx4 v124, s[8:11], s40 offen offset:2048 sc1 lds
  buffer_load_dwordx4 v124, s[8:11], s40 offen offset:3072 sc1 lds
  s_add_u32 m0, s42, 0x4000
  s_nop 0
  buffer_load_dwordx4 v124, s[8:11], s41 offen sc1 lds
  buffer_load_dwordx4 v124, s[8:11], s41 offen offset:1024 sc1 lds
  buffer_load_dwordx4 v124, s[8:11], s41 offen offset:2048 sc1 lds
  buffer_load_dwordx4 v124, s[8:11], s41 offen offset:3072 sc1 lds
  s_add_u32 s40, s40, 0x4000
  s_add_u32 s41, s41, 0x4000
  s_add_u32 s42, s42, 0x8000
  s_and_b32 s42, s42, 0x1ffff
  s_add_u32 s20, s20, 1
  s_cmp_eq_u32 s20, s21
  s_cselect_b32 s40, s22, s40
  s_sub_u32 s6, s20, 1
  s_cmp_eq_u32 s6, s21
  s_cselect_b32 s40, s23, s40
  s_sub_u32 s6, s20, 2
  s_cmp_eq_u32 s6, s21
  s_cselect_b32 s40, s24, s40
  s_add_u32 s6, s40, 0x4000
  s_cmp_gt_u32 s20, s21
  s_cselect_b32 s41, s6, s41
  s_sub_u32 s45, s45, 1
  s_cmp_lg_u32 s45, 0
  s_cbranch_scc1 A_DL
  s_waitcnt vmcnt(0)
  buffer_store_dword v4, v19, s[8:11], s37 offen offset:64 sc1
A_DONE:
  s_barrier
  s_lshl_b32 s7, s39, 14
  s_add_u32 s6, s25, s7
  s_add_u32 s7, s7, s50
  s_add_u32 m0, s7, s48
  s_nop 0
  buffer_load_dwordx4 v124, s[8:11], s6 offen sc1 lds
  buffer_load_dwordx4 v124, s[8:11], s6 offen offset:1024 sc1 lds
  buffer_load_dwordx4 v124, s[8:11], s6 offen offset:2048 sc1 lds
  buffer_load_dwordx4 v124, s[8:11], s6 offen offset:3072 sc1 lds
  s_lshl_b32 s49, s35, 2
  s_add_u32 s49, s49, s47
  s_lshl_b32 s49, s49, 3
  s_add_u32 s6, s49, s3
  s_lshl_b32 s6, s6, 3
  s_add_u32 s6, s6, s46
  s_mul_i32 s6, s6, 0x2400
  s_add_u32 s40, s6, 0x3800000
  s_add_u32 s41, s40, 0x1000
  s_add_u32 s42, s40, 0x2000
  ds_read_b128 v[112:115], v22
  ds_read_b128 v[116:119], v22 offset:1024
  ds_read_b128 v[120:123], v22 offset:2048
  ds_read_b128 v[10:13], v22 offset:3072
  v_mov_b32 v6, 0x7fffff00
  v_mov_b32 v5, 0x7c000fc
  v_cmp_eq_u32 vcc, 0, v1
  s_nop 1
  v_cndmask_b32 v28, v6, v5, vcc
  s_waitcnt lgkmcnt(3)
  v_mfma_f32_32x32x16_bf16 v[32:47], v[112:115], a[64:67], 0
  ds_read_b128 v[14:17], v26
  s_waitcnt lgkmcnt(3)
  v_mfma_f32_32x32x16_bf16 v[48:63], v[116:119], a[64:67], 0
  ds_read_b128 v[112:115], v22 offset:4096
  s_waitcnt lgkmcnt(3)
  v_mfma_f32_32x32x16_bf16 v[64:79], v[120:123], a[64:67], 0
  ds_read_b128 v[116:119], v22 offset:5120
  s_waitcnt lgkmcnt(3)
  v_mfma_f32_32x32x16_bf16 v[80:95], v[10:13], a[64:67], 0
  ds_read_b128 v[120:123], v22 offset:6144
  s_cmp_eq_u32 s39, 0
  s_cbranch_scc1 ONLY76
  s_waitcnt vmcnt(4)
  buffer_store_dword v4, v19, s[8:11], s37 offen offset:64 sc1
ONLY76:
  s_waitcnt lgkmcnt(3)
  v_mfma_f32_32x32x16_bf16 v[96:111], v[14:17], a[64:67], 0
  ds_read_b128 v[10:13], v22 offset:7168
  s_waitcnt lgkmcnt(3)
  v_mfma_f32_32x32x16_bf16 v[32:47], v[112:115], a[68:71], v[32:47]
  ds_read_b128 v[14:17], v26 offset:512
  s_waitcnt lgkmcnt(3)
  v_mfma_f32_32x32x16_bf16 v[48:63], v[116:119], a[68:71], v[48:63]
  ds_read_b128 v[112:115], v22 offset:8192
  s_waitcnt lgkmcnt(3)
  v_mfma_f32_32x32x16_bf16 v[64:79], v[120:123], a[68:71], v[64:79]
  ds_read_b128 v[116:119], v22 offset:9216
  s_waitcnt lgkmcnt(3)
  v_mfma_f32_32x32x16_bf16 v[80:95], v[10:13], a[68:71], v[80:95]
  ds_read_b128 v[120:123], v22 offset:10240
  s_waitcnt lgkmcnt(3)
  v_mfma_f32_32x32x16_bf16 v[96:111], v[14:17], a[68:71], v[96:111]
  ds_read_b128 v[10:13], v22 offset:11264
  s_waitcnt lgkmcnt(3)
  v_mfma_f32_32x32x16_bf16 v[32:47], v[112:115], a[72:75], v[32:47]
  ds_read_b128 v[14:17], v26 offset:1024
  s_waitcnt lgkmcnt(3)
  v_mfma_f32_32x32x16_bf16 v[48:63], v[116:119], a[72:75], v[48:63]
  ds_read_b128 v[112:115], v22 offset:12288
  s_waitcnt lgkmcnt(3)
  v_mfma_f32_32x32x16_bf16 v[64:79], v[120:123], a[72:75], v[64:79]
  ds_read_b128 v[116:119], v22 offset:13312
  s_waitcnt lgkmcnt(3)
  v_mfma_f32_32x32x16_bf16 v[80:95], v[10:13], a[72:75], v[80:95]
  ds_read_b128 v[120:123], v22 offset:14336
  s_waitcnt lgkmcnt(3)
  v_mfma_f32_32x32x16_bf16 v[96:111], v[14:17], a[72:75], v[96:111]
  ds_read_b128 v[10:13], v22 offset:15360
  s_waitcnt lgkmcnt(3)
  v_mfma_f32_32x32x16_bf16 v[32:47], v[112:115], a[76:79], v[32:47]
  ds_read_b128 v[14:17], v26 offset:1536
  s_waitcnt lgkmcnt(3)
  v_mfma_f32_32x32x16_bf16 v[48:63], v[116:119], a[76:79], v[48:63]
  ds_read_b128 v[112:115], v22 offset:16384
  s_waitcnt lgkmcnt(3)
  v_mfma_f32_32x32x16_bf16 v[64:79], v[120:123], a[76:79], v[64:79]
  ds_read_b128 v[116:119], v22 offset:17408
  s_waitcnt lgkmcnt(3)
  v_mfma_f32_32x32x16_bf16 v[80:95], v[10:13], a[76:79], v[80:95]
  ds_read_b128 v[120:123], v22 offset:18432
  s_waitcnt lgkmcnt(3)
  v_mfma_f32_32x32x16_bf16 v[96:111], v[14:17], a[76:79], v[96:111]
  ds_read_b128 v[10:13], v22 offset:19456
  s_waitcnt lgkmcnt(3)
  v_mfma_f32_32x32x16_bf16 v[32:47], v[112:115], a[80:83], v[32:47]
  ds_read_b128 v[14:17], v26 offset:2048
  s_waitcnt lgkmcnt(3)
  v_mfma_f32_32x32x16_bf16 v[48:63], v[116:119], a[80:83], v[48:63]
  ds_read_b128 v[112:115], v22 offset:20480
  s_waitcnt lgkmcnt(3)
  v_mfma_f32_32x32x16_bf16 v[64:79], v[120:123], a[80:83], v[64:79]
  ds_read_b128 v[116:119], v22 offset:21504
  s_waitcnt lgkmcnt(3)
  v_mfma_f32_32x32x16_bf16 v[80:95], v[10:13], a[80:83], v[80:95]
  ds_read_b128 v[120:123], v22 offset:22528
  s_waitcnt lgkmcnt(3)
  v_mfma_f32_32x32x16_bf16 v[96:111], v[14:17], a[80:83], v[96:111]
  ds_read_b128 v[10:13], v22 offset:23552
  s_mov_b32 s38, 0
PL77:
  buffer_load_dword v21, v20, s[8:11], 0 offen sc1
  s_waitcnt vmcnt(0)
  v_cmp_ne_u32 vcc, 1, v21
  s_add_u32 s38, s38, 1
  s_cbranch_vccz PD78
  s_sleep 1
  s_cmp_lt_u32 s38, 0x30d40
  s_cbranch_scc1 PL77
PD78:
  s_add_u32 s6, s47, 1
  s_and_b32 s6, s6, 3
  s_lshl_b32 s7, s46, 2
  s_add_u32 s6, s6, s7
  s_add_u32 s6, s6, s96
  s_lshl_b32 s6, s6, 13
  s_add_u32 s6, s6, 0x2000000
  s_add_u32 s7, s6, 0x1000
  buffer_load_dwordx4 a[0:3], v2, s[8:11], s6 offen offset:0 sc1
  buffer_load_dwordx4 a[4:7], v2, s[8:11], s6 offen offset:1024 sc1
  buffer_load_dwordx4 a[8:11], v2, s[8:11], s6 offen offset:2048 sc1
  buffer_load_dwordx4 a[12:15], v2, s[8:11], s6 offen offset:3072 sc1
  buffer_load_dwordx4 a[16:19], v2, s[8:11], s7 offen offset:0 sc1
  buffer_load_dwordx4 a[20:23], v2, s[8:11], s7 offen offset:1024 sc1
  buffer_load_dwordx4 a[24:27], v2, s[8:11], s7 offen offset:2048 sc1
  buffer_load_dwordx4 a[28:31], v2, s[8:11], s7 offen offset:3072 sc1
  s_add_u32 s6, s47, 2
  s_and_b32 s6, s6, 3
  s_lshl_b32 s7, s46, 2
  s_add_u32 s6, s6, s7
  s_add_u32 s6, s6, s96
  s_lshl_b32 s6, s6, 13
  s_add_u32 s6, s6, 0x2000000
  s_add_u32 s7, s6, 0x1000
  buffer_load_dwordx4 a[32:35], v2, s[8:11], s6 offen offset:0 sc1
  buffer_load_dwordx4 a[36:39], v2, s[8:11], s6 offen offset:1024 sc1
  buffer_load_dwordx4 a[40:43], v2, s[8:11], s6 offen offset:2048 sc1
  buffer_load_dwordx4 a[44:47], v2, s[8:11], s6 offen offset:3072 sc1
  buffer_load_dwordx4 a[48:51], v2, s[8:11], s7 offen offset:0 sc1
  buffer_load_dwordx4 a[52:55], v2, s[8:11], s7 offen offset:1024 sc1
  buffer_load_dwordx4 a[56:59], v2, s[8:11], s7 offen offset:2048 sc1
  buffer_load_dwordx4 a[60:63], v2, s[8:11], s7 offen offset:3072 sc1
  s_add_u32 s6, s47, 3
  s_and_b32 s6, s6, 3
  s_lshl_b32 s7, s46, 2
  s_add_u32 s6, s6, s7
  s_add_u32 s6, s6, s96
  s_lshl_b32 s6, s6, 13
  s_add_u32 s6, s6, 0x2000000
  s_add_u32 s7, s6, 0x1000
  buffer_load_dwordx4 a[96:99], v2, s[8:11], s6 offen offset:0 sc1
  buffer_load_dwordx4 a[100:103], v2, s[8:11], s6 offen offset:1024 sc1
  buffer_load_dwordx4 a[104:107], v2, s[8:11], s6 offen offset:2048 sc1
  buffer_load_dwordx4 a[108:111], v2, s[8:11], s6 offen offset:3072 sc1
  buffer_load_dwordx4 a[112:115], v2, s[8:11], s7 offen offset:0 sc1
  buffer_load_dwordx4 a[116:119], v2, s[8:11], s7 offen offset:1024 sc1
  buffer_load_dwordx4 a[120:123], v2, s[8:11], s7 offen offset:2048 sc1
  buffer_load_dwordx4 a[124:127], v2, s[8:11], s7 offen offset:3072 sc1
  s_waitcnt lgkmcnt(3)
  v_mfma_f32_32x32x16_bf16 v[32:47], v[112:115], a[84:87], v[32:47]
  ds_read_b128 v[14:17], v26 offset:2560
  s_waitcnt lgkmcnt(3)
  v_mfma_f32_32x32x16_bf16 v[48:63], v[116:119], a[84:87], v[48:63]
  ds_read_b128 v[112:115], v22 offset:24576
  s_waitcnt lgkmcnt(3)
  v_mfma_f32_32x32x16_bf16 v[64:79], v[120:123], a[84:87], v[64:79]
  ds_read_b128 v[116:119], v22 offset:25600
  s_waitcnt lgkmcnt(3)
  v_mfma_f32_32x32x16_bf16 v[80:95], v[10:13], a[84:87], v[80:95]
  ds_read_b128 v[120:123], v22 offset:26624
  s_waitcnt lgkmcnt(3)
  v_mfma_f32_32x32x16_bf16 v[96:111], v[14:17], a[84:87], v[96:111]
  ds_read_b128 v[10:13], v22 offset:27648
  s_waitcnt lgkmcnt(3)
  v_mfma_f32_32x32x16_bf16 v[32:47], v[112:115], a[88:91], v[32:47]
  ds_read_b128 v[14:17], v26 offset:3072
  s_waitcnt lgkmcnt(3)
  v_mfma_f32_32x32x16_bf16 v[48:63], v[116:119], a[88:91], v[48:63]
  ds_read_b128 v[112:115], v22 offset:28672
  s_waitcnt lgkmcnt(3)
  v_mfma_f32_32x32x16_bf16 v[64:79], v[120:123], a[88:91], v[64:79]
  ds_read_b128 v[116:119], v22 offset:29696
  s_waitcnt lgkmcnt(3)
  v_mfma_f32_32x32x16_bf16 v[80:95], v[10:13], a[88:91], v[80:95]
  ds_read_b128 v[120:123], v22 offset:30720
  s_waitcnt lgkmcnt(3)
  v_mfma_f32_32x32x16_bf16 v[96:111], v[14:17], a[88:91], v[96:111]
  ds_read_b128 v[10:13], v22 offset:31744
  s_waitcnt lgkmcnt(3)
  v_mfma_f32_32x32x16_bf16 v[32:47], v[112:115], a[92:95], v[32:47]
  ds_read_b128 v[14:17], v26 offset:3584
  s_waitcnt lgkmcnt(3)
  v_mfma_f32_32x32x16_bf16 v[48:63], v[116:119], a[92:95], v[48:63]
  ds_read_b128 v[112:115], v23
  s_waitcnt lgkmcnt(3)
  v_mfma_f32_32x32x16_bf16 v[64:79], v[120:123], a[92:95], v[64:79]
  ds_read_b128 v[116:119], v23 offset:4096
  s_waitcnt lgkmcnt(3)
  v_mfma_f32_32x32x16_bf16 v[80:95], v[10:13], a[92:95], v[80:95]
  ds_read_b128 v[120:123], v23 offset:8192
  s_waitcnt lgkmcnt(3)
  v_mfma_f32_32x32x16_bf16 v[96:111], v[14:17], a[92:95], v[96:111]
  ds_read_b128 v[10:13], v23 offset:12288
  s_waitcnt vmcnt(16)
  s_waitcnt lgkmcnt(3)
  v_mfma_f32_32x32x16_bf16 v[32:47], v[112:115], a[0:3], v[32:47]
  ds_read_b128 v[14:17], v23 offset:16384
  s_waitcnt lgkmcnt(3)
  v_mfma_f32_32x32x16_bf16 v[32:47], v[116:119], a[4:7], v[32:47]
  ds_read_b128 v[112:115], v23 offset:20480
  s_waitcnt lgkmcnt(3)
  v_mfma_f32_32x32x16_bf16 v[32:47], v[120:123], a[8:11], v[32:47]
  ds_read_b128 v[116:119], v23 offset:24576
  s_waitcnt lgkmcnt(3)
  v_mfma_f32_32x32x16_bf16 v[32:47], v[10:13], a[12:15], v[32:47]
  ds_read_b128 v[120:123], v23 offset:28672
  s_waitcnt lgkmcnt(3)
  v_mfma_f32_32x32x16_bf16 v[32:47], v[14:17], a[16:19], v[32:47]
  ds_read_b128 v[10:13], v24
  s_waitcnt lgkmcnt(3)
  v_mfma_f32_32x32x16_bf16 v[32:47], v[112:115], a[20:23], v[32:47]
  ds_read_b128 v[14:17], v24 offset:4096
  s_waitcnt lgkmcnt(3)
  v_mfma_f32_32x32x16_bf16 v[32:47], v[116:119], a[24:27], v[32:47]
  ds_read_b128 v[112:115], v24 offset:8192
  s_waitcnt lgkmcnt(3)
  v_mfma_f32_32x32x16_bf16 v[32:47], v[120:123], a[28:31], v[32:47]
  ds_read_b128 v[116:119], v24 offset:12288
  s_waitcnt vmcnt(8)
  s_waitcnt lgkmcnt(3)
  v_mfma_f32_32x32x16_bf16 v[32:47], v[10:13], a[32:35], v[32:47]
  s_barrier
  ds_read_b128 v[120:123], v24 offset:16384
  s_waitcnt lgkmcnt(3)
  v_mfma_f32_32x32x16_bf16 v[32:47], v[14:17], a[36:39], v[32:47]
  ds_read_b128 v[10:13], v24 offset:20480
  s_waitcnt lgkmcnt(3)
  v_mfma_f32_32x32x16_bf16 v[32:47], v[112:115], a[40:43], v[32:47]
  ds_read_b128 v[14:17], v24 offset:24576
  s_waitcnt lgkmcnt(3)
  v_mfma_f32_32x32x16_bf16 v[32:47], v[116:119], a[44:47], v[32:47]
  ds_read_b128 v[112:115], v24 offset:28672
  s_waitcnt lgkmcnt(3)
  v_mfma_f32_32x32x16_bf16 v[32:47], v[120:123], a[48:51], v[32:47]
  ds_read_b128 v[116:119], v25
  s_waitcnt lgkmcnt(3)
  v_mfma_f32_32x32x16_bf16 v[32:47], v[10:13], a[52:55], v[32:47]
  ds_read_b128 v[120:123], v25 offset:4096
  s_waitcnt lgkmcnt(3)
  v_mfma_f32_32x32x16_bf16 v[32:47], v[14:17], a[56:59], v[32:47]
  ds_read_b128 v[10:13], v25 offset:8192
  s_waitcnt lgkmcnt(3)
  v_mfma_f32_32x32x16_bf16 v[32:47], v[112:115], a[60:63], v[32:47]
  ds_read_b128 v[14:17], v25 offset:12288
  s_waitcnt vmcnt(0)
  s_waitcnt lgkmcnt(3)
  v_mfma_f32_32x32x16_bf16 v[32:47], v[116:119], a[96:99], v[32:47]
  ds_read_b128 v[112:115], v25 offset:16384
  s_waitcnt lgkmcnt(3)
  v_mfma_f32_32x32x16_bf16 v[32:47], v[120:123], a[100:103], v[32:47]
  ds_read_b128 v[116:119], v25 offset:20480
  s_waitcnt lgkmcnt(3)
  v_mfma_f32_32x32x16_bf16 v[32:47], v[10:13], a[104:107], v[32:47]
  ds_read_b128 v[120:123], v25 offset:24576
  s_waitcnt lgkmcnt(3)
  v_mfma_f32_32x32x16_bf16 v[32:47], v[14:17], a[108:111], v[32:47]
  ds_read_b128 v[10:13], v25 offset:28672
  s_waitcnt lgkmcnt(3)
  v_mfma_f32_32x32x16_bf16 v[32:47], v[112:115], a[112:115], v[32:47]
  ds_read_b128 v[14:17], v23 offset:1024
  s_waitcnt lgkmcnt(3)
  v_mfma_f32_32x32x16_bf16 v[32:47], v[116:119], a[116:119], v[32:47]
  ds_read_b128 v[112:115], v23 offset:5120
  s_waitcnt lgkmcnt(3)
  v_mfma_f32_32x32x16_bf16 v[32:47], v[120:123], a[120:123], v[32:47]
  ds_read_b128 v[116:119], v23 offset:9216
  s_waitcnt lgkmcnt(3)
  v_mfma_f32_32x32x16_bf16 v[32:47], v[10:13], a[124:127], v[32:47]
  ds_read_b128 v[120:123], v23 offset:13312
  s_waitcnt lgkmcnt(3)
  v_mfma_f32_32x32x16_bf16 v[48:63], v[14:17], a[0:3], v[48:63]
  ds_read_b128 v[10:13], v23 offset:17408
  s_waitcnt lgkmcnt(3)
  v_mfma_f32_32x32x16_bf16 v[48:63], v[112:115], a[4:7], v[48:63]
  ds_read_b128 v[14:17], v23 offset:21504
  s_waitcnt lgkmcnt(3)
  v_mfma_f32_32x32x16_bf16 v[48:63], v[116:119], a[8:11], v[48:63]
  ds_read_b128 v[112:115], v23 offset:25600
  s_waitcnt lgkmcnt(3)
  v_mfma_f32_32x32x16_bf16 v[48:63], v[120:123], a[12:15], v[48:63]
  ds_read_b128 v[116:119], v23 offset:29696
  s_waitcnt lgkmcnt(3)
  v_mfma_f32_32x32x16_bf16 v[48:63], v[10:13], a[16:19], v[48:63]
  ds_read_b128 v[120:123], v24 offset:1024
  v_cvt_pk_bf16_f32 v32, v32, v33
  v_cvt_pk_bf16_f32 v33, v34, v35
  s_waitcnt lgkmcnt(3)
  v_mfma_f32_32x32x16_bf16 v[48:63], v[14:17], a[20:23], v[48:63]
  ds_read_b128 v[10:13], v24 offset:5120
  v_cvt_pk_bf16_f32 v34, v36, v37
  v_cvt_pk_bf16_f32 v35, v38, v39
  s_waitcnt lgkmcnt(3)
  v_mfma_f32_32x32x16_bf16 v[48:63], v[112:115], a[24:27], v[48:63]
  ds_read_b128 v[14:17], v24 offset:9216
  buffer_store_dwordx4 v[32:35], v2, s[8:11], s40 offen sc1
  v_cvt_pk_bf16_f32 v36, v40, v41
  s_waitcnt lgkmcnt(3)
  v_mfma_f32_32x32x16_bf16 v[48:63], v[116:119], a[28:31], v[48:63]
  ds_read_b128 v[112:115], v24 offset:13312
  v_cvt_pk_bf16_f32 v37, v42, v43
  v_cvt_pk_bf16_f32 v38, v44, v45
  s_waitcnt lgkmcnt(3)
  v_mfma_f32_32x32x16_bf16 v[48:63], v[120:123], a[32:35], v[48:63]
  ds_read_b128 v[116:119], v24 offset:17408
  v_cvt_pk_bf16_f32 v39, v46, v47
  buffer_store_dwordx4 v[36:39], v2, s[8:11], s40 offen offset:1024 sc1
  s_waitcnt lgkmcnt(3)
  v_mfma_f32_32x32x16_bf16 v[48:63], v[10:13], a[36:39], v[48:63]
  ds_read_b128 v[120:123], v24 offset:21504
  s_waitcnt lgkmcnt(3)
  v_mfma_f32_32x32x16_bf16 v[48:63], v[14:17], a[40:43], v[48:63]
  ds_read_b128 v[10:13], v24 offset:25600
  s_waitcnt lgkmcnt(3)
  v_mfma_f32_32x32x16_bf16 v[48:63], v[112:115], a[44:47], v[48:63]
  ds_read_b128 v[14:17], v24 offset:29696
  s_waitcnt lgkmcnt(3)
  v_mfma_f32_32x32x16_bf16 v[48:63], v[116:119], a[48:51], v[48:63]
  ds_read_b128 v[112:115], v25 offset:1024
  s_waitcnt lgkmcnt(3)
  v_mfma_f32_32x32x16_bf16 v[48:63], v[120:123], a[52:55], v[48:63]
  ds_read_b128 v[116:119], v25 offset:5120
  s_waitcnt lgkmcnt(3)
  v_mfma_f32_32x32x16_bf16 v[48:63], v[10:13], a[56:59], v[48:63]
  ds_read_b128 v[120:123], v25 offset:9216
  s_waitcnt lgkmcnt(3)
  v_mfma_f32_32x32x16_bf16 v[48:63], v[14:17], a[60:63], v[48:63]
  ds_read_b128 v[10:13], v25 offset:13312
  s_waitcnt lgkmcnt(3)
  v_mfma_f32_32x32x16_bf16 v[48:63], v[112:115], a[96:99], v[48:63]
  ds_read_b128 v[14:17], v25 offset:17408
  s_waitcnt lgkmcnt(3)
  v_mfma_f32_32x32x16_bf16 v[48:63], v[116:119], a[100:103], v[48:63]
  ds_read_b128 v[112:115], v25 offset:21504
  s_waitcnt lgkmcnt(3)
  v_mfma_f32_32x32x16_bf16 v[48:63], v[120:123], a[104:107], v[48:63]
  ds_read_b128 v[116:119], v25 offset:25600
  s_waitcnt lgkmcnt(3)
  v_mfma_f32_32x32x16_bf16 v[48:63], v[10:13], a[108:111], v[48:63]
  ds_read_b128 v[120:123], v25 offset:29696
  s_waitcnt lgkmcnt(3)
  v_mfma_f32_32x32x16_bf16 v[48:63], v[14:17], a[112:115], v[48:63]
  ds_read_b128 v[10:13], v23 offset:2048
  s_waitcnt lgkmcnt(3)
  v_mfma_f32_32x32x16_bf16 v[48:63], v[112:115], a[116:119], v[48:63]
  ds_read_b128 v[14:17], v23 offset:6144
  s_waitcnt lgkmcnt(3)
  v_mfma_f32_32x32x16_bf16 v[48:63], v[116:119], a[120:123], v[48:63]
  ds_read_b128 v[112:115], v23 offset:10240
  s_waitcnt lgkmcnt(3)
  v_mfma_f32_32x32x16_bf16 v[48:63], v[120:123], a[124:127], v[48:63]
  ds_read_b128 v[116:119], v23 offset:14336
  s_waitcnt lgkmcnt(3)
  v_mfma_f32_32x32x16_bf16 v[64:79], v[10:13], a[0:3], v[64:79]
  ds_read_b128 v[120:123], v23 offset:18432
  s_waitcnt lgkmcnt(3)
  v_mfma_f32_32x32x16_bf16 v[64:79], v[14:17], a[4:7], v[64:79]
  ds_read_b128 v[10:13], v23 offset:22528
  s_waitcnt lgkmcnt(3)
  v_mfma_f32_32x32x16_bf16 v[64:79], v[112:115], a[8:11], v[64:79]
  ds_read_b128 v[14:17], v23 offset:26624
  s_waitcnt lgkmcnt(3)
  v_mfma_f32_32x32x16_bf16 v[64:79], v[116:119], a[12:15], v[64:79]
  ds_read_b128 v[112:115], v23 offset:30720
  s_waitcnt lgkmcnt(3)
  v_mfma_f32_32x32x16_bf16 v[64:79], v[120:123], a[16:19], v[64:79]
  ds_read_b128 v[116:119], v24 offset:2048
  v_cvt_pk_bf16_f32 v48, v48, v49
  v_cvt_pk_bf16_f32 v49, v50, v51
  s_waitcnt lgkmcnt(3)
  v_mfma_f32_32x32x16_bf16 v[64:79], v[10:13], a[20:23], v[64:79]
  ds_read_b128 v[120:123], v24 offset:6144
  v_cvt_pk_bf16_f32 v50, v52, v53
  v_cvt_pk_bf16_f32 v51, v54, v55
  s_waitcnt lgkmcnt(3)
  v_mfma_f32_32x32x16_bf16 v[64:79], v[14:17], a[24:27], v[64:79]
  ds_read_b128 v[10:13], v24 offset:10240
  buffer_store_dwordx4 v[48:51], v2, s[8:11], s40 offen offset:2048 sc1
  v_cvt_pk_bf16_f32 v52, v56, v57
  s_waitcnt lgkmcnt(3)
  v_mfma_f32_32x32x16_bf16 v[64:79], v[112:115], a[28:31], v[64:79]
  ds_read_b128 v[14:17], v24 offset:14336
  v_cvt_pk_bf16_f32 v53, v58, v59
  v_cvt_pk_bf16_f32 v54, v60, v61
  s_waitcnt lgkmcnt(3)
  v_mfma_f32_32x32x16_bf16 v[64:79], v[116:119], a[32:35], v[64:79]
  ds_read_b128 v[112:115], v24 offset:18432
  v_cvt_pk_bf16_f32 v55, v62, v63
  buffer_store_dwordx4 v[52:55], v2, s[8:11], s40 offen offset:3072 sc1
  s_waitcnt lgkmcnt(3)
  v_mfma_f32_32x32x16_bf16 v[64:79], v[120:123], a[36:39], v[64:79]
  ds_read_b128 v[116:119], v24 offset:22528
  s_waitcnt lgkmcnt(3)
  v_mfma_f32_32x32x16_bf16 v[64:79], v[10:13], a[40:43], v[64:79]
  ds_read_b128 v[120:123], v24 offset:26624
  s_waitcnt lgkmcnt(3)
  v_mfma_f32_32x32x16_bf16 v[64:79], v[14:17], a[44:47], v[64:79]
  ds_read_b128 v[10:13], v24 offset:30720
  s_waitcnt lgkmcnt(3)
  v_mfma_f32_32x32x16_bf16 v[64:79], v[112:115], a[48:51], v[64:79]
  ds_read_b128 v[14:17], v25 offset:2048
  s_waitcnt lgkmcnt(3)
  v_mfma_f32_32x32x16_bf16 v[64:79], v[116:119], a[52:55], v[64:79]
  ds_read_b128 v[112:115], v25 offset:6144
  s_waitcnt lgkmcnt(3)
  v_mfma_f32_32x32x16_bf16 v[64:79], v[120:123], a[56:59], v[64:79]
  ds_read_b128 v[116:119], v25 offset:10240
  s_waitcnt lgkmcnt(3)
  v_mfma_f32_32x32x16_bf16 v[64:79], v[10:13], a[60:63], v[64:79]
  ds_read_b128 v[120:123], v25 offset:14336
  s_waitcnt lgkmcnt(3)
  v_mfma_f32_32x32x16_bf16 v[64:79], v[14:17], a[96:99], v[64:79]
  ds_read_b128 v[10:13], v25 offset:18432
  s_waitcnt lgkmcnt(3)
  v_mfma_f32_32x32x16_bf16 v[64:79], v[112:115], a[100:103], v[64:79]
  ds_read_b128 v[14:17], v25 offset:22528
  s_waitcnt lgkmcnt(3)
  v_mfma_f32_32x32x16_bf16 v[64:79], v[116:119], a[104:107], v[64:79]
  ds_read_b128 v[112:115], v25 offset:26624
  s_waitcnt lgkmcnt(3)
  v_mfma_f32_32x32x16_bf16 v[64:79], v[120:123], a[108:111], v[64:79]
  ds_read_b128 v[116:119], v25 offset:30720
  s_waitcnt lgkmcnt(3)
  v_mfma_f32_32x32x16_bf16 v[64:79], v[10:13], a[112:115], v[64:79]
  ds_read_b128 v[120:123], v23 offset:3072
  s_waitcnt lgkmcnt(3)
  v_mfma_f32_32x32x16_bf16 v[64:79], v[14:17], a[116:119], v[64:79]
  ds_read_b128 v[10:13], v23 offset:7168
  s_waitcnt lgkmcnt(3)
  v_mfma_f32_32x32x16_bf16 v[64:79], v[112:115], a[120:123], v[64:79]
  ds_read_b128 v[14:17], v23 offset:11264
  s_waitcnt lgkmcnt(3)
  v_mfma_f32_32x32x16_bf16 v[64:79], v[116:119], a[124:127], v[64:79]
  ds_read_b128 v[112:115], v23 offset:15360
  s_waitcnt lgkmcnt(3)
  v_mfma_f32_32x32x16_bf16 v[80:95], v[120:123], a[0:3], v[80:95]
  ds_read_b128 v[116:119], v23 offset:19456
  s_waitcnt lgkmcnt(3)
  v_mfma_f32_32x32x16_bf16 v[80:95], v[10:13], a[4:7], v[80:95]
  ds_read_b128 v[120:123], v23 offset:23552
  s_waitcnt lgkmcnt(3)
  v_mfma_f32_32x32x16_bf16 v[80:95], v[14:17], a[8:11], v[80:95]
  ds_read_b128 v[10:13], v23 offset:27648
  s_waitcnt lgkmcnt(3)
  v_mfma_f32_32x32x16_bf16 v[80:95], v[112:115], a[12:15], v[80:95]
  ds_read_b128 v[14:17], v23 offset:31744
  s_waitcnt lgkmcnt(3)
  v_mfma_f32_32x32x16_bf16 v[80:95], v[116:119], a[16:19], v[80:95]
  ds_read_b128 v[112:115], v24 offset:3072
  v_cvt_pk_bf16_f32 v64, v64, v65
  v_cvt_pk_bf16_f32 v65, v66, v67
  s_waitcnt lgkmcnt(3)
  v_mfma_f32_32x32x16_bf16 v[80:95], v[120:123], a[20:23], v[80:95]
  ds_read_b128 v[116:119], v24 offset:7168
  v_cvt_pk_bf16_f32 v66, v68, v69
  v_cvt_pk_bf16_f32 v67, v70, v71
  s_waitcnt lgkmcnt(3)
  v_mfma_f32_32x32x16_bf16 v[80:95], v[10:13], a[24:27], v[80:95]
  ds_read_b128 v[120:123], v24 offset:11264
  buffer_store_dwordx4 v[64:67], v2, s[8:11], s41 offen sc1
  v_cvt_pk_bf16_f32 v68, v72, v73
  s_waitcnt lgkmcnt(3)
  v_mfma_f32_32x32x16_bf16 v[80:95], v[14:17], a[28:31], v[80:95]
  ds_read_b128 v[10:13], v24 offset:15360
  v_cvt_pk_bf16_f32 v69, v74, v75
  v_cvt_pk_bf16_f32 v70, v76, v77
  s_waitcnt lgkmcnt(3)
  v_mfma_f32_32x32x16_bf16 v[80:95], v[112:115], a[32:35], v[80:95]
  ds_read_b128 v[14:17], v24 offset:19456
  v_cvt_pk_bf16_f32 v71, v78, v79
  buffer_store_dwordx4 v[68:71], v2, s[8:11], s41 offen offset:1024 sc1
  s_waitcnt lgkmcnt(3)
  v_mfma_f32_32x32x16_bf16 v[80:95], v[116:119], a[36:39], v[80:95]
  ds_read_b128 v[112:115], v24 offset:23552
  s_waitcnt lgkmcnt(3)
  v_mfma_f32_32x32x16_bf16 v[80:95], v[120:123], a[40:43], v[80:95]
  ds_read_b128 v[116:119], v24 offset:27648
  s_waitcnt lgkmcnt(3)
  v_mfma_f32_32x32x16_bf16 v[80:95], v[10:13], a[44:47], v[80:95]
  ds_read_b128 v[120:123], v24 offset:31744
  s_waitcnt lgkmcnt(3)
  v_mfma_f32_32x32x16_bf16 v[80:95], v[14:17], a[48:51], v[80:95]
  ds_read_b128 v[10:13], v25 offset:3072
  s_waitcnt lgkmcnt(3)
  v_mfma_f32_32x32x16_bf16 v[80:95], v[112:115], a[52:55], v[80:95]
  ds_read_b128 v[14:17], v25 offset:7168
  s_waitcnt lgkmcnt(3)
  v_mfma_f32_32x32x16_bf16 v[80:95], v[116:119], a[56:59], v[80:95]
  ds_read_b128 v[112:115], v25 offset:11264
  s_waitcnt lgkmcnt(3)
  v_mfma_f32_32x32x16_bf16 v[80:95], v[120:123], a[60:63], v[80:95]
  ds_read_b128 v[116:119], v25 offset:15360
  s_waitcnt lgkmcnt(3)
  v_mfma_f32_32x32x16_bf16 v[80:95], v[10:13], a[96:99], v[80:95]
  ds_read_b128 v[120:123], v25 offset:19456
  s_waitcnt lgkmcnt(3)
  v_mfma_f32_32x32x16_bf16 v[80:95], v[14:17], a[100:103], v[80:95]
  ds_read_b128 v[10:13], v25 offset:23552
  s_waitcnt lgkmcnt(3)
  v_mfma_f32_32x32x16_bf16 v[80:95], v[112:115], a[104:107], v[80:95]
  ds_read_b128 v[14:17], v25 offset:27648
  s_waitcnt lgkmcnt(3)
  v_mfma_f32_32x32x16_bf16 v[80:95], v[116:119], a[108:111], v[80:95]
  ds_read_b128 v[112:115], v25 offset:31744
  s_waitcnt lgkmcnt(3)
  v_mfma_f32_32x32x16_bf16 v[80:95], v[120:123], a[112:115], v[80:95]
  ds_read_b128 v[116:119], v26 offset:4096
  s_waitcnt lgkmcnt(3)
  v_mfma_f32_32x32x16_bf16 v[80:95], v[10:13], a[116:119], v[80:95]
  ds_read_b128 v[120:123], v26 offset:4608
  s_waitcnt lgkmcnt(3)
  v_mfma_f32_32x32x16_bf16 v[80:95], v[14:17], a[120:123], v[80:95]
  ds_read_b128 v[10:13], v26 offset:5120
  s_waitcnt lgkmcnt(3)
  v_mfma_f32_32x32x16_bf16 v[80:95], v[112:115], a[124:127], v[80:95]
  ds_read_b128 v[14:17], v26 offset:5632
  s_waitcnt lgkmcnt(3)
  v_mfma_f32_32x32x16_bf16 v[96:111], v[116:119], a[0:3], v[96:111]
  ds_read_b128 v[112:115], v26 offset:6144
  s_waitcnt lgkmcnt(3)
  v_mfma_f32_32x32x16_bf16 v[96:111], v[120:123], a[4:7], v[96:111]
  ds_read_b128 v[116:119], v26 offset:6656
  s_waitcnt lgkmcnt(3)
  v_mfma_f32_32x32x16_bf16 v[96:111], v[10:13], a[8:11], v[96:111]
  ds_read_b128 v[120:123], v26 offset:7168
  s_waitcnt lgkmcnt(3)
  v_mfma_f32_32x32x16_bf16 v[96:111], v[14:17], a[12:15], v[96:111]
  ds_read_b128 v[10:13], v26 offset:7680
  s_waitcnt lgkmcnt(3)
  v_mfma_f32_32x32x16_bf16 v[96:111], v[112:115], a[16:19], v[96:111]
  ds_read_b128 v[14:17], v26 offset:8192
  v_cvt_pk_bf16_f32 v80, v80, v81
  v_cvt_pk_bf16_f32 v81, v82, v83
  s_waitcnt lgkmcnt(3)
  v_mfma_f32_32x32x16_bf16 v[96:111], v[116:119], a[20:23], v[96:111]
  ds_read_b128 v[112:115], v26 offset:8704
  v_cvt_pk_bf16_f32 v82, v84, v85
  v_cvt_pk_bf16_f32 v83, v86, v87
  s_waitcnt lgkmcnt(3)
  v_mfma_f32_32x32x16_bf16 v[96:111], v[120:123], a[24:27], v[96:111]
  ds_read_b128 v[116:119], v26 offset:9216
  buffer_store_dwordx4 v[80:83], v2, s[8:11], s41 offen offset:2048 sc1
  v_cvt_pk_bf16_f32 v84, v88, v89
  s_waitcnt lgkmcnt(3)
  v_mfma_f32_32x32x16_bf16 v[96:111], v[10:13], a[28:31], v[96:111]
  ds_read_b128 v[120:123], v26 offset:9728
  v_cvt_pk_bf16_f32 v85, v90, v91
  v_cvt_pk_bf16_f32 v86, v92, v93
  s_waitcnt lgkmcnt(3)
  v_mfma_f32_32x32x16_bf16 v[96:111], v[14:17], a[32:35], v[96:111]
  ds_read_b128 v[10:13], v26 offset:10240
  v_cvt_pk_bf16_f32 v87, v94, v95
  buffer_store_dwordx4 v[84:87], v2, s[8:11], s41 offen offset:3072 sc1
  s_waitcnt lgkmcnt(3)
  v_mfma_f32_32x32x16_bf16 v[96:111], v[112:115], a[36:39], v[96:111]
  ds_read_b128 v[14:17], v26 offset:10752
  s_waitcnt lgkmcnt(3)
  v_mfma_f32_32x32x16_bf16 v[96:111], v[116:119], a[40:43], v[96:111]
  ds_read_b128 v[112:115], v26 offset:11264
  s_waitcnt lgkmcnt(3)
  v_mfma_f32_32x32x16_bf16 v[96:111], v[120:123], a[44:47], v[96:111]
  ds_read_b128 v[116:119], v26 offset:11776
  s_waitcnt lgkmcnt(3)
  v_mfma_f32_32x32x16_bf16 v[96:111], v[10:13], a[48:51], v[96:111]
  ds_read_b128 v[120:123], v26 offset:12288
  s_cmp_lg_u32 s3, 7
  s_cbranch_scc1 ONLYW79
  v_mov_b32 v27, 1
  buffer_atomic_add v27, v28, s[8:11], 0 offen sc0 sc1
ONLYW79:
  s_waitcnt lgkmcnt(3)
  v_mfma_f32_32x32x16_bf16 v[96:111], v[14:17], a[52:55], v[96:111]
  ds_read_b128 v[10:13], v26 offset:12800
  s_waitcnt lgkmcnt(3)
  v_mfma_f32_32x32x16_bf16 v[96:111], v[112:115], a[56:59], v[96:111]
  ds_read_b128 v[14:17], v26 offset:13312
  s_waitcnt lgkmcnt(3)
  v_mfma_f32_32x32x16_bf16 v[96:111], v[116:119], a[60:63], v[96:111]
  ds_read_b128 v[112:115], v26 offset:13824
  s_waitcnt lgkmcnt(3)
  v_mfma_f32_32x32x16_bf16 v[96:111], v[120:123], a[96:99], v[96:111]
  ds_read_b128 v[116:119], v26 offset:14336
  s_waitcnt lgkmcnt(3)
  v_mfma_f32_32x32x16_bf16 v[96:111], v[10:13], a[100:103], v[96:111]
  ds_read_b128 v[120:123], v26 offset:14848
  s_waitcnt lgkmcnt(3)
  v_mfma_f32_32x32x16_bf16 v[96:111], v[14:17], a[104:107], v[96:111]
  ds_read_b128 v[10:13], v26 offset:15360
  s_waitcnt lgkmcnt(3)
  v_mfma_f32_32x32x16_bf16 v[96:111], v[112:115], a[108:111], v[96:111]
  ds_read_b128 v[14:17], v26 offset:15872
  s_waitcnt lgkmcnt(3)
  v_mfma_f32_32x32x16_bf16 v[96:111], v[116:119], a[112:115], v[96:111]
  s_waitcnt lgkmcnt(2)
  v_mfma_f32_32x32x16_bf16 v[96:111], v[120:123], a[116:119], v[96:111]
  s_waitcnt lgkmcnt(1)
  v_mfma_f32_32x32x16_bf16 v[96:111], v[10:13], a[120:123], v[96:111]
  s_waitcnt lgkmcnt(0)
  v_mfma_f32_32x32x16_bf16 v[96:111], v[14:17], a[124:127], v[96:111]
  s_nop 11
  v_cvt_pk_bf16_f32 v96, v96, v97
  v_cvt_pk_bf16_f32 v97, v98, v99
  v_cvt_pk_bf16_f32 v98, v100, v101
  v_cvt_pk_bf16_f32 v99, v102, v103
  buffer_store_dwordx4 v[96:99], v2, s[8:11], s42 offen sc1
  v_and_b32 v5, 7, v1
  v_lshrrev_b32 v6, 5, v1
  v_lshlrev_b32 v6, 7, v6
  v_lshl_add_u32 v22, v5, 4, v6
  v_mov_b32 v7, 0x7fffff00
  s_cmp_lt_u32 s3, 4
  s_cselect_b64 s[4:5], -1, 0
  v_cndmask_b32 v23, v7, v2, s[4:5]
  v_cndmask_b32 v24, v7, v22, s[4:5]
  v_and_b32 v5, 31, v1
  v_mul_u32_u24 v5, 0x130, v5
  v_lshrrev_b32 v6, 5, v1
  v_lshl_add_u32 v5, v6, 4, v5
  s_mul_i32 s6, s3, 0x4c00
  v_add_u32 v25, s6, v5
  v_mul_u32_u24 v6, 0xaaab, v0
  v_lshrrev_b32 v6, 18, v6
  v_mul_u32_u24 v7, 6, v6
  v_sub_u32 v7, v0, v7
  v_mul_u32_u24 v5, 0x130, v6
  v_mul_u32_u24 v8, 48, v7
  v_add_u32 v30, v5, v8
  v_add_u32 v31, 0xe400, v30
  v_add_u32 v123, 0x1c800, v30
  v_mul_u32_u24 v6, 0x900, v6
  v_mul_u32_u24 v8, 24, v7
  v_add_u32 v26, v6, v8
  v_bfe_u32 v5, v1, 2, 2
  v_lshlrev_b32 v5, 8, v5
  v_and_b32 v6, 3, v1
  v_lshl_add_u32 v5, v6, 2, v5
  v_add_u32 v20, 0x7c06020, v5
  s_mov_b32 s12, s84
  s_mov_b32 s13, s85
  s_mov_b32 s14, 0x480000
  s_mov_b32 s15, 0x20000
  s_waitcnt vmcnt(0)
  buffer_store_dword v4, v19, s[8:11], s37 offen offset:96 sc1
  v_mov_b32 v29, 0x27100
B_TOP:
  s_cmp_lg_u32 s3, 7
  s_cbranch_scc1 ONLYW80
  s_waitcnt vmcnt(0)
  v_readfirstlane_b32 s6, v27
  s_nop 1
  v_mov_b32 v27, s6
  ds_write_b32 v29, v27
ONLYW80:
  s_waitcnt lgkmcnt(0)
  s_barrier
  ds_read_b32 v5, v29
  s_waitcnt lgkmcnt(0)
  v_readfirstlane_b32 s6, v5
  s_nop 0
  s_cmp_ge_u32 s6, 0x100
  s_cbranch_scc1 B_END
  s_lshr_b32 s32, s6, 3
  s_and_b32 s33, s6, 7
  s_lshl_b32 s90, s32, 10
  s_mov_b32 s38, 0
PL81:
  buffer_load_dword v21, v20, s[8:11], s90 offen sc1
  s_waitcnt vmcnt(0)
  v_cmp_ne_u32 vcc, 1, v21
  s_add_u32 s38, s38, 1
  s_cbranch_vccz PD82
  s_sleep 1
  s_cmp_lt_u32 s38, 0x30d40
  s_cbranch_scc1 PL81
PD82:
  s_mul_i32 s53, s32, 0x48
  s_add_u32 s53, s53, s3
  s_lshl_b32 s53, s53, 10
  s_add_u32 s53, s53, 0x7000000
  s_add_u32 s54, s53, 0x9000
  s_mul_i32 s55, s33, 0xa4400
  s_mul_i32 s6, s3, 0x900
  s_add_u32 s55, s55, s6
  s_add_u32 s55, s55, 0x7490000
  buffer_load_dwordx4 a[64:67], v2, s[8:11], s53 offen sc1
  buffer_load_dwordx4 a[68:71], v2, s[8:11], s54 offen sc1
  s_add_u32 s53, s53, 0x2000
  s_add_u32 s54, s54, 0x2000
  buffer_load_dwordx4 a[72:75], v2, s[8:11], s55 offen sc1
  buffer_load_dwordx4 a[76:79], v2, s[8:11], s55 offen offset:1024 sc1
  buffer_load_dwordx4 a[80:83], v22, s[8:11], s55 offen offset:2048 sc1
  s_add_u32 s55, s55, 0x4800
  buffer_load_dwordx4 a[84:87], v2, s[8:11], s53 offen sc1
  buffer_load_dwordx4 a[88:91], v2, s[8:11], s54 offen sc1
  s_add_u32 s53, s53, 0x2000
  s_add_u32 s54, s54, 0x2000
  buffer_load_dwordx4 a[92:95], v2, s[8:11], s55 offen sc1
  buffer_load_dwordx4 a[96:99], v2, s[8:11], s55 offen offset:1024 sc1
  buffer_load_dwordx4 a[100:103], v22, s[8:11], s55 offen offset:2048 sc1
  s_add_u32 s55, s55, 0x4800
  buffer_load_dwordx4 a[104:107], v2, s[8:11], s53 offen sc1
  buffer_load_dwordx4 a[108:111], v2, s[8:11], s54 offen sc1
  s_add_u32 s53, s53, 0x2000
  s_add_u32 s54, s54, 0x2000
  buffer_load_dwordx4 a[112:115], v2, s[8:11], s55 offen sc1
  buffer_load_dwordx4 a[116:119], v2, s[8:11], s55 offen offset:1024 sc1
  buffer_load_dwordx4 a[120:123], v22, s[8:11], s55 offen offset:2048 sc1
  s_add_u32 s55, s55, 0x4800
  buffer_load_dwordx4 a[124:127], v2, s[8:11], s53 offen sc1
  buffer_load_dwordx4 v[64:67], v2, s[8:11], s54 offen sc1
  s_add_u32 s53, s53, 0x2000
  s_add_u32 s54, s54, 0x2000
  buffer_load_dwordx4 v[68:71], v2, s[8:11], s55 offen sc1
  buffer_load_dwordx4 v[72:75], v2, s[8:11], s55 offen offset:1024 sc1
  buffer_load_dwordx4 v[76:79], v22, s[8:11], s55 offen offset:2048 sc1
  s_add_u32 s55, s55, 0x4800
  buffer_load_dwordx4 v[96:99], v23, s[8:11], s53 offen sc1
  buffer_load_dwordx4 v[100:103], v23, s[8:11], s54 offen sc1
  s_add_u32 s53, s53, 0x2000
  s_add_u32 s54, s54, 0x2000
  buffer_load_dwordx4 v[104:107], v23, s[8:11], s55 offen sc1
  buffer_load_dwordx4 v[108:111], v23, s[8:11], s55 offen offset:1024 sc1
  buffer_load_dwordx4 v[112:115], v24, s[8:11], s55 offen offset:2048 sc1
  s_add_u32 s55, s55, 0x4800
  s_waitcnt vmcnt(22)
  v_mfma_f32_32x32x16_bf16 a[0:15], a[72:75], a[64:67], 0
  v_mfma_f32_32x32x16_bf16 a[48:63], a[72:75], a[68:71], 0
  s_waitcnt vmcnt(21)
  v_mfma_f32_32x32x16_bf16 a[16:31], a[76:79], a[64:67], 0
  v_mfma_f32_32x32x16_bf16 v[32:47], a[76:79], a[68:71], 0
  s_waitcnt vmcnt(20)
  v_mfma_f32_32x32x16_bf16 a[32:47], a[80:83], a[64:67], 0
  v_mfma_f32_32x32x16_bf16 v[48:63], a[80:83], a[68:71], 0
  s_waitcnt vmcnt(17)
  v_mfma_f32_32x32x16_bf16 a[0:15], a[92:95], a[84:87], a[0:15]
  v_mfma_f32_32x32x16_bf16 a[48:63], a[92:95], a[88:91], a[48:63]
  s_waitcnt vmcnt(16)
  v_mfma_f32_32x32x16_bf16 a[16:31], a[96:99], a[84:87], a[16:31]
  v_mfma_f32_32x32x16_bf16 v[32:47], a[96:99], a[88:91], v[32:47]
  s_waitcnt vmcnt(15)
  v_mfma_f32_32x32x16_bf16 a[32:47], a[100:103], a[84:87], a[32:47]
  v_mfma_f32_32x32x16_bf16 v[48:63], a[100:103], a[88:91], v[48:63]
  s_waitcnt vmcnt(12)
  v_mfma_f32_32x32x16_bf16 a[0:15], a[112:115], a[104:107], a[0:15]
  v_mfma_f32_32x32x16_bf16 a[48:63], a[112:115], a[108:111], a[48:63]
  s_waitcnt vmcnt(11)
  v_mfma_f32_32x32x16_bf16 a[16:31], a[116:119], a[104:107], a[16:31]
  v_mfma_f32_32x32x16_bf16 v[32:47], a[116:119], a[108:111], v[32:47]
  s_waitcnt vmcnt(10)
  v_mfma_f32_32x32x16_bf16 a[32:47], a[120:123], a[104:107], a[32:47]
  v_mfma_f32_32x32x16_bf16 v[48:63], a[120:123], a[108:111], v[48:63]
  s_waitcnt vmcnt(7)
  v_mfma_f32_32x32x16_bf16 a[0:15], v[68:71], a[124:127], a[0:15]
  v_mfma_f32_32x32x16_bf16 a[48:63], v[68:71], v[64:67], a[48:63]
  s_waitcnt vmcnt(6)
  v_mfma_f32_32x32x16_bf16 a[16:31], v[72:75], a[124:127], a[16:31]
  v_mfma_f32_32x32x16_bf16 v[32:47], v[72:75], v[64:67], v[32:47]
  s_waitcnt vmcnt(5)
  v_mfma_f32_32x32x16_bf16 a[32:47], v[76:79], a[124:127], a[32:47]
  v_mfma_f32_32x32x16_bf16 v[48:63], v[76:79], v[64:67], v[48:63]
  s_waitcnt vmcnt(2)
  v_mfma_f32_32x32x16_bf16 a[0:15], v[104:107], v[96:99], a[0:15]
  v_mfma_f32_32x32x16_bf16 a[48:63], v[104:107], v[100:103], a[48:63]
  s_waitcnt vmcnt(1)
  v_mfma_f32_32x32x16_bf16 a[16:31], v[108:111], v[96:99], a[16:31]
  v_mfma_f32_32x32x16_bf16 v[32:47], v[108:111], v[100:103], v[32:47]
  s_waitcnt vmcnt(0)
  v_mfma_f32_32x32x16_bf16 a[32:47], v[112:115], v[96:99], a[32:47]
  v_mfma_f32_32x32x16_bf16 v[48:63], v[112:115], v[100:103], v[48:63]
  s_cmp_lg_u32 s3, 7
  s_cbranch_scc1 ONLYW83
  v_mov_b32 v27, 1
  buffer_atomic_add v27, v28, s[8:11], 0 offen sc0 sc1
ONLYW83:
  s_nop 2
  ds_write_b128 v25, a[0:3] offset:0
  ds_write_b128 v25, a[4:7] offset:32
  ds_write_b128 v25, a[8:11] offset:64
  ds_write_b128 v25, a[12:15] offset:96
  ds_write_b128 v25, a[16:19] offset:128
  ds_write_b128 v25, a[20:23] offset:160
  ds_write_b128 v25, a[24:27] offset:192
  ds_write_b128 v25, a[28:31] offset:224
  ds_write_b128 v25, a[32:35] offset:256
  ds_write_b128 v25, a[48:51] offset:9728
  ds_write_b128 v25, a[52:55] offset:9760
  ds_write_b128 v25, a[56:59] offset:9792
  ds_write_b128 v25, a[60:63] offset:9824
  ds_write_b128 v25, v[32:35] offset:9856
  ds_write_b128 v25, v[36:39] offset:9888
  ds_write_b128 v25, v[40:43] offset:9920
  ds_write_b128 v25, v[44:47] offset:9952
  ds_write_b128 v25, v[48:51] offset:9984
  s_waitcnt lgkmcnt(0)
  s_barrier
  s_cmp_ge_u32 s3, 6
  s_cbranch_scc1 O_SK84
  ds_read_b128 v[32:35], v30
  ds_read_b128 v[36:39], v30 offset:16
  ds_read_b128 v[40:43], v30 offset:32
  ds_read_b128 v[44:47], v30 offset:19456
  ds_read_b128 v[48:51], v30 offset:19472
  ds_read_b128 v[52:55], v30 offset:19488
  ds_read_b128 v[56:59], v30 offset:38912
  ds_read_b128 v[60:63], v30 offset:38928
  ds_read_b128 v[64:67], v30 offset:38944
  ds_read_b128 v[68:71], v31
  ds_read_b128 v[72:75], v31 offset:16
  ds_read_b128 v[76:79], v31 offset:32
  ds_read_b128 v[80:83], v31 offset:19456
  ds_read_b128 v[84:87], v31 offset:19472
  ds_read_b128 v[88:91], v31 offset:19488
  ds_read_b128 v[92:95], v31 offset:38912
  ds_read_b128 v[96:99], v31 offset:38928
  ds_read_b128 v[100:103], v31 offset:38944
  ds_read_b128 v[104:107], v123
  ds_read_b128 v[108:111], v123 offset:16
  ds_read_b128 v[112:115], v123 offset:32
  ds_read_b128 v[116:119], v123 offset:19456
  ds_read_b128 v[10:13], v123 offset:19472
  ds_read_b128 v[14:17], v123 offset:19488
  s_waitcnt lgkmcnt(15)
  v_add_f32 v32, v32, v44
  v_add_f32 v33, v33, v45
  v_add_f32 v34, v34, v46
  v_add_f32 v35, v35, v47
  v_add_f32 v36, v36, v48
  v_add_f32 v37, v37, v49
  v_add_f32 v38, v38, v50
  v_add_f32 v39, v39, v51
  v_add_f32 v40, v40, v52
  v_add_f32 v41, v41, v53
  v_add_f32 v42, v42, v54
  v_add_f32 v43, v43, v55
  s_waitcnt lgkmcnt(14)
  v_add_f32 v56, v56, v68
  v_add_f32 v57, v57, v69
  v_add_f32 v58, v58, v70
  v_add_f32 v59, v59, v71
  s_waitcnt lgkmcnt(13)
  v_add_f32 v60, v60, v72
  v_add_f32 v61, v61, v73
  v_add_f32 v62, v62, v74
  v_add_f32 v63, v63, v75
  s_waitcnt lgkmcnt(12)
  v_add_f32 v64, v64, v76
  v_add_f32 v65, v65, v77
  v_add_f32 v66, v66, v78
  v_add_f32 v67, v67, v79
  s_waitcnt lgkmcnt(8)
  v_add_f32 v80, v80, v92
  v_add_f32 v81, v81, v93
  v_add_f32 v82, v82, v94
  v_add_f32 v83, v83, v95
  s_waitcnt lgkmcnt(7)
  v_add_f32 v84, v84, v96
  v_add_f32 v85, v85, v97
  v_add_f32 v86, v86, v98
  v_add_f32 v87, v87, v99
  s_waitcnt lgkmcnt(6)
  v_add_f32 v88, v88, v100
  v_add_f32 v89, v89, v101
  v_add_f32 v90, v90, v102
  v_add_f32 v91, v91, v103
  s_waitcnt lgkmcnt(2)
  v_add_f32 v104, v104, v116
  v_add_f32 v105, v105, v117
  v_add_f32 v106, v106, v118
  v_add_f32 v107, v107, v119
  s_waitcnt lgkmcnt(1)
  v_add_f32 v108, v108, v10
  v_add_f32 v109, v109, v11
  v_add_f32 v110, v110, v12
  v_add_f32 v111, v111, v13
  s_waitcnt lgkmcnt(0)
  v_add_f32 v112, v112, v14
  v_add_f32 v113, v113, v15
  v_add_f32 v114, v114, v16
  v_add_f32 v115, v115, v17
  v_add_f32 v32, v32, v56
  v_add_f32 v33, v33, v57
  v_add_f32 v34, v34, v58
  v_add_f32 v35, v35, v59
  v_add_f32 v36, v36, v60
  v_add_f32 v37, v37, v61
  v_add_f32 v38, v38, v62
  v_add_f32 v39, v39, v63
  v_add_f32 v40, v40, v64
  v_add_f32 v41, v41, v65
  v_add_f32 v42, v42, v66
  v_add_f32 v43, v43, v67
  v_add_f32 v80, v80, v104
  v_add_f32 v81, v81, v105
  v_add_f32 v82, v82, v106
  v_add_f32 v83, v83, v107
  v_add_f32 v84, v84, v108
  v_add_f32 v85, v85, v109
  v_add_f32 v86, v86, v110
  v_add_f32 v87, v87, v111
  v_add_f32 v88, v88, v112
  v_add_f32 v89, v89, v113
  v_add_f32 v90, v90, v114
  v_add_f32 v91, v91, v115
  v_add_f32 v32, v32, v80
  v_add_f32 v33, v33, v81
  v_add_f32 v34, v34, v82
  v_add_f32 v35, v35, v83
  v_add_f32 v36, v36, v84
  v_add_f32 v37, v37, v85
  v_add_f32 v38, v38, v86
  v_add_f32 v39, v39, v87
  v_add_f32 v40, v40, v88
  v_add_f32 v41, v41, v89
  v_add_f32 v42, v42, v90
  v_add_f32 v43, v43, v91
  v_cvt_pk_bf16_f32 v44, v32, v33
  v_cvt_pk_bf16_f32 v45, v34, v35
  v_cvt_pk_bf16_f32 v46, v36, v37
  v_cvt_pk_bf16_f32 v47, v38, v39
  v_cvt_pk_bf16_f32 v48, v40, v41
  v_cvt_pk_bf16_f32 v49, v42, v43
  s_mul_i32 s6, s32, 0x24000
  s_mul_i32 s7, s33, 0x90
  s_add_u32 s6, s6, s7
  s_add_u32 s6, s6, 0x480
  buffer_store_dwordx4 v[44:47], v26, s[12:15], s6 offen
  buffer_store_dwordx2 v[48:49], v26, s[12:15], s6 offen offset:16
O_SK84:
  s_nop 7
  s_branch B_TOP
B_END:
  s_and_b32 s6, s2, 0xf8
  s_lshl_b32 s6, s6, 8
  s_lshl_b32 s7, s46, 2
  s_add_u32 s6, s6, s7
  s_add_u32 s6, s6, 0x7c00060
  v_and_b32 v5, 7, v1
  v_lshlrev_b32 v5, 8, v5
  v_add_u32 v5, s6, v5
  s_mov_b32 s38, 0
PL85:
  buffer_load_dword v21, v5, s[8:11], 0 offen sc1
  s_waitcnt vmcnt(0)
  v_cmp_ne_u32 vcc, 1, v21
  s_add_u32 s38, s38, 1
  s_cbranch_vccz PD86
  s_sleep 1
  s_cmp_lt_u32 s38, 0x30d40
  s_cbranch_scc1 PL85
PD86:
  s_sub_u32 s6, 15, s35
  s_cmp_lt_u32 s46, 4
  s_cselect_b32 s6, s35, s6
  s_lshl_b32 s6, s6, 7
  s_and_b32 s7, s46, 3
  s_lshl_b32 s7, s7, 5
  s_add_u32 s6, s6, s7
  v_and_b32 v5, 31, v1
  v_add_u32 v5, s6, v5
  v_mul_u32_u24 v5, 0x900, v5
  v_lshrrev_b32 v6, 5, v1
  v_lshl_add_u32 v5, v6, 4, v5
  s_mul_i32 s6, s47, 0x120
  v_add_u32 v5, s6, v5
  s_add_u32 s6, s49, s46
  s_mul_i32 s6, s6, 0x12000
  s_add_u32 s50, s6, 0x3800000
  s_lshl_b32 s6, s3, 10
  s_add_u32 s6, s6, s50
  buffer_load_dwordx4 v[32:35], v2, s[8:11], s6 offen sc1
  s_add_u32 s6, s6, 0x2400
  buffer_load_dwordx4 v[36:39], v2, s[8:11], s6 offen sc1
  s_add_u32 s6, s6, 0x2400
  buffer_load_dwordx4 v[40:43], v2, s[8:11], s6 offen sc1
  s_add_u32 s6, s6, 0x2400
  buffer_load_dwordx4 v[44:47], v2, s[8:11], s6 offen sc1
  s_add_u32 s6, s6, 0x2400
  buffer_load_dwordx4 v[48:51], v2, s[8:11], s6 offen sc1
  s_add_u32 s6, s6, 0x2400
  buffer_load_dwordx4 v[52:55], v2, s[8:11], s6 offen sc1
  s_add_u32 s6, s6, 0x2400
  buffer_load_dwordx4 v[56:59], v2, s[8:11], s6 offen sc1
  s_add_u32 s6, s6, 0x2400
  buffer_load_dwordx4 v[60:63], v2, s[8:11], s6 offen sc1
  s_add_u32 s6, s6, 0x2400
  s_waitcnt vmcnt(7)
  v_lshlrev_b32 v64, 16, v32
  v_and_b32 v65, 0xffff0000, v32
  v_lshlrev_b32 v66, 16, v33
  v_and_b32 v67, 0xffff0000, v33
  v_lshlrev_b32 v68, 16, v34
  v_and_b32 v69, 0xffff0000, v34
  v_lshlrev_b32 v70, 16, v35
  v_and_b32 v71, 0xffff0000, v35
  s_waitcnt vmcnt(6)
  v_lshlrev_b32 v7, 16, v36
  v_and_b32 v8, 0xffff0000, v36
  v_add_f32 v64, v64, v7
  v_add_f32 v65, v65, v8
  v_lshlrev_b32 v7, 16, v37
  v_and_b32 v8, 0xffff0000, v37
  v_add_f32 v66, v66, v7
  v_add_f32 v67, v67, v8
  v_lshlrev_b32 v7, 16, v38
  v_and_b32 v8, 0xffff0000, v38
  v_add_f32 v68, v68, v7
  v_add_f32 v69, v69, v8
  v_lshlrev_b32 v7, 16, v39
  v_and_b32 v8, 0xffff0000, v39
  v_add_f32 v70, v70, v7
  v_add_f32 v71, v71, v8
  s_waitcnt vmcnt(5)
  v_lshlrev_b32 v7, 16, v40
  v_and_b32 v8, 0xffff0000, v40
  v_add_f32 v64, v64, v7
  v_add_f32 v65, v65, v8
  v_lshlrev_b32 v7, 16, v41
  v_and_b32 v8, 0xffff0000, v41
  v_add_f32 v66, v66, v7
  v_add_f32 v67, v67, v8
  v_lshlrev_b32 v7, 16, v42
  v_and_b32 v8, 0xffff0000, v42
  v_add_f32 v68, v68, v7
  v_add_f32 v69, v69, v8
  v_lshlrev_b32 v7, 16, v43
  v_and_b32 v8, 0xffff0000, v43
  v_add_f32 v70, v70, v7
  v_add_f32 v71, v71, v8
  s_waitcnt vmcnt(4)
  v_lshlrev_b32 v7, 16, v44
  v_and_b32 v8, 0xffff0000, v44
  v_add_f32 v64, v64, v7
  v_add_f32 v65, v65, v8
  v_lshlrev_b32 v7, 16, v45
  v_and_b32 v8, 0xffff0000, v45
  v_add_f32 v66, v66, v7
  v_add_f32 v67, v67, v8
  v_lshlrev_b32 v7, 16, v46
  v_and_b32 v8, 0xffff0000, v46
  v_add_f32 v68, v68, v7
  v_add_f32 v69, v69, v8
  v_lshlrev_b32 v7, 16, v47
  v_and_b32 v8, 0xffff0000, v47
  v_add_f32 v70, v70, v7
  v_add_f32 v71, v71, v8
  s_waitcnt vmcnt(3)
  v_lshlrev_b32 v7, 16, v48
  v_and_b32 v8, 0xffff0000, v48
  v_add_f32 v64, v64, v7
  v_add_f32 v65, v65, v8
  v_lshlrev_b32 v7, 16, v49
  v_and_b32 v8, 0xffff0000, v49
  v_add_f32 v66, v66, v7
  v_add_f32 v67, v67, v8
  v_lshlrev_b32 v7, 16, v50
  v_and_b32 v8, 0xffff0000, v50
  v_add_f32 v68, v68, v7
  v_add_f32 v69, v69, v8
  v_lshlrev_b32 v7, 16, v51
  v_and_b32 v8, 0xffff0000, v51
  v_add_f32 v70, v70, v7
  v_add_f32 v71, v71, v8
  s_waitcnt vmcnt(2)
  v_lshlrev_b32 v7, 16, v52
  v_and_b32 v8, 0xffff0000, v52
  v_add_f32 v64, v64, v7
  v_add_f32 v65, v65, v8
  v_lshlrev_b32 v7, 16, v53
  v_and_b32 v8, 0xffff0000, v53
  v_add_f32 v66, v66, v7
  v_add_f32 v67, v67, v8
  v_lshlrev_b32 v7, 16, v54
  v_and_b32 v8, 0xffff0000, v54
  v_add_f32 v68, v68, v7
  v_add_f32 v69, v69, v8
  v_lshlrev_b32 v7, 16, v55
  v_and_b32 v8, 0xffff0000, v55
  v_add_f32 v70, v70, v7
  v_add_f32 v71, v71, v8
  s_waitcnt vmcnt(1)
  v_lshlrev_b32 v7, 16, v56
  v_and_b32 v8, 0xffff0000, v56
  v_add_f32 v64, v64, v7
  v_add_f32 v65, v65, v8
  v_lshlrev_b32 v7, 16, v57
  v_and_b32 v8, 0xffff0000, v57
  v_add_f32 v66, v66, v7
  v_add_f32 v67, v67, v8
  v_lshlrev_b32 v7, 16, v58
  v_and_b32 v8, 0xffff0000, v58
  v_add_f32 v68, v68, v7
  v_add_f32 v69, v69, v8
  v_lshlrev_b32 v7, 16, v59
  v_and_b32 v8, 0xffff0000, v59
  v_add_f32 v70, v70, v7
  v_add_f32 v71, v71, v8
  s_waitcnt vmcnt(0)
  v_lshlrev_b32 v7, 16, v60
  v_and_b32 v8, 0xffff0000, v60
  v_add_f32 v64, v64, v7
  v_add_f32 v65, v65, v8
  v_lshlrev_b32 v7, 16, v61
  v_and_b32 v8, 0xffff0000, v61
  v_add_f32 v66, v66, v7
  v_add_f32 v67, v67, v8
  v_lshlrev_b32 v7, 16, v62
  v_and_b32 v8, 0xffff0000, v62
  v_add_f32 v68, v68, v7
  v_add_f32 v69, v69, v8
  v_lshlrev_b32 v7, 16, v63
  v_and_b32 v8, 0xffff0000, v63
  v_add_f32 v70, v70, v7
  v_add_f32 v71, v71, v8
  v_cvt_pk_bf16_f32 v72, v64, v65
  v_cvt_pk_bf16_f32 v73, v66, v67
  v_cvt_pk_bf16_f32 v74, v68, v69
  v_cvt_pk_bf16_f32 v75, v70, v71
  s_nop 0
  v_permlane32_swap_b32 v72, v74
  v_permlane32_swap_b32 v73, v75
  s_lshl_b32 s6, s3, 5
  buffer_store_dwordx4 v[72:75], v5, s[12:15], s6 offen
  s_mov_b32 s51, 8
  s_cmp_lg_u32 s3, 7
  s_cbranch_scc1 ONLYW87
  s_lshl_b32 s6, s51, 10
  s_add_u32 s6, s6, s50
  buffer_load_dwordx4 v[32:35], v2, s[8:11], s6 offen sc1
  s_add_u32 s6, s6, 0x2400
  buffer_load_dwordx4 v[36:39], v2, s[8:11], s6 offen sc1
  s_add_u32 s6, s6, 0x2400
  buffer_load_dwordx4 v[40:43], v2, s[8:11], s6 offen sc1
  s_add_u32 s6, s6, 0x2400
  buffer_load_dwordx4 v[44:47], v2, s[8:11], s6 offen sc1
  s_add_u32 s6, s6, 0x2400
  buffer_load_dwordx4 v[48:51], v2, s[8:11], s6 offen sc1
  s_add_u32 s6, s6, 0x2400
  buffer_load_dwordx4 v[52:55], v2, s[8:11], s6 offen sc1
  s_add_u32 s6, s6, 0x2400
  buffer_load_dwordx4 v[56:59], v2, s[8:11], s6 offen sc1
  s_add_u32 s6, s6, 0x2400
  buffer_load_dwordx4 v[60:63], v2, s[8:11], s6 offen sc1
  s_add_u32 s6, s6, 0x2400
  s_waitcnt vmcnt(7)
  v_lshlrev_b32 v64, 16, v32
  v_and_b32 v65, 0xffff0000, v32
  v_lshlrev_b32 v66, 16, v33
  v_and_b32 v67, 0xffff0000, v33
  v_lshlrev_b32 v68, 16, v34
  v_and_b32 v69, 0xffff0000, v34
  v_lshlrev_b32 v70, 16, v35
  v_and_b32 v71, 0xffff0000, v35
  s_waitcnt vmcnt(6)
  v_lshlrev_b32 v7, 16, v36
  v_and_b32 v8, 0xffff0000, v36
  v_add_f32 v64, v64, v7
  v_add_f32 v65, v65, v8
  v_lshlrev_b32 v7, 16, v37
  v_and_b32 v8, 0xffff0000, v37
  v_add_f32 v66, v66, v7
  v_add_f32 v67, v67, v8
  v_lshlrev_b32 v7, 16, v38
  v_and_b32 v8, 0xffff0000, v38
  v_add_f32 v68, v68, v7
  v_add_f32 v69, v69, v8
  v_lshlrev_b32 v7, 16, v39
  v_and_b32 v8, 0xffff0000, v39
  v_add_f32 v70, v70, v7
  v_add_f32 v71, v71, v8
  s_waitcnt vmcnt(5)
  v_lshlrev_b32 v7, 16, v40
  v_and_b32 v8, 0xffff0000, v40
  v_add_f32 v64, v64, v7
  v_add_f32 v65, v65, v8
  v_lshlrev_b32 v7, 16, v41
  v_and_b32 v8, 0xffff0000, v41
  v_add_f32 v66, v66, v7
  v_add_f32 v67, v67, v8
  v_lshlrev_b32 v7, 16, v42
  v_and_b32 v8, 0xffff0000, v42
  v_add_f32 v68, v68, v7
  v_add_f32 v69, v69, v8
  v_lshlrev_b32 v7, 16, v43
  v_and_b32 v8, 0xffff0000, v43
  v_add_f32 v70, v70, v7
  v_add_f32 v71, v71, v8
  s_waitcnt vmcnt(4)
  v_lshlrev_b32 v7, 16, v44
  v_and_b32 v8, 0xffff0000, v44
  v_add_f32 v64, v64, v7
  v_add_f32 v65, v65, v8
  v_lshlrev_b32 v7, 16, v45
  v_and_b32 v8, 0xffff0000, v45
  v_add_f32 v66, v66, v7
  v_add_f32 v67, v67, v8
  v_lshlrev_b32 v7, 16, v46
  v_and_b32 v8, 0xffff0000, v46
  v_add_f32 v68, v68, v7
  v_add_f32 v69, v69, v8
  v_lshlrev_b32 v7, 16, v47
  v_and_b32 v8, 0xffff0000, v47
  v_add_f32 v70, v70, v7
  v_add_f32 v71, v71, v8
  s_waitcnt vmcnt(3)
  v_lshlrev_b32 v7, 16, v48
  v_and_b32 v8, 0xffff0000, v48
  v_add_f32 v64, v64, v7
  v_add_f32 v65, v65, v8
  v_lshlrev_b32 v7, 16, v49
  v_and_b32 v8, 0xffff0000, v49
  v_add_f32 v66, v66, v7
  v_add_f32 v67, v67, v8
  v_lshlrev_b32 v7, 16, v50
  v_and_b32 v8, 0xffff0000, v50
  v_add_f32 v68, v68, v7
  v_add_f32 v69, v69, v8
  v_lshlrev_b32 v7, 16, v51
  v_and_b32 v8, 0xffff0000, v51
  v_add_f32 v70, v70, v7
  v_add_f32 v71, v71, v8
  s_waitcnt vmcnt(2)
  v_lshlrev_b32 v7, 16, v52
  v_and_b32 v8, 0xffff0000, v52
  v_add_f32 v64, v64, v7
  v_add_f32 v65, v65, v8
  v_lshlrev_b32 v7, 16, v53
  v_and_b32 v8, 0xffff0000, v53
  v_add_f32 v66, v66, v7
  v_add_f32 v67, v67, v8
  v_lshlrev_b32 v7, 16, v54
  v_and_b32 v8, 0xffff0000, v54
  v_add_f32 v68, v68, v7
  v_add_f32 v69, v69, v8
  v_lshlrev_b32 v7, 16, v55
  v_and_b32 v8, 0xffff0000, v55
  v_add_f32 v70, v70, v7
  v_add_f32 v71, v71, v8
  s_waitcnt vmcnt(1)
  v_lshlrev_b32 v7, 16, v56
  v_and_b32 v8, 0xffff0000, v56
  v_add_f32 v64, v64, v7
  v_add_f32 v65, v65, v8
  v_lshlrev_b32 v7, 16, v57
  v_and_b32 v8, 0xffff0000, v57
  v_add_f32 v66, v66, v7
  v_add_f32 v67, v67, v8
  v_lshlrev_b32 v7, 16, v58
  v_and_b32 v8, 0xffff0000, v58
  v_add_f32 v68, v68, v7
  v_add_f32 v69, v69, v8
  v_lshlrev_b32 v7, 16, v59
  v_and_b32 v8, 0xffff0000, v59
  v_add_f32 v70, v70, v7
  v_add_f32 v71, v71, v8
  s_waitcnt vmcnt(0)
  v_lshlrev_b32 v7, 16, v60
  v_and_b32 v8, 0xffff0000, v60
  v_add_f32 v64, v64, v7
  v_add_f32 v65, v65, v8
  v_lshlrev_b32 v7, 16, v61
  v_and_b32 v8, 0xffff0000, v61
  v_add_f32 v66, v66, v7
  v_add_f32 v67, v67, v8
  v_lshlrev_b32 v7, 16, v62
  v_and_b32 v8, 0xffff0000, v62
  v_add_f32 v68, v68, v7
  v_add_f32 v69, v69, v8
  v_lshlrev_b32 v7, 16, v63
  v_and_b32 v8, 0xffff0000, v63
  v_add_f32 v70, v70, v7
  v_add_f32 v71, v71, v8
  v_cvt_pk_bf16_f32 v72, v64, v65
  v_cvt_pk_bf16_f32 v73, v66, v67
  v_cvt_pk_bf16_f32 v74, v68, v69
  v_cvt_pk_bf16_f32 v75, v70, v71
  s_nop 0
  v_permlane32_swap_b32 v72, v74
  v_permlane32_swap_b32 v73, v75
  s_lshl_b32 s6, s51, 5
  buffer_store_dwordx4 v[72:75], v5, s[12:15], s6 offen
ONLYW87:
F_END:
  s_endpgm
A_SLOW45:
  s_nop 15
  s_nop 3
  v_max3_f32 v5, v32, v33, v34
  v_max3_f32 v5, v5, v35, v36
  v_max3_f32 v5, v5, v37, v38
  v_max3_f32 v5, v5, v39, v40
  v_max3_f32 v5, v5, v41, v42
  v_max3_f32 v5, v5, v43, v44
  v_max3_f32 v5, v5, v45, v46
  v_max_f32 v5, v5, v47
  v_mov_b32 v6, v5
  s_nop 1
  v_permlane32_swap_b32 v5, v6
  v_max_f32 v5, v5, v6
  v_add_f32 v5, 0x42200000, v5
  v_max_f32 v18, 0, v5
  v_exp_f32 v17, -v18
  v_sub_f32 v64, v64, v18
  v_sub_f32 v32, v32, v18
  v_sub_f32 v48, v48, v18
  v_sub_f32 v65, v65, v18
  v_sub_f32 v33, v33, v18
  v_sub_f32 v49, v49, v18
  v_sub_f32 v66, v66, v18
  v_sub_f32 v34, v34, v18
  v_sub_f32 v50, v50, v18
  v_sub_f32 v67, v67, v18
  v_sub_f32 v35, v35, v18
  v_sub_f32 v51, v51, v18
  v_sub_f32 v68, v68, v18
  v_sub_f32 v36, v36, v18
  v_sub_f32 v52, v52, v18
  v_sub_f32 v69, v69, v18
  v_sub_f32 v37, v37, v18
  v_sub_f32 v53, v53, v18
  v_sub_f32 v70, v70, v18
  v_sub_f32 v38, v38, v18
  v_sub_f32 v54, v54, v18
  v_sub_f32 v71, v71, v18
  v_sub_f32 v39, v39, v18
  v_sub_f32 v55, v55, v18
  v_sub_f32 v72, v72, v18
  v_sub_f32 v40, v40, v18
  v_sub_f32 v56, v56, v18
  v_sub_f32 v73, v73, v18
  v_sub_f32 v41, v41, v18
  v_sub_f32 v57, v57, v18
  v_sub_f32 v74, v74, v18
  v_sub_f32 v42, v42, v18
  v_sub_f32 v58, v58, v18
  v_sub_f32 v75, v75, v18
  v_sub_f32 v43, v43, v18
  v_sub_f32 v59, v59, v18
  v_sub_f32 v76, v76, v18
  v_sub_f32 v44, v44, v18
  v_sub_f32 v60, v60, v18
  v_sub_f32 v77, v77, v18
  v_sub_f32 v45, v45, v18
  v_sub_f32 v61, v61, v18
  v_sub_f32 v78, v78, v18
  v_sub_f32 v46, v46, v18
  v_sub_f32 v62, v62, v18
  v_sub_f32 v79, v79, v18
  v_sub_f32 v47, v47, v18
  v_sub_f32 v63, v63, v18
  v_mul_f32 v10, v10, v17
  v_accvgpr_read_b32 v104, a0
  v_accvgpr_read_b32 v105, a1
  v_accvgpr_read_b32 v106, a2
  v_accvgpr_read_b32 v107, a3
  v_accvgpr_read_b32 v108, a4
  v_accvgpr_read_b32 v109, a5
  v_accvgpr_read_b32 v110, a6
  v_accvgpr_read_b32 v111, a7
  v_mul_f32 v104, v104, v17
  v_mul_f32 v105, v105, v17
  v_mul_f32 v106, v106, v17
  v_mul_f32 v107, v107, v17
  v_mul_f32 v108, v108, v17
  v_mul_f32 v109, v109, v17
  v_mul_f32 v110, v110, v17
  v_mul_f32 v111, v111, v17
  v_accvgpr_write_b32 a0, v104
  v_accvgpr_write_b32 a1, v105
  v_accvgpr_write_b32 a2, v106
  v_accvgpr_write_b32 a3, v107
  v_accvgpr_write_b32 a4, v108
  v_accvgpr_write_b32 a5, v109
  v_accvgpr_write_b32 a6, v110
  v_accvgpr_write_b32 a7, v111
  v_accvgpr_read_b32 v104, a8
  v_accvgpr_read_b32 v105, a9
  v_accvgpr_read_b32 v106, a10
  v_accvgpr_read_b32 v107, a11
  v_accvgpr_read_b32 v108, a12
  v_accvgpr_read_b32 v109, a13
  v_accvgpr_read_b32 v110, a14
  v_accvgpr_read_b32 v111, a15
  v_mul_f32 v104, v104, v17
  v_mul_f32 v105, v105, v17
  v_mul_f32 v106, v106, v17
  v_mul_f32 v107, v107, v17
  v_mul_f32 v108, v108, v17
  v_mul_f32 v109, v109, v17
  v_mul_f32 v110, v110, v17
  v_mul_f32 v111, v111, v17
  v_accvgpr_write_b32 a8, v104
  v_accvgpr_write_b32 a9, v105
  v_accvgpr_write_b32 a10, v106
  v_accvgpr_write_b32 a11, v107
  v_accvgpr_write_b32 a12, v108
  v_accvgpr_write_b32 a13, v109
  v_accvgpr_write_b32 a14, v110
  v_accvgpr_write_b32 a15, v111
  v_accvgpr_read_b32 v104, a16
  v_accvgpr_read_b32 v105, a17
  v_accvgpr_read_b32 v106, a18
  v_accvgpr_read_b32 v107, a19
  v_accvgpr_read_b32 v108, a20
  v_accvgpr_read_b32 v109, a21
  v_accvgpr_read_b32 v110, a22
  v_accvgpr_read_b32 v111, a23
  v_mul_f32 v104, v104, v17
  v_mul_f32 v105, v105, v17
  v_mul_f32 v106, v106, v17
  v_mul_f32 v107, v107, v17
  v_mul_f32 v108, v108, v17
  v_mul_f32 v109, v109, v17
  v_mul_f32 v110, v110, v17
  v_mul_f32 v111, v111, v17
  v_accvgpr_write_b32 a16, v104
  v_accvgpr_write_b32 a17, v105
  v_accvgpr_write_b32 a18, v106
  v_accvgpr_write_b32 a19, v107
  v_accvgpr_write_b32 a20, v108
  v_accvgpr_write_b32 a21, v109
  v_accvgpr_write_b32 a22, v110
  v_accvgpr_write_b32 a23, v111
  v_accvgpr_read_b32 v104, a24
  v_accvgpr_read_b32 v105, a25
  v_accvgpr_read_b32 v106, a26
  v_accvgpr_read_b32 v107, a27
  v_accvgpr_read_b32 v108, a28
  v_accvgpr_read_b32 v109, a29
  v_accvgpr_read_b32 v110, a30
  v_accvgpr_read_b32 v111, a31
  v_mul_f32 v104, v104, v17
  v_mul_f32 v105, v105, v17
  v_mul_f32 v106, v106, v17
  v_mul_f32 v107, v107, v17
  v_mul_f32 v108, v108, v17
  v_mul_f32 v109, v109, v17
  v_mul_f32 v110, v110, v17
  v_mul_f32 v111, v111, v17
  v_accvgpr_write_b32 a24, v104
  v_accvgpr_write_b32 a25, v105
  v_accvgpr_write_b32 a26, v106
  v_accvgpr_write_b32 a27, v107
  v_accvgpr_write_b32 a28, v108
  v_accvgpr_write_b32 a29, v109
  v_accvgpr_write_b32 a30, v110
  v_accvgpr_write_b32 a31, v111
  v_accvgpr_read_b32 v104, a32
  v_accvgpr_read_b32 v105, a33
  v_accvgpr_read_b32 v106, a34
  v_accvgpr_read_b32 v107, a35
  v_accvgpr_read_b32 v108, a36
  v_accvgpr_read_b32 v109, a37
  v_accvgpr_read_b32 v110, a38
  v_accvgpr_read_b32 v111, a39
  v_mul_f32 v104, v104, v17
  v_mul_f32 v105, v105, v17
  v_mul_f32 v106, v106, v17
  v_mul_f32 v107, v107, v17
  v_mul_f32 v108, v108, v17
  v_mul_f32 v109, v109, v17
  v_mul_f32 v110, v110, v17
  v_mul_f32 v111, v111, v17
  v_accvgpr_write_b32 a32, v104
  v_accvgpr_write_b32 a33, v105
  v_accvgpr_write_b32 a34, v106
  v_accvgpr_write_b32 a35, v107
  v_accvgpr_write_b32 a36, v108
  v_accvgpr_write_b32 a37, v109
  v_accvgpr_write_b32 a38, v110
  v_accvgpr_write_b32 a39, v111
  v_accvgpr_read_b32 v104, a40
  v_accvgpr_read_b32 v105, a41
  v_accvgpr_read_b32 v106, a42
  v_accvgpr_read_b32 v107, a43
  v_accvgpr_read_b32 v108, a44
  v_accvgpr_read_b32 v109, a45
  v_accvgpr_read_b32 v110, a46
  v_accvgpr_read_b32 v111, a47
  v_mul_f32 v104, v104, v17
  v_mul_f32 v105, v105, v17
  v_mul_f32 v106, v106, v17
  v_mul_f32 v107, v107, v17
  v_mul_f32 v108, v108, v17
  v_mul_f32 v109, v109, v17
  v_mul_f32 v110, v110, v17
  v_mul_f32 v111, v111, v17
  v_accvgpr_write_b32 a40, v104
  v_accvgpr_write_b32 a41, v105
  v_accvgpr_write_b32 a42, v106
  v_accvgpr_write_b32 a43, v107
  v_accvgpr_write_b32 a44, v108
  v_accvgpr_write_b32 a45, v109
  v_accvgpr_write_b32 a46, v110
  v_accvgpr_write_b32 a47, v111
  v_accvgpr_read_b32 v104, a48
  v_accvgpr_read_b32 v105, a49
  v_accvgpr_read_b32 v106, a50
  v_accvgpr_read_b32 v107, a51
  v_accvgpr_read_b32 v108, a52
  v_accvgpr_read_b32 v109, a53
  v_accvgpr_read_b32 v110, a54
  v_accvgpr_read_b32 v111, a55
  v_mul_f32 v104, v104, v17
  v_mul_f32 v105, v105, v17
  v_mul_f32 v106, v106, v17
  v_mul_f32 v107, v107, v17
  v_mul_f32 v108, v108, v17
  v_mul_f32 v109, v109, v17
  v_mul_f32 v110, v110, v17
  v_mul_f32 v111, v111, v17
  v_accvgpr_write_b32 a48, v104
  v_accvgpr_write_b32 a49, v105
  v_accvgpr_write_b32 a50, v106
  v_accvgpr_write_b32 a51, v107
  v_accvgpr_write_b32 a52, v108
  v_accvgpr_write_b32 a53, v109
  v_accvgpr_write_b32 a54, v110
  v_accvgpr_write_b32 a55, v111
  v_accvgpr_read_b32 v104, a56
  v_accvgpr_read_b32 v105, a57
  v_accvgpr_read_b32 v106, a58
  v_accvgpr_read_b32 v107, a59
  v_accvgpr_read_b32 v108, a60
  v_accvgpr_read_b32 v109, a61
  v_accvgpr_read_b32 v110, a62
  v_accvgpr_read_b32 v111, a63
  v_mul_f32 v104, v104, v17
  v_mul_f32 v105, v105, v17
  v_mul_f32 v106, v106, v17
  v_mul_f32 v107, v107, v17
  v_mul_f32 v108, v108, v17
  v_mul_f32 v109, v109, v17
  v_mul_f32 v110, v110, v17
  v_mul_f32 v111, v111, v17
  v_accvgpr_write_b32 a56, v104
  v_accvgpr_write_b32 a57, v105
  v_accvgpr_write_b32 a58, v106
  v_accvgpr_write_b32 a59, v107
  v_accvgpr_write_b32 a60, v108
  v_accvgpr_write_b32 a61, v109
  v_accvgpr_write_b32 a62, v110
  v_accvgpr_write_b32 a63, v111
  v_exp_f32 v96, v32
  v_exp_f32 v97, v33
  v_exp_f32 v98, v34
  v_exp_f32 v99, v35
  v_mov_b32 v15, v96
  v_mov_b32 v16, v97
  v_cvt_pk_bf16_f32 v80, v96, v97
  v_exp_f32 v100, v36
  v_exp_f32 v101, v37
  v_add_f32 v15, v15, v98
  v_add_f32 v16, v16, v99
  v_cvt_pk_bf16_f32 v81, v98, v99
  v_exp_f32 v102, v38
  v_exp_f32 v103, v39
  v_add_f32 v15, v15, v100
  v_add_f32 v16, v16, v101
  v_cvt_pk_bf16_f32 v82, v100, v101
  v_exp_f32 v96, v40
  v_exp_f32 v97, v41
  v_add_f32 v15, v15, v102
  v_add_f32 v16, v16, v103
  v_cvt_pk_bf16_f32 v83, v102, v103
  v_exp_f32 v98, v42
  v_exp_f32 v99, v43
  v_add_f32 v15, v15, v96
  v_add_f32 v16, v16, v97
  v_cvt_pk_bf16_f32 v84, v96, v97
  v_exp_f32 v100, v44
  v_exp_f32 v101, v45
  v_add_f32 v15, v15, v98
  v_add_f32 v16, v16, v99
  v_cvt_pk_bf16_f32 v85, v98, v99
  v_exp_f32 v102, v46
  v_exp_f32 v103, v47
  v_add_f32 v15, v15, v100
  v_add_f32 v16, v16, v101
  v_cvt_pk_bf16_f32 v86, v100, v101
  v_add_f32 v15, v15, v102
  v_add_f32 v16, v16, v103
  v_cvt_pk_bf16_f32 v87, v102, v103
  v_add_f32 v15, v15, v16
  s_nop 3
  s_branch A_RET46
A_SLOW47:
  s_nop 15
  s_nop 3
  v_max3_f32 v5, v48, v49, v50
  v_max3_f32 v5, v5, v51, v52
  v_max3_f32 v5, v5, v53, v54
  v_max3_f32 v5, v5, v55, v56
  v_max3_f32 v5, v5, v57, v58
  v_max3_f32 v5, v5, v59, v60
  v_max3_f32 v5, v5, v61, v62
  v_max_f32 v5, v5, v63
  v_mov_b32 v6, v5
  s_nop 1
  v_permlane32_swap_b32 v5, v6
  v_max_f32 v5, v5, v6
  v_add_f32 v5, 0x42200000, v5
  v_max_f32 v18, 0, v5
  v_exp_f32 v17, -v18
  v_sub_f32 v64, v64, v18
  v_sub_f32 v48, v48, v18
  v_sub_f32 v32, v32, v18
  v_sub_f32 v65, v65, v18
  v_sub_f32 v49, v49, v18
  v_sub_f32 v33, v33, v18
  v_sub_f32 v66, v66, v18
  v_sub_f32 v50, v50, v18
  v_sub_f32 v34, v34, v18
  v_sub_f32 v67, v67, v18
  v_sub_f32 v51, v51, v18
  v_sub_f32 v35, v35, v18
  v_sub_f32 v68, v68, v18
  v_sub_f32 v52, v52, v18
  v_sub_f32 v36, v36, v18
  v_sub_f32 v69, v69, v18
  v_sub_f32 v53, v53, v18
  v_sub_f32 v37, v37, v18
  v_sub_f32 v70, v70, v18
  v_sub_f32 v54, v54, v18
  v_sub_f32 v38, v38, v18
  v_sub_f32 v71, v71, v18
  v_sub_f32 v55, v55, v18
  v_sub_f32 v39, v39, v18
  v_sub_f32 v72, v72, v18
  v_sub_f32 v56, v56, v18
  v_sub_f32 v40, v40, v18
  v_sub_f32 v73, v73, v18
  v_sub_f32 v57, v57, v18
  v_sub_f32 v41, v41, v18
  v_sub_f32 v74, v74, v18
  v_sub_f32 v58, v58, v18
  v_sub_f32 v42, v42, v18
  v_sub_f32 v75, v75, v18
  v_sub_f32 v59, v59, v18
  v_sub_f32 v43, v43, v18
  v_sub_f32 v76, v76, v18
  v_sub_f32 v60, v60, v18
  v_sub_f32 v44, v44, v18
  v_sub_f32 v77, v77, v18
  v_sub_f32 v61, v61, v18
  v_sub_f32 v45, v45, v18
  v_sub_f32 v78, v78, v18
  v_sub_f32 v62, v62, v18
  v_sub_f32 v46, v46, v18
  v_sub_f32 v79, v79, v18
  v_sub_f32 v63, v63, v18
  v_sub_f32 v47, v47, v18
  v_mul_f32 v10, v10, v17
  v_accvgpr_read_b32 v104, a0
  v_accvgpr_read_b32 v105, a1
  v_accvgpr_read_b32 v106, a2
  v_accvgpr_read_b32 v107, a3
  v_accvgpr_read_b32 v108, a4
  v_accvgpr_read_b32 v109, a5
  v_accvgpr_read_b32 v110, a6
  v_accvgpr_read_b32 v111, a7
  v_mul_f32 v104, v104, v17
  v_mul_f32 v105, v105, v17
  v_mul_f32 v106, v106, v17
  v_mul_f32 v107, v107, v17
  v_mul_f32 v108, v108, v17
  v_mul_f32 v109, v109, v17
  v_mul_f32 v110, v110, v17
  v_mul_f32 v111, v111, v17
  v_accvgpr_write_b32 a0, v104
  v_accvgpr_write_b32 a1, v105
  v_accvgpr_write_b32 a2, v106
  v_accvgpr_write_b32 a3, v107
  v_accvgpr_write_b32 a4, v108
  v_accvgpr_write_b32 a5, v109
  v_accvgpr_write_b32 a6, v110
  v_accvgpr_write_b32 a7, v111
  v_accvgpr_read_b32 v104, a8
  v_accvgpr_read_b32 v105, a9
  v_accvgpr_read_b32 v106, a10
  v_accvgpr_read_b32 v107, a11
  v_accvgpr_read_b32 v108, a12
  v_accvgpr_read_b32 v109, a13
  v_accvgpr_read_b32 v110, a14
  v_accvgpr_read_b32 v111, a15
  v_mul_f32 v104, v104, v17
  v_mul_f32 v105, v105, v17
  v_mul_f32 v106, v106, v17
  v_mul_f32 v107, v107, v17
  v_mul_f32 v108, v108, v17
  v_mul_f32 v109, v109, v17
  v_mul_f32 v110, v110, v17
  v_mul_f32 v111, v111, v17
  v_accvgpr_write_b32 a8, v104
  v_accvgpr_write_b32 a9, v105
  v_accvgpr_write_b32 a10, v106
  v_accvgpr_write_b32 a11, v107
  v_accvgpr_write_b32 a12, v108
  v_accvgpr_write_b32 a13, v109
  v_accvgpr_write_b32 a14, v110
  v_accvgpr_write_b32 a15, v111
  v_accvgpr_read_b32 v104, a16
  v_accvgpr_read_b32 v105, a17
  v_accvgpr_read_b32 v106, a18
  v_accvgpr_read_b32 v107, a19
  v_accvgpr_read_b32 v108, a20
  v_accvgpr_read_b32 v109, a21
  v_accvgpr_read_b32 v110, a22
  v_accvgpr_read_b32 v111, a23
  v_mul_f32 v104, v104, v17
  v_mul_f32 v105, v105, v17
  v_mul_f32 v106, v106, v17
  v_mul_f32 v107, v107, v17
  v_mul_f32 v108, v108, v17
  v_mul_f32 v109, v109, v17
  v_mul_f32 v110, v110, v17
  v_mul_f32 v111, v111, v17
  v_accvgpr_write_b32 a16, v104
  v_accvgpr_write_b32 a17, v105
  v_accvgpr_write_b32 a18, v106
  v_accvgpr_write_b32 a19, v107
  v_accvgpr_write_b32 a20, v108
  v_accvgpr_write_b32 a21, v109
  v_accvgpr_write_b32 a22, v110
  v_accvgpr_write_b32 a23, v111
  v_accvgpr_read_b32 v104, a24
  v_accvgpr_read_b32 v105, a25
  v_accvgpr_read_b32 v106, a26
  v_accvgpr_read_b32 v107, a27
  v_accvgpr_read_b32 v108, a28
  v_accvgpr_read_b32 v109, a29
  v_accvgpr_read_b32 v110, a30
  v_accvgpr_read_b32 v111, a31
  v_mul_f32 v104, v104, v17
  v_mul_f32 v105, v105, v17
  v_mul_f32 v106, v106, v17
  v_mul_f32 v107, v107, v17
  v_mul_f32 v108, v108, v17
  v_mul_f32 v109, v109, v17
  v_mul_f32 v110, v110, v17
  v_mul_f32 v111, v111, v17
  v_accvgpr_write_b32 a24, v104
  v_accvgpr_write_b32 a25, v105
  v_accvgpr_write_b32 a26, v106
  v_accvgpr_write_b32 a27, v107
  v_accvgpr_write_b32 a28, v108
  v_accvgpr_write_b32 a29, v109
  v_accvgpr_write_b32 a30, v110
  v_accvgpr_write_b32 a31, v111
  v_accvgpr_read_b32 v104, a32
  v_accvgpr_read_b32 v105, a33
  v_accvgpr_read_b32 v106, a34
  v_accvgpr_read_b32 v107, a35
  v_accvgpr_read_b32 v108, a36
  v_accvgpr_read_b32 v109, a37
  v_accvgpr_read_b32 v110, a38
  v_accvgpr_read_b32 v111, a39
  v_mul_f32 v104, v104, v17
  v_mul_f32 v105, v105, v17
  v_mul_f32 v106, v106, v17
  v_mul_f32 v107, v107, v17
  v_mul_f32 v108, v108, v17
  v_mul_f32 v109, v109, v17
  v_mul_f32 v110, v110, v17
  v_mul_f32 v111, v111, v17
  v_accvgpr_write_b32 a32, v104
  v_accvgpr_write_b32 a33, v105
  v_accvgpr_write_b32 a34, v106
  v_accvgpr_write_b32 a35, v107
  v_accvgpr_write_b32 a36, v108
  v_accvgpr_write_b32 a37, v109
  v_accvgpr_write_b32 a38, v110
  v_accvgpr_write_b32 a39, v111
  v_accvgpr_read_b32 v104, a40
  v_accvgpr_read_b32 v105, a41
  v_accvgpr_read_b32 v106, a42
  v_accvgpr_read_b32 v107, a43
  v_accvgpr_read_b32 v108, a44
  v_accvgpr_read_b32 v109, a45
  v_accvgpr_read_b32 v110, a46
  v_accvgpr_read_b32 v111, a47
  v_mul_f32 v104, v104, v17
  v_mul_f32 v105, v105, v17
  v_mul_f32 v106, v106, v17
  v_mul_f32 v107, v107, v17
  v_mul_f32 v108, v108, v17
  v_mul_f32 v109, v109, v17
  v_mul_f32 v110, v110, v17
  v_mul_f32 v111, v111, v17
  v_accvgpr_write_b32 a40, v104
  v_accvgpr_write_b32 a41, v105
  v_accvgpr_write_b32 a42, v106
  v_accvgpr_write_b32 a43, v107
  v_accvgpr_write_b32 a44, v108
  v_accvgpr_write_b32 a45, v109
  v_accvgpr_write_b32 a46, v110
  v_accvgpr_write_b32 a47, v111
  v_accvgpr_read_b32 v104, a48
  v_accvgpr_read_b32 v105, a49
  v_accvgpr_read_b32 v106, a50
  v_accvgpr_read_b32 v107, a51
  v_accvgpr_read_b32 v108, a52
  v_accvgpr_read_b32 v109, a53
  v_accvgpr_read_b32 v110, a54
  v_accvgpr_read_b32 v111, a55
  v_mul_f32 v104, v104, v17
  v_mul_f32 v105, v105, v17
  v_mul_f32 v106, v106, v17
  v_mul_f32 v107, v107, v17
  v_mul_f32 v108, v108, v17
  v_mul_f32 v109, v109, v17
  v_mul_f32 v110, v110, v17
  v_mul_f32 v111, v111, v17
  v_accvgpr_write_b32 a48, v104
  v_accvgpr_write_b32 a49, v105
  v_accvgpr_write_b32 a50, v106
  v_accvgpr_write_b32 a51, v107
  v_accvgpr_write_b32 a52, v108
  v_accvgpr_write_b32 a53, v109
  v_accvgpr_write_b32 a54, v110
  v_accvgpr_write_b32 a55, v111
  v_accvgpr_read_b32 v104, a56
  v_accvgpr_read_b32 v105, a57
  v_accvgpr_read_b32 v106, a58
  v_accvgpr_read_b32 v107, a59
  v_accvgpr_read_b32 v108, a60
  v_accvgpr_read_b32 v109, a61
  v_accvgpr_read_b32 v110, a62
  v_accvgpr_read_b32 v111, a63
  v_mul_f32 v104, v104, v17
  v_mul_f32 v105, v105, v17
  v_mul_f32 v106, v106, v17
  v_mul_f32 v107, v107, v17
  v_mul_f32 v108, v108, v17
  v_mul_f32 v109, v109, v17
  v_mul_f32 v110, v110, v17
  v_mul_f32 v111, v111, v17
  v_accvgpr_write_b32 a56, v104
  v_accvgpr_write_b32 a57, v105
  v_accvgpr_write_b32 a58, v106
  v_accvgpr_write_b32 a59, v107
  v_accvgpr_write_b32 a60, v108
  v_accvgpr_write_b32 a61, v109
  v_accvgpr_write_b32 a62, v110
  v_accvgpr_write_b32 a63, v111
  v_exp_f32 v96, v48
  v_exp_f32 v97, v49
  v_exp_f32 v98, v50
  v_exp_f32 v99, v51
  v_mov_b32 v15, v96
  v_mov_b32 v16, v97
  v_cvt_pk_bf16_f32 v88, v96, v97
  v_exp_f32 v100, v52
  v_exp_f32 v101, v53
  v_add_f32 v15, v15, v98
  v_add_f32 v16, v16, v99
  v_cvt_pk_bf16_f32 v89, v98, v99
  v_exp_f32 v102, v54
  v_exp_f32 v103, v55
  v_add_f32 v15, v15, v100
  v_add_f32 v16, v16, v101
  v_cvt_pk_bf16_f32 v90, v100, v101
  v_exp_f32 v96, v56
  v_exp_f32 v97, v57
  v_add_f32 v15, v15, v102
  v_add_f32 v16, v16, v103
  v_cvt_pk_bf16_f32 v91, v102, v103
  v_exp_f32 v98, v58
  v_exp_f32 v99, v59
  v_add_f32 v15, v15, v96
  v_add_f32 v16, v16, v97
  v_cvt_pk_bf16_f32 v92, v96, v97
  v_exp_f32 v100, v60
  v_exp_f32 v101, v61
  v_add_f32 v15, v15, v98
  v_add_f32 v16, v16, v99
  v_cvt_pk_bf16_f32 v93, v98, v99
  v_exp_f32 v102, v62
  v_exp_f32 v103, v63
  v_add_f32 v15, v15, v100
  v_add_f32 v16, v16, v101
  v_cvt_pk_bf16_f32 v94, v100, v101
  v_add_f32 v15, v15, v102
  v_add_f32 v16, v16, v103
  v_cvt_pk_bf16_f32 v95, v102, v103
  v_add_f32 v15, v15, v16
  s_nop 3
  s_branch A_RET48
A_SLOW50:
  s_nop 15
  s_nop 3
  v_max3_f32 v5, v32, v33, v34
  v_max3_f32 v5, v5, v35, v36
  v_max3_f32 v5, v5, v37, v38
  v_max3_f32 v5, v5, v39, v40
  v_max3_f32 v5, v5, v41, v42
  v_max3_f32 v5, v5, v43, v44
  v_max3_f32 v5, v5, v45, v46
  v_max_f32 v5, v5, v47
  v_mov_b32 v6, v5
  s_nop 1
  v_permlane32_swap_b32 v5, v6
  v_max_f32 v5, v5, v6
  v_add_f32 v5, 0x42200000, v5
  v_max_f32 v18, 0, v5
  v_exp_f32 v17, -v18
  v_sub_f32 v64, v64, v18
  v_sub_f32 v32, v32, v18
  v_sub_f32 v48, v48, v18
  v_sub_f32 v65, v65, v18
  v_sub_f32 v33, v33, v18
  v_sub_f32 v49, v49, v18
  v_sub_f32 v66, v66, v18
  v_sub_f32 v34, v34, v18
  v_sub_f32 v50, v50, v18
  v_sub_f32 v67, v67, v18
  v_sub_f32 v35, v35, v18
  v_sub_f32 v51, v51, v18
  v_sub_f32 v68, v68, v18
  v_sub_f32 v36, v36, v18
  v_sub_f32 v52, v52, v18
  v_sub_f32 v69, v69, v18
  v_sub_f32 v37, v37, v18
  v_sub_f32 v53, v53, v18
  v_sub_f32 v70, v70, v18
  v_sub_f32 v38, v38, v18
  v_sub_f32 v54, v54, v18
  v_sub_f32 v71, v71, v18
  v_sub_f32 v39, v39, v18
  v_sub_f32 v55, v55, v18
  v_sub_f32 v72, v72, v18
  v_sub_f32 v40, v40, v18
  v_sub_f32 v56, v56, v18
  v_sub_f32 v73, v73, v18
  v_sub_f32 v41, v41, v18
  v_sub_f32 v57, v57, v18
  v_sub_f32 v74, v74, v18
  v_sub_f32 v42, v42, v18
  v_sub_f32 v58, v58, v18
  v_sub_f32 v75, v75, v18
  v_sub_f32 v43, v43, v18
  v_sub_f32 v59, v59, v18
  v_sub_f32 v76, v76, v18
  v_sub_f32 v44, v44, v18
  v_sub_f32 v60, v60, v18
  v_sub_f32 v77, v77, v18
  v_sub_f32 v45, v45, v18
  v_sub_f32 v61, v61, v18
  v_sub_f32 v78, v78, v18
  v_sub_f32 v46, v46, v18
  v_sub_f32 v62, v62, v18
  v_sub_f32 v79, v79, v18
  v_sub_f32 v47, v47, v18
  v_sub_f32 v63, v63, v18
  v_mul_f32 v10, v10, v17
  v_accvgpr_read_b32 v104, a0
  v_accvgpr_read_b32 v105, a1
  v_accvgpr_read_b32 v106, a2
  v_accvgpr_read_b32 v107, a3
  v_accvgpr_read_b32 v108, a4
  v_accvgpr_read_b32 v109, a5
  v_accvgpr_read_b32 v110, a6
  v_accvgpr_read_b32 v111, a7
  v_mul_f32 v104, v104, v17
  v_mul_f32 v105, v105, v17
  v_mul_f32 v106, v106, v17
  v_mul_f32 v107, v107, v17
  v_mul_f32 v108, v108, v17
  v_mul_f32 v109, v109, v17
  v_mul_f32 v110, v110, v17
  v_mul_f32 v111, v111, v17
  v_accvgpr_write_b32 a0, v104
  v_accvgpr_write_b32 a1, v105
  v_accvgpr_write_b32 a2, v106
  v_accvgpr_write_b32 a3, v107
  v_accvgpr_write_b32 a4, v108
  v_accvgpr_write_b32 a5, v109
  v_accvgpr_write_b32 a6, v110
  v_accvgpr_write_b32 a7, v111
  v_accvgpr_read_b32 v104, a8
  v_accvgpr_read_b32 v105, a9
  v_accvgpr_read_b32 v106, a10
  v_accvgpr_read_b32 v107, a11
  v_accvgpr_read_b32 v108, a12
  v_accvgpr_read_b32 v109, a13
  v_accvgpr_read_b32 v110, a14
  v_accvgpr_read_b32 v111, a15
  v_mul_f32 v104, v104, v17
  v_mul_f32 v105, v105, v17
  v_mul_f32 v106, v106, v17
  v_mul_f32 v107, v107, v17
  v_mul_f32 v108, v108, v17
  v_mul_f32 v109, v109, v17
  v_mul_f32 v110, v110, v17
  v_mul_f32 v111, v111, v17
  v_accvgpr_write_b32 a8, v104
  v_accvgpr_write_b32 a9, v105
  v_accvgpr_write_b32 a10, v106
  v_accvgpr_write_b32 a11, v107
  v_accvgpr_write_b32 a12, v108
  v_accvgpr_write_b32 a13, v109
  v_accvgpr_write_b32 a14, v110
  v_accvgpr_write_b32 a15, v111
  v_accvgpr_read_b32 v104, a16
  v_accvgpr_read_b32 v105, a17
  v_accvgpr_read_b32 v106, a18
  v_accvgpr_read_b32 v107, a19
  v_accvgpr_read_b32 v108, a20
  v_accvgpr_read_b32 v109, a21
  v_accvgpr_read_b32 v110, a22
  v_accvgpr_read_b32 v111, a23
  v_mul_f32 v104, v104, v17
  v_mul_f32 v105, v105, v17
  v_mul_f32 v106, v106, v17
  v_mul_f32 v107, v107, v17
  v_mul_f32 v108, v108, v17
  v_mul_f32 v109, v109, v17
  v_mul_f32 v110, v110, v17
  v_mul_f32 v111, v111, v17
  v_accvgpr_write_b32 a16, v104
  v_accvgpr_write_b32 a17, v105
  v_accvgpr_write_b32 a18, v106
  v_accvgpr_write_b32 a19, v107
  v_accvgpr_write_b32 a20, v108
  v_accvgpr_write_b32 a21, v109
  v_accvgpr_write_b32 a22, v110
  v_accvgpr_write_b32 a23, v111
  v_accvgpr_read_b32 v104, a24
  v_accvgpr_read_b32 v105, a25
  v_accvgpr_read_b32 v106, a26
  v_accvgpr_read_b32 v107, a27
  v_accvgpr_read_b32 v108, a28
  v_accvgpr_read_b32 v109, a29
  v_accvgpr_read_b32 v110, a30
  v_accvgpr_read_b32 v111, a31
  v_mul_f32 v104, v104, v17
  v_mul_f32 v105, v105, v17
  v_mul_f32 v106, v106, v17
  v_mul_f32 v107, v107, v17
  v_mul_f32 v108, v108, v17
  v_mul_f32 v109, v109, v17
  v_mul_f32 v110, v110, v17
  v_mul_f32 v111, v111, v17
  v_accvgpr_write_b32 a24, v104
  v_accvgpr_write_b32 a25, v105
  v_accvgpr_write_b32 a26, v106
  v_accvgpr_write_b32 a27, v107
  v_accvgpr_write_b32 a28, v108
  v_accvgpr_write_b32 a29, v109
  v_accvgpr_write_b32 a30, v110
  v_accvgpr_write_b32 a31, v111
  v_accvgpr_read_b32 v104, a32
  v_accvgpr_read_b32 v105, a33
  v_accvgpr_read_b32 v106, a34
  v_accvgpr_read_b32 v107, a35
  v_accvgpr_read_b32 v108, a36
  v_accvgpr_read_b32 v109, a37
  v_accvgpr_read_b32 v110, a38
  v_accvgpr_read_b32 v111, a39
  v_mul_f32 v104, v104, v17
  v_mul_f32 v105, v105, v17
  v_mul_f32 v106, v106, v17
  v_mul_f32 v107, v107, v17
  v_mul_f32 v108, v108, v17
  v_mul_f32 v109, v109, v17
  v_mul_f32 v110, v110, v17
  v_mul_f32 v111, v111, v17
  v_accvgpr_write_b32 a32, v104
  v_accvgpr_write_b32 a33, v105
  v_accvgpr_write_b32 a34, v106
  v_accvgpr_write_b32 a35, v107
  v_accvgpr_write_b32 a36, v108
  v_accvgpr_write_b32 a37, v109
  v_accvgpr_write_b32 a38, v110
  v_accvgpr_write_b32 a39, v111
  v_accvgpr_read_b32 v104, a40
  v_accvgpr_read_b32 v105, a41
  v_accvgpr_read_b32 v106, a42
  v_accvgpr_read_b32 v107, a43
  v_accvgpr_read_b32 v108, a44
  v_accvgpr_read_b32 v109, a45
  v_accvgpr_read_b32 v110, a46
  v_accvgpr_read_b32 v111, a47
  v_mul_f32 v104, v104, v17
  v_mul_f32 v105, v105, v17
  v_mul_f32 v106, v106, v17
  v_mul_f32 v107, v107, v17
  v_mul_f32 v108, v108, v17
  v_mul_f32 v109, v109, v17
  v_mul_f32 v110, v110, v17
  v_mul_f32 v111, v111, v17
  v_accvgpr_write_b32 a40, v104
  v_accvgpr_write_b32 a41, v105
  v_accvgpr_write_b32 a42, v106
  v_accvgpr_write_b32 a43, v107
  v_accvgpr_write_b32 a44, v108
  v_accvgpr_write_b32 a45, v109
  v_accvgpr_write_b32 a46, v110
  v_accvgpr_write_b32 a47, v111
  v_accvgpr_read_b32 v104, a48
  v_accvgpr_read_b32 v105, a49
  v_accvgpr_read_b32 v106, a50
  v_accvgpr_read_b32 v107, a51
  v_accvgpr_read_b32 v108, a52
  v_accvgpr_read_b32 v109, a53
  v_accvgpr_read_b32 v110, a54
  v_accvgpr_read_b32 v111, a55
  v_mul_f32 v104, v104, v17
  v_mul_f32 v105, v105, v17
  v_mul_f32 v106, v106, v17
  v_mul_f32 v107, v107, v17
  v_mul_f32 v108, v108, v17
  v_mul_f32 v109, v109, v17
  v_mul_f32 v110, v110, v17
  v_mul_f32 v111, v111, v17
  v_accvgpr_write_b32 a48, v104
  v_accvgpr_write_b32 a49, v105
  v_accvgpr_write_b32 a50, v106
  v_accvgpr_write_b32 a51, v107
  v_accvgpr_write_b32 a52, v108
  v_accvgpr_write_b32 a53, v109
  v_accvgpr_write_b32 a54, v110
  v_accvgpr_write_b32 a55, v111
  v_accvgpr_read_b32 v104, a56
  v_accvgpr_read_b32 v105, a57
  v_accvgpr_read_b32 v106, a58
  v_accvgpr_read_b32 v107, a59
  v_accvgpr_read_b32 v108, a60
  v_accvgpr_read_b32 v109, a61
  v_accvgpr_read_b32 v110, a62
  v_accvgpr_read_b32 v111, a63
  v_mul_f32 v104, v104, v17
  v_mul_f32 v105, v105, v17
  v_mul_f32 v106, v106, v17
  v_mul_f32 v107, v107, v17
  v_mul_f32 v108, v108, v17
  v_mul_f32 v109, v109, v17
  v_mul_f32 v110, v110, v17
  v_mul_f32 v111, v111, v17
  v_accvgpr_write_b32 a56, v104
  v_accvgpr_write_b32 a57, v105
  v_accvgpr_write_b32 a58, v106
  v_accvgpr_write_b32 a59, v107
  v_accvgpr_write_b32 a60, v108
  v_accvgpr_write_b32 a61, v109
  v_accvgpr_write_b32 a62, v110
  v_accvgpr_write_b32 a63, v111
  v_exp_f32 v96, v32
  v_exp_f32 v97, v33
  v_exp_f32 v98, v34
  v_exp_f32 v99, v35
  v_mov_b32 v15, v96
  v_mov_b32 v16, v97
  v_cvt_pk_bf16_f32 v80, v96, v97
  v_exp_f32 v100, v36
  v_exp_f32 v101, v37
  v_add_f32 v15, v15, v98
  v_add_f32 v16, v16, v99
  v_cvt_pk_bf16_f32 v81, v98, v99
  v_exp_f32 v102, v38
  v_exp_f32 v103, v39
  v_add_f32 v15, v15, v100
  v_add_f32 v16, v16, v101
  v_cvt_pk_bf16_f32 v82, v100, v101
  v_exp_f32 v96, v40
  v_exp_f32 v97, v41
  v_add_f32 v15, v15, v102
  v_add_f32 v16, v16, v103
  v_cvt_pk_bf16_f32 v83, v102, v103
  v_exp_f32 v98, v42
  v_exp_f32 v99, v43
  v_add_f32 v15, v15, v96
  v_add_f32 v16, v16, v97
  v_cvt_pk_bf16_f32 v84, v96, v97
  v_exp_f32 v100, v44
  v_exp_f32 v101, v45
  v_add_f32 v15, v15, v98
  v_add_f32 v16, v16, v99
  v_cvt_pk_bf16_f32 v85, v98, v99
  v_exp_f32 v102, v46
  v_exp_f32 v103, v47
  v_add_f32 v15, v15, v100
  v_add_f32 v16, v16, v101
  v_cvt_pk_bf16_f32 v86, v100, v101
  v_add_f32 v15, v15, v102
  v_add_f32 v16, v16, v103
  v_cvt_pk_bf16_f32 v87, v102, v103
  v_add_f32 v15, v15, v16
  s_nop 3
  s_branch A_RET51
A_SLOW52:
  s_nop 15
  s_nop 3
  v_max3_f32 v5, v48, v49, v50
  v_max3_f32 v5, v5, v51, v52
  v_max3_f32 v5, v5, v53, v54
  v_max3_f32 v5, v5, v55, v56
  v_max3_f32 v5, v5, v57, v58
  v_max3_f32 v5, v5, v59, v60
  v_max3_f32 v5, v5, v61, v62
  v_max_f32 v5, v5, v63
  v_mov_b32 v6, v5
  s_nop 1
  v_permlane32_swap_b32 v5, v6
  v_max_f32 v5, v5, v6
  v_add_f32 v5, 0x42200000, v5
  v_max_f32 v18, 0, v5
  v_exp_f32 v17, -v18
  v_sub_f32 v64, v64, v18
  v_sub_f32 v48, v48, v18
  v_sub_f32 v32, v32, v18
  v_sub_f32 v65, v65, v18
  v_sub_f32 v49, v49, v18
  v_sub_f32 v33, v33, v18
  v_sub_f32 v66, v66, v18
  v_sub_f32 v50, v50, v18
  v_sub_f32 v34, v34, v18
  v_sub_f32 v67, v67, v18
  v_sub_f32 v51, v51, v18
  v_sub_f32 v35, v35, v18
  v_sub_f32 v68, v68, v18
  v_sub_f32 v52, v52, v18
  v_sub_f32 v36, v36, v18
  v_sub_f32 v69, v69, v18
  v_sub_f32 v53, v53, v18
  v_sub_f32 v37, v37, v18
  v_sub_f32 v70, v70, v18
  v_sub_f32 v54, v54, v18
  v_sub_f32 v38, v38, v18
  v_sub_f32 v71, v71, v18
  v_sub_f32 v55, v55, v18
  v_sub_f32 v39, v39, v18
  v_sub_f32 v72, v72, v18
  v_sub_f32 v56, v56, v18
  v_sub_f32 v40, v40, v18
  v_sub_f32 v73, v73, v18
  v_sub_f32 v57, v57, v18
  v_sub_f32 v41, v41, v18
  v_sub_f32 v74, v74, v18
  v_sub_f32 v58, v58, v18
  v_sub_f32 v42, v42, v18
  v_sub_f32 v75, v75, v18
  v_sub_f32 v59, v59, v18
  v_sub_f32 v43, v43, v18
  v_sub_f32 v76, v76, v18
  v_sub_f32 v60, v60, v18
  v_sub_f32 v44, v44, v18
  v_sub_f32 v77, v77, v18
  v_sub_f32 v61, v61, v18
  v_sub_f32 v45, v45, v18
  v_sub_f32 v78, v78, v18
  v_sub_f32 v62, v62, v18
  v_sub_f32 v46, v46, v18
  v_sub_f32 v79, v79, v18
  v_sub_f32 v63, v63, v18
  v_sub_f32 v47, v47, v18
  v_mul_f32 v10, v10, v17
  v_accvgpr_read_b32 v104, a0
  v_accvgpr_read_b32 v105, a1
  v_accvgpr_read_b32 v106, a2
  v_accvgpr_read_b32 v107, a3
  v_accvgpr_read_b32 v108, a4
  v_accvgpr_read_b32 v109, a5
  v_accvgpr_read_b32 v110, a6
  v_accvgpr_read_b32 v111, a7
  v_mul_f32 v104, v104, v17
  v_mul_f32 v105, v105, v17
  v_mul_f32 v106, v106, v17
  v_mul_f32 v107, v107, v17
  v_mul_f32 v108, v108, v17
  v_mul_f32 v109, v109, v17
  v_mul_f32 v110, v110, v17
  v_mul_f32 v111, v111, v17
  v_accvgpr_write_b32 a0, v104
  v_accvgpr_write_b32 a1, v105
  v_accvgpr_write_b32 a2, v106
  v_accvgpr_write_b32 a3, v107
  v_accvgpr_write_b32 a4, v108
  v_accvgpr_write_b32 a5, v109
  v_accvgpr_write_b32 a6, v110
  v_accvgpr_write_b32 a7, v111
  v_accvgpr_read_b32 v104, a8
  v_accvgpr_read_b32 v105, a9
  v_accvgpr_read_b32 v106, a10
  v_accvgpr_read_b32 v107, a11
  v_accvgpr_read_b32 v108, a12
  v_accvgpr_read_b32 v109, a13
  v_accvgpr_read_b32 v110, a14
  v_accvgpr_read_b32 v111, a15
  v_mul_f32 v104, v104, v17
  v_mul_f32 v105, v105, v17
  v_mul_f32 v106, v106, v17
  v_mul_f32 v107, v107, v17
  v_mul_f32 v108, v108, v17
  v_mul_f32 v109, v109, v17
  v_mul_f32 v110, v110, v17
  v_mul_f32 v111, v111, v17
  v_accvgpr_write_b32 a8, v104
  v_accvgpr_write_b32 a9, v105
  v_accvgpr_write_b32 a10, v106
  v_accvgpr_write_b32 a11, v107
  v_accvgpr_write_b32 a12, v108
  v_accvgpr_write_b32 a13, v109
  v_accvgpr_write_b32 a14, v110
  v_accvgpr_write_b32 a15, v111
  v_accvgpr_read_b32 v104, a16
  v_accvgpr_read_b32 v105, a17
  v_accvgpr_read_b32 v106, a18
  v_accvgpr_read_b32 v107, a19
  v_accvgpr_read_b32 v108, a20
  v_accvgpr_read_b32 v109, a21
  v_accvgpr_read_b32 v110, a22
  v_accvgpr_read_b32 v111, a23
  v_mul_f32 v104, v104, v17
  v_mul_f32 v105, v105, v17
  v_mul_f32 v106, v106, v17
  v_mul_f32 v107, v107, v17
  v_mul_f32 v108, v108, v17
  v_mul_f32 v109, v109, v17
  v_mul_f32 v110, v110, v17
  v_mul_f32 v111, v111, v17
  v_accvgpr_write_b32 a16, v104
  v_accvgpr_write_b32 a17, v105
  v_accvgpr_write_b32 a18, v106
  v_accvgpr_write_b32 a19, v107
  v_accvgpr_write_b32 a20, v108
  v_accvgpr_write_b32 a21, v109
  v_accvgpr_write_b32 a22, v110
  v_accvgpr_write_b32 a23, v111
  v_accvgpr_read_b32 v104, a24
  v_accvgpr_read_b32 v105, a25
  v_accvgpr_read_b32 v106, a26
  v_accvgpr_read_b32 v107, a27
  v_accvgpr_read_b32 v108, a28
  v_accvgpr_read_b32 v109, a29
  v_accvgpr_read_b32 v110, a30
  v_accvgpr_read_b32 v111, a31
  v_mul_f32 v104, v104, v17
  v_mul_f32 v105, v105, v17
  v_mul_f32 v106, v106, v17
  v_mul_f32 v107, v107, v17
  v_mul_f32 v108, v108, v17
  v_mul_f32 v109, v109, v17
  v_mul_f32 v110, v110, v17
  v_mul_f32 v111, v111, v17
  v_accvgpr_write_b32 a24, v104
  v_accvgpr_write_b32 a25, v105
  v_accvgpr_write_b32 a26, v106
  v_accvgpr_write_b32 a27, v107
  v_accvgpr_write_b32 a28, v108
  v_accvgpr_write_b32 a29, v109
  v_accvgpr_write_b32 a30, v110
  v_accvgpr_write_b32 a31, v111
  v_accvgpr_read_b32 v104, a32
  v_accvgpr_read_b32 v105, a33
  v_accvgpr_read_b32 v106, a34
  v_accvgpr_read_b32 v107, a35
  v_accvgpr_read_b32 v108, a36
  v_accvgpr_read_b32 v109, a37
  v_accvgpr_read_b32 v110, a38
  v_accvgpr_read_b32 v111, a39
  v_mul_f32 v104, v104, v17
  v_mul_f32 v105, v105, v17
  v_mul_f32 v106, v106, v17
  v_mul_f32 v107, v107, v17
  v_mul_f32 v108, v108, v17
  v_mul_f32 v109, v109, v17
  v_mul_f32 v110, v110, v17
  v_mul_f32 v111, v111, v17
  v_accvgpr_write_b32 a32, v104
  v_accvgpr_write_b32 a33, v105
  v_accvgpr_write_b32 a34, v106
  v_accvgpr_write_b32 a35, v107
  v_accvgpr_write_b32 a36, v108
  v_accvgpr_write_b32 a37, v109
  v_accvgpr_write_b32 a38, v110
  v_accvgpr_write_b32 a39, v111
  v_accvgpr_read_b32 v104, a40
  v_accvgpr_read_b32 v105, a41
  v_accvgpr_read_b32 v106, a42
  v_accvgpr_read_b32 v107, a43
  v_accvgpr_read_b32 v108, a44
  v_accvgpr_read_b32 v109, a45
  v_accvgpr_read_b32 v110, a46
  v_accvgpr_read_b32 v111, a47
  v_mul_f32 v104, v104, v17
  v_mul_f32 v105, v105, v17
  v_mul_f32 v106, v106, v17
  v_mul_f32 v107, v107, v17
  v_mul_f32 v108, v108, v17
  v_mul_f32 v109, v109, v17
  v_mul_f32 v110, v110, v17
  v_mul_f32 v111, v111, v17
  v_accvgpr_write_b32 a40, v104
  v_accvgpr_write_b32 a41, v105
  v_accvgpr_write_b32 a42, v106
  v_accvgpr_write_b32 a43, v107
  v_accvgpr_write_b32 a44, v108
  v_accvgpr_write_b32 a45, v109
  v_accvgpr_write_b32 a46, v110
  v_accvgpr_write_b32 a47, v111
  v_accvgpr_read_b32 v104, a48
  v_accvgpr_read_b32 v105, a49
  v_accvgpr_read_b32 v106, a50
  v_accvgpr_read_b32 v107, a51
  v_accvgpr_read_b32 v108, a52
  v_accvgpr_read_b32 v109, a53
  v_accvgpr_read_b32 v110, a54
  v_accvgpr_read_b32 v111, a55
  v_mul_f32 v104, v104, v17
  v_mul_f32 v105, v105, v17
  v_mul_f32 v106, v106, v17
  v_mul_f32 v107, v107, v17
  v_mul_f32 v108, v108, v17
  v_mul_f32 v109, v109, v17
  v_mul_f32 v110, v110, v17
  v_mul_f32 v111, v111, v17
  v_accvgpr_write_b32 a48, v104
  v_accvgpr_write_b32 a49, v105
  v_accvgpr_write_b32 a50, v106
  v_accvgpr_write_b32 a51, v107
  v_accvgpr_write_b32 a52, v108
  v_accvgpr_write_b32 a53, v109
  v_accvgpr_write_b32 a54, v110
  v_accvgpr_write_b32 a55, v111
  v_accvgpr_read_b32 v104, a56
  v_accvgpr_read_b32 v105, a57
  v_accvgpr_read_b32 v106, a58
  v_accvgpr_read_b32 v107, a59
  v_accvgpr_read_b32 v108, a60
  v_accvgpr_read_b32 v109, a61
  v_accvgpr_read_b32 v110, a62
  v_accvgpr_read_b32 v111, a63
  v_mul_f32 v104, v104, v17
  v_mul_f32 v105, v105, v17
  v_mul_f32 v106, v106, v17
  v_mul_f32 v107, v107, v17
  v_mul_f32 v108, v108, v17
  v_mul_f32 v109, v109, v17
  v_mul_f32 v110, v110, v17
  v_mul_f32 v111, v111, v17
  v_accvgpr_write_b32 a56, v104
  v_accvgpr_write_b32 a57, v105
  v_accvgpr_write_b32 a58, v106
  v_accvgpr_write_b32 a59, v107
  v_accvgpr_write_b32 a60, v108
  v_accvgpr_write_b32 a61, v109
  v_accvgpr_write_b32 a62, v110
  v_accvgpr_write_b32 a63, v111
  v_exp_f32 v96, v48
  v_exp_f32 v97, v49
  v_exp_f32 v98, v50
  v_exp_f32 v99, v51
  v_mov_b32 v15, v96
  v_mov_b32 v16, v97
  v_cvt_pk_bf16_f32 v88, v96, v97
  v_exp_f32 v100, v52
  v_exp_f32 v101, v53
  v_add_f32 v15, v15, v98
  v_add_f32 v16, v16, v99
  v_cvt_pk_bf16_f32 v89, v98, v99
  v_exp_f32 v102, v54
  v_exp_f32 v103, v55
  v_add_f32 v15, v15, v100
  v_add_f32 v16, v16, v101
  v_cvt_pk_bf16_f32 v90, v100, v101
  v_exp_f32 v96, v56
  v_exp_f32 v97, v57
  v_add_f32 v15, v15, v102
  v_add_f32 v16, v16, v103
  v_cvt_pk_bf16_f32 v91, v102, v103
  v_exp_f32 v98, v58
  v_exp_f32 v99, v59
  v_add_f32 v15, v15, v96
  v_add_f32 v16, v16, v97
  v_cvt_pk_bf16_f32 v92, v96, v97
  v_exp_f32 v100, v60
  v_exp_f32 v101, v61
  v_add_f32 v15, v15, v98
  v_add_f32 v16, v16, v99
  v_cvt_pk_bf16_f32 v93, v98, v99
  v_exp_f32 v102, v62
  v_exp_f32 v103, v63
  v_add_f32 v15, v15, v100
  v_add_f32 v16, v16, v101
  v_cvt_pk_bf16_f32 v94, v100, v101
  v_add_f32 v15, v15, v102
  v_add_f32 v16, v16, v103
  v_cvt_pk_bf16_f32 v95, v102, v103
  v_add_f32 v15, v15, v16
  s_nop 3
  s_branch A_RET53
A_SLOW55:
  s_nop 15
  s_nop 3
  v_max3_f32 v5, v32, v33, v34
  v_max3_f32 v5, v5, v35, v36
  v_max3_f32 v5, v5, v37, v38
  v_max3_f32 v5, v5, v39, v40
  v_max3_f32 v5, v5, v41, v42
  v_max3_f32 v5, v5, v43, v44
  v_max3_f32 v5, v5, v45, v46
  v_max_f32 v5, v5, v47
  v_mov_b32 v6, v5
  s_nop 1
  v_permlane32_swap_b32 v5, v6
  v_max_f32 v5, v5, v6
  v_add_f32 v5, 0x42200000, v5
  v_max_f32 v18, 0, v5
  v_exp_f32 v17, -v18
  v_sub_f32 v64, v64, v18
  v_sub_f32 v32, v32, v18
  v_sub_f32 v48, v48, v18
  v_sub_f32 v65, v65, v18
  v_sub_f32 v33, v33, v18
  v_sub_f32 v49, v49, v18
  v_sub_f32 v66, v66, v18
  v_sub_f32 v34, v34, v18
  v_sub_f32 v50, v50, v18
  v_sub_f32 v67, v67, v18
  v_sub_f32 v35, v35, v18
  v_sub_f32 v51, v51, v18
  v_sub_f32 v68, v68, v18
  v_sub_f32 v36, v36, v18
  v_sub_f32 v52, v52, v18
  v_sub_f32 v69, v69, v18
  v_sub_f32 v37, v37, v18
  v_sub_f32 v53, v53, v18
  v_sub_f32 v70, v70, v18
  v_sub_f32 v38, v38, v18
  v_sub_f32 v54, v54, v18
  v_sub_f32 v71, v71, v18
  v_sub_f32 v39, v39, v18
  v_sub_f32 v55, v55, v18
  v_sub_f32 v72, v72, v18
  v_sub_f32 v40, v40, v18
  v_sub_f32 v56, v56, v18
  v_sub_f32 v73, v73, v18
  v_sub_f32 v41, v41, v18
  v_sub_f32 v57, v57, v18
  v_sub_f32 v74, v74, v18
  v_sub_f32 v42, v42, v18
  v_sub_f32 v58, v58, v18
  v_sub_f32 v75, v75, v18
  v_sub_f32 v43, v43, v18
  v_sub_f32 v59, v59, v18
  v_sub_f32 v76, v76, v18
  v_sub_f32 v44, v44, v18
  v_sub_f32 v60, v60, v18
  v_sub_f32 v77, v77, v18
  v_sub_f32 v45, v45, v18
  v_sub_f32 v61, v61, v18
  v_sub_f32 v78, v78, v18
  v_sub_f32 v46, v46, v18
  v_sub_f32 v62, v62, v18
  v_sub_f32 v79, v79, v18
  v_sub_f32 v47, v47, v18
  v_sub_f32 v63, v63, v18
  v_mul_f32 v10, v10, v17
  v_accvgpr_read_b32 v104, a0
  v_accvgpr_read_b32 v105, a1
  v_accvgpr_read_b32 v106, a2
  v_accvgpr_read_b32 v107, a3
  v_accvgpr_read_b32 v108, a4
  v_accvgpr_read_b32 v109, a5
  v_accvgpr_read_b32 v110, a6
  v_accvgpr_read_b32 v111, a7
  v_mul_f32 v104, v104, v17
  v_mul_f32 v105, v105, v17
  v_mul_f32 v106, v106, v17
  v_mul_f32 v107, v107, v17
  v_mul_f32 v108, v108, v17
  v_mul_f32 v109, v109, v17
  v_mul_f32 v110, v110, v17
  v_mul_f32 v111, v111, v17
  v_accvgpr_write_b32 a0, v104
  v_accvgpr_write_b32 a1, v105
  v_accvgpr_write_b32 a2, v106
  v_accvgpr_write_b32 a3, v107
  v_accvgpr_write_b32 a4, v108
  v_accvgpr_write_b32 a5, v109
  v_accvgpr_write_b32 a6, v110
  v_accvgpr_write_b32 a7, v111
  v_accvgpr_read_b32 v104, a8
  v_accvgpr_read_b32 v105, a9
  v_accvgpr_read_b32 v106, a10
  v_accvgpr_read_b32 v107, a11
  v_accvgpr_read_b32 v108, a12
  v_accvgpr_read_b32 v109, a13
  v_accvgpr_read_b32 v110, a14
  v_accvgpr_read_b32 v111, a15
  v_mul_f32 v104, v104, v17
  v_mul_f32 v105, v105, v17
  v_mul_f32 v106, v106, v17
  v_mul_f32 v107, v107, v17
  v_mul_f32 v108, v108, v17
  v_mul_f32 v109, v109, v17
  v_mul_f32 v110, v110, v17
  v_mul_f32 v111, v111, v17
  v_accvgpr_write_b32 a8, v104
  v_accvgpr_write_b32 a9, v105
  v_accvgpr_write_b32 a10, v106
  v_accvgpr_write_b32 a11, v107
  v_accvgpr_write_b32 a12, v108
  v_accvgpr_write_b32 a13, v109
  v_accvgpr_write_b32 a14, v110
  v_accvgpr_write_b32 a15, v111
  v_accvgpr_read_b32 v104, a16
  v_accvgpr_read_b32 v105, a17
  v_accvgpr_read_b32 v106, a18
  v_accvgpr_read_b32 v107, a19
  v_accvgpr_read_b32 v108, a20
  v_accvgpr_read_b32 v109, a21
  v_accvgpr_read_b32 v110, a22
  v_accvgpr_read_b32 v111, a23
  v_mul_f32 v104, v104, v17
  v_mul_f32 v105, v105, v17
  v_mul_f32 v106, v106, v17
  v_mul_f32 v107, v107, v17
  v_mul_f32 v108, v108, v17
  v_mul_f32 v109, v109, v17
  v_mul_f32 v110, v110, v17
  v_mul_f32 v111, v111, v17
  v_accvgpr_write_b32 a16, v104
  v_accvgpr_write_b32 a17, v105
  v_accvgpr_write_b32 a18, v106
  v_accvgpr_write_b32 a19, v107
  v_accvgpr_write_b32 a20, v108
  v_accvgpr_write_b32 a21, v109
  v_accvgpr_write_b32 a22, v110
  v_accvgpr_write_b32 a23, v111
  v_accvgpr_read_b32 v104, a24
  v_accvgpr_read_b32 v105, a25
  v_accvgpr_read_b32 v106, a26
  v_accvgpr_read_b32 v107, a27
  v_accvgpr_read_b32 v108, a28
  v_accvgpr_read_b32 v109, a29
  v_accvgpr_read_b32 v110, a30
  v_accvgpr_read_b32 v111, a31
  v_mul_f32 v104, v104, v17
  v_mul_f32 v105, v105, v17
  v_mul_f32 v106, v106, v17
  v_mul_f32 v107, v107, v17
  v_mul_f32 v108, v108, v17
  v_mul_f32 v109, v109, v17
  v_mul_f32 v110, v110, v17
  v_mul_f32 v111, v111, v17
  v_accvgpr_write_b32 a24, v104
  v_accvgpr_write_b32 a25, v105
  v_accvgpr_write_b32 a26, v106
  v_accvgpr_write_b32 a27, v107
  v_accvgpr_write_b32 a28, v108
  v_accvgpr_write_b32 a29, v109
  v_accvgpr_write_b32 a30, v110
  v_accvgpr_write_b32 a31, v111
  v_accvgpr_read_b32 v104, a32
  v_accvgpr_read_b32 v105, a33
  v_accvgpr_read_b32 v106, a34
  v_accvgpr_read_b32 v107, a35
  v_accvgpr_read_b32 v108, a36
  v_accvgpr_read_b32 v109, a37
  v_accvgpr_read_b32 v110, a38
  v_accvgpr_read_b32 v111, a39
  v_mul_f32 v104, v104, v17
  v_mul_f32 v105, v105, v17
  v_mul_f32 v106, v106, v17
  v_mul_f32 v107, v107, v17
  v_mul_f32 v108, v108, v17
  v_mul_f32 v109, v109, v17
  v_mul_f32 v110, v110, v17
  v_mul_f32 v111, v111, v17
  v_accvgpr_write_b32 a32, v104
  v_accvgpr_write_b32 a33, v105
  v_accvgpr_write_b32 a34, v106
  v_accvgpr_write_b32 a35, v107
  v_accvgpr_write_b32 a36, v108
  v_accvgpr_write_b32 a37, v109
  v_accvgpr_write_b32 a38, v110
  v_accvgpr_write_b32 a39, v111
  v_accvgpr_read_b32 v104, a40
  v_accvgpr_read_b32 v105, a41
  v_accvgpr_read_b32 v106, a42
  v_accvgpr_read_b32 v107, a43
  v_accvgpr_read_b32 v108, a44
  v_accvgpr_read_b32 v109, a45
  v_accvgpr_read_b32 v110, a46
  v_accvgpr_read_b32 v111, a47
  v_mul_f32 v104, v104, v17
  v_mul_f32 v105, v105, v17
  v_mul_f32 v106, v106, v17
  v_mul_f32 v107, v107, v17
  v_mul_f32 v108, v108, v17
  v_mul_f32 v109, v109, v17
  v_mul_f32 v110, v110, v17
  v_mul_f32 v111, v111, v17
  v_accvgpr_write_b32 a40, v104
  v_accvgpr_write_b32 a41, v105
  v_accvgpr_write_b32 a42, v106
  v_accvgpr_write_b32 a43, v107
  v_accvgpr_write_b32 a44, v108
  v_accvgpr_write_b32 a45, v109
  v_accvgpr_write_b32 a46, v110
  v_accvgpr_write_b32 a47, v111
  v_accvgpr_read_b32 v104, a48
  v_accvgpr_read_b32 v105, a49
  v_accvgpr_read_b32 v106, a50
  v_accvgpr_read_b32 v107, a51
  v_accvgpr_read_b32 v108, a52
  v_accvgpr_read_b32 v109, a53
  v_accvgpr_read_b32 v110, a54
  v_accvgpr_read_b32 v111, a55
  v_mul_f32 v104, v104, v17
  v_mul_f32 v105, v105, v17
  v_mul_f32 v106, v106, v17
  v_mul_f32 v107, v107, v17
  v_mul_f32 v108, v108, v17
  v_mul_f32 v109, v109, v17
  v_mul_f32 v110, v110, v17
  v_mul_f32 v111, v111, v17
  v_accvgpr_write_b32 a48, v104
  v_accvgpr_write_b32 a49, v105
  v_accvgpr_write_b32 a50, v106
  v_accvgpr_write_b32 a51, v107
  v_accvgpr_write_b32 a52, v108
  v_accvgpr_write_b32 a53, v109
  v_accvgpr_write_b32 a54, v110
  v_accvgpr_write_b32 a55, v111
  v_accvgpr_read_b32 v104, a56
  v_accvgpr_read_b32 v105, a57
  v_accvgpr_read_b32 v106, a58
  v_accvgpr_read_b32 v107, a59
  v_accvgpr_read_b32 v108, a60
  v_accvgpr_read_b32 v109, a61
  v_accvgpr_read_b32 v110, a62
  v_accvgpr_read_b32 v111, a63
  v_mul_f32 v104, v104, v17
  v_mul_f32 v105, v105, v17
  v_mul_f32 v106, v106, v17
  v_mul_f32 v107, v107, v17
  v_mul_f32 v108, v108, v17
  v_mul_f32 v109, v109, v17
  v_mul_f32 v110, v110, v17
  v_mul_f32 v111, v111, v17
  v_accvgpr_write_b32 a56, v104
  v_accvgpr_write_b32 a57, v105
  v_accvgpr_write_b32 a58, v106
  v_accvgpr_write_b32 a59, v107
  v_accvgpr_write_b32 a60, v108
  v_accvgpr_write_b32 a61, v109
  v_accvgpr_write_b32 a62, v110
  v_accvgpr_write_b32 a63, v111
  v_exp_f32 v96, v32
  v_exp_f32 v97, v33
  v_exp_f32 v98, v34
  v_exp_f32 v99, v35
  v_mov_b32 v15, v96
  v_mov_b32 v16, v97
  v_cvt_pk_bf16_f32 v80, v96, v97
  v_exp_f32 v100, v36
  v_exp_f32 v101, v37
  v_add_f32 v15, v15, v98
  v_add_f32 v16, v16, v99
  v_cvt_pk_bf16_f32 v81, v98, v99
  v_exp_f32 v102, v38
  v_exp_f32 v103, v39
  v_add_f32 v15, v15, v100
  v_add_f32 v16, v16, v101
  v_cvt_pk_bf16_f32 v82, v100, v101
  v_exp_f32 v96, v40
  v_exp_f32 v97, v41
  v_add_f32 v15, v15, v102
  v_add_f32 v16, v16, v103
  v_cvt_pk_bf16_f32 v83, v102, v103
  v_exp_f32 v98, v42
  v_exp_f32 v99, v43
  v_add_f32 v15, v15, v96
  v_add_f32 v16, v16, v97
  v_cvt_pk_bf16_f32 v84, v96, v97
  v_exp_f32 v100, v44
  v_exp_f32 v101, v45
  v_add_f32 v15, v15, v98
  v_add_f32 v16, v16, v99
  v_cvt_pk_bf16_f32 v85, v98, v99
  v_exp_f32 v102, v46
  v_exp_f32 v103, v47
  v_add_f32 v15, v15, v100
  v_add_f32 v16, v16, v101
  v_cvt_pk_bf16_f32 v86, v100, v101
  v_add_f32 v15, v15, v102
  v_add_f32 v16, v16, v103
  v_cvt_pk_bf16_f32 v87, v102, v103
  v_add_f32 v15, v15, v16
  s_nop 3
  s_branch A_RET56
A_SLOW57:
  s_nop 15
  s_nop 3
  v_max3_f32 v5, v48, v49, v50
  v_max3_f32 v5, v5, v51, v52
  v_max3_f32 v5, v5, v53, v54
  v_max3_f32 v5, v5, v55, v56
  v_max3_f32 v5, v5, v57, v58
  v_max3_f32 v5, v5, v59, v60
  v_max3_f32 v5, v5, v61, v62
  v_max_f32 v5, v5, v63
  v_mov_b32 v6, v5
  s_nop 1
  v_permlane32_swap_b32 v5, v6
  v_max_f32 v5, v5, v6
  v_add_f32 v5, 0x42200000, v5
  v_max_f32 v18, 0, v5
  v_exp_f32 v17, -v18
  v_sub_f32 v64, v64, v18
  v_sub_f32 v48, v48, v18
  v_sub_f32 v32, v32, v18
  v_sub_f32 v65, v65, v18
  v_sub_f32 v49, v49, v18
  v_sub_f32 v33, v33, v18
  v_sub_f32 v66, v66, v18
  v_sub_f32 v50, v50, v18
  v_sub_f32 v34, v34, v18
  v_sub_f32 v67, v67, v18
  v_sub_f32 v51, v51, v18
  v_sub_f32 v35, v35, v18
  v_sub_f32 v68, v68, v18
  v_sub_f32 v52, v52, v18
  v_sub_f32 v36, v36, v18
  v_sub_f32 v69, v69, v18
  v_sub_f32 v53, v53, v18
  v_sub_f32 v37, v37, v18
  v_sub_f32 v70, v70, v18
  v_sub_f32 v54, v54, v18
  v_sub_f32 v38, v38, v18
  v_sub_f32 v71, v71, v18
  v_sub_f32 v55, v55, v18
  v_sub_f32 v39, v39, v18
  v_sub_f32 v72, v72, v18
  v_sub_f32 v56, v56, v18
  v_sub_f32 v40, v40, v18
  v_sub_f32 v73, v73, v18
  v_sub_f32 v57, v57, v18
  v_sub_f32 v41, v41, v18
  v_sub_f32 v74, v74, v18
  v_sub_f32 v58, v58, v18
  v_sub_f32 v42, v42, v18
  v_sub_f32 v75, v75, v18
  v_sub_f32 v59, v59, v18
  v_sub_f32 v43, v43, v18
  v_sub_f32 v76, v76, v18
  v_sub_f32 v60, v60, v18
  v_sub_f32 v44, v44, v18
  v_sub_f32 v77, v77, v18
  v_sub_f32 v61, v61, v18
  v_sub_f32 v45, v45, v18
  v_sub_f32 v78, v78, v18
  v_sub_f32 v62, v62, v18
  v_sub_f32 v46, v46, v18
  v_sub_f32 v79, v79, v18
  v_sub_f32 v63, v63, v18
  v_sub_f32 v47, v47, v18
  v_mul_f32 v10, v10, v17
  v_accvgpr_read_b32 v104, a0
  v_accvgpr_read_b32 v105, a1
  v_accvgpr_read_b32 v106, a2
  v_accvgpr_read_b32 v107, a3
  v_accvgpr_read_b32 v108, a4
  v_accvgpr_read_b32 v109, a5
  v_accvgpr_read_b32 v110, a6
  v_accvgpr_read_b32 v111, a7
  v_mul_f32 v104, v104, v17
  v_mul_f32 v105, v105, v17
  v_mul_f32 v106, v106, v17
  v_mul_f32 v107, v107, v17
  v_mul_f32 v108, v108, v17
  v_mul_f32 v109, v109, v17
  v_mul_f32 v110, v110, v17
  v_mul_f32 v111, v111, v17
  v_accvgpr_write_b32 a0, v104
  v_accvgpr_write_b32 a1, v105
  v_accvgpr_write_b32 a2, v106
  v_accvgpr_write_b32 a3, v107
  v_accvgpr_write_b32 a4, v108
  v_accvgpr_write_b32 a5, v109
  v_accvgpr_write_b32 a6, v110
  v_accvgpr_write_b32 a7, v111
  v_accvgpr_read_b32 v104, a8
  v_accvgpr_read_b32 v105, a9
  v_accvgpr_read_b32 v106, a10
  v_accvgpr_read_b32 v107, a11
  v_accvgpr_read_b32 v108, a12
  v_accvgpr_read_b32 v109, a13
  v_accvgpr_read_b32 v110, a14
  v_accvgpr_read_b32 v111, a15
  v_mul_f32 v104, v104, v17
  v_mul_f32 v105, v105, v17
  v_mul_f32 v106, v106, v17
  v_mul_f32 v107, v107, v17
  v_mul_f32 v108, v108, v17
  v_mul_f32 v109, v109, v17
  v_mul_f32 v110, v110, v17
  v_mul_f32 v111, v111, v17
  v_accvgpr_write_b32 a8, v104
  v_accvgpr_write_b32 a9, v105
  v_accvgpr_write_b32 a10, v106
  v_accvgpr_write_b32 a11, v107
  v_accvgpr_write_b32 a12, v108
  v_accvgpr_write_b32 a13, v109
  v_accvgpr_write_b32 a14, v110
  v_accvgpr_write_b32 a15, v111
  v_accvgpr_read_b32 v104, a16
  v_accvgpr_read_b32 v105, a17
  v_accvgpr_read_b32 v106, a18
  v_accvgpr_read_b32 v107, a19
  v_accvgpr_read_b32 v108, a20
  v_accvgpr_read_b32 v109, a21
  v_accvgpr_read_b32 v110, a22
  v_accvgpr_read_b32 v111, a23
  v_mul_f32 v104, v104, v17
  v_mul_f32 v105, v105, v17
  v_mul_f32 v106, v106, v17
  v_mul_f32 v107, v107, v17
  v_mul_f32 v108, v108, v17
  v_mul_f32 v109, v109, v17
  v_mul_f32 v110, v110, v17
  v_mul_f32 v111, v111, v17
  v_accvgpr_write_b32 a16, v104
  v_accvgpr_write_b32 a17, v105
  v_accvgpr_write_b32 a18, v106
  v_accvgpr_write_b32 a19, v107
  v_accvgpr_write_b32 a20, v108
  v_accvgpr_write_b32 a21, v109
  v_accvgpr_write_b32 a22, v110
  v_accvgpr_write_b32 a23, v111
  v_accvgpr_read_b32 v104, a24
  v_accvgpr_read_b32 v105, a25
  v_accvgpr_read_b32 v106, a26
  v_accvgpr_read_b32 v107, a27
  v_accvgpr_read_b32 v108, a28
  v_accvgpr_read_b32 v109, a29
  v_accvgpr_read_b32 v110, a30
  v_accvgpr_read_b32 v111, a31
  v_mul_f32 v104, v104, v17
  v_mul_f32 v105, v105, v17
  v_mul_f32 v106, v106, v17
  v_mul_f32 v107, v107, v17
  v_mul_f32 v108, v108, v17
  v_mul_f32 v109, v109, v17
  v_mul_f32 v110, v110, v17
  v_mul_f32 v111, v111, v17
  v_accvgpr_write_b32 a24, v104
  v_accvgpr_write_b32 a25, v105
  v_accvgpr_write_b32 a26, v106
  v_accvgpr_write_b32 a27, v107
  v_accvgpr_write_b32 a28, v108
  v_accvgpr_write_b32 a29, v109
  v_accvgpr_write_b32 a30, v110
  v_accvgpr_write_b32 a31, v111
  v_accvgpr_read_b32 v104, a32
  v_accvgpr_read_b32 v105, a33
  v_accvgpr_read_b32 v106, a34
  v_accvgpr_read_b32 v107, a35
  v_accvgpr_read_b32 v108, a36
  v_accvgpr_read_b32 v109, a37
  v_accvgpr_read_b32 v110, a38
  v_accvgpr_read_b32 v111, a39
  v_mul_f32 v104, v104, v17
  v_mul_f32 v105, v105, v17
  v_mul_f32 v106, v106, v17
  v_mul_f32 v107, v107, v17
  v_mul_f32 v108, v108, v17
  v_mul_f32 v109, v109, v17
  v_mul_f32 v110, v110, v17
  v_mul_f32 v111, v111, v17
  v_accvgpr_write_b32 a32, v104
  v_accvgpr_write_b32 a33, v105
  v_accvgpr_write_b32 a34, v106
  v_accvgpr_write_b32 a35, v107
  v_accvgpr_write_b32 a36, v108
  v_accvgpr_write_b32 a37, v109
  v_accvgpr_write_b32 a38, v110
  v_accvgpr_write_b32 a39, v111
  v_accvgpr_read_b32 v104, a40
  v_accvgpr_read_b32 v105, a41
  v_accvgpr_read_b32 v106, a42
  v_accvgpr_read_b32 v107, a43
  v_accvgpr_read_b32 v108, a44
  v_accvgpr_read_b32 v109, a45
  v_accvgpr_read_b32 v110, a46
  v_accvgpr_read_b32 v111, a47
  v_mul_f32 v104, v104, v17
  v_mul_f32 v105, v105, v17
  v_mul_f32 v106, v106, v17
  v_mul_f32 v107, v107, v17
  v_mul_f32 v108, v108, v17
  v_mul_f32 v109, v109, v17
  v_mul_f32 v110, v110, v17
  v_mul_f32 v111, v111, v17
  v_accvgpr_write_b32 a40, v104
  v_accvgpr_write_b32 a41, v105
  v_accvgpr_write_b32 a42, v106
  v_accvgpr_write_b32 a43, v107
  v_accvgpr_write_b32 a44, v108
  v_accvgpr_write_b32 a45, v109
  v_accvgpr_write_b32 a46, v110
  v_accvgpr_write_b32 a47, v111
  v_accvgpr_read_b32 v104, a48
  v_accvgpr_read_b32 v105, a49
  v_accvgpr_read_b32 v106, a50
  v_accvgpr_read_b32 v107, a51
  v_accvgpr_read_b32 v108, a52
  v_accvgpr_read_b32 v109, a53
  v_accvgpr_read_b32 v110, a54
  v_accvgpr_read_b32 v111, a55
  v_mul_f32 v104, v104, v17
  v_mul_f32 v105, v105, v17
  v_mul_f32 v106, v106, v17
  v_mul_f32 v107, v107, v17
  v_mul_f32 v108, v108, v17
  v_mul_f32 v109, v109, v17
  v_mul_f32 v110, v110, v17
  v_mul_f32 v111, v111, v17
  v_accvgpr_write_b32 a48, v104
  v_accvgpr_write_b32 a49, v105
  v_accvgpr_write_b32 a50, v106
  v_accvgpr_write_b32 a51, v107
  v_accvgpr_write_b32 a52, v108
  v_accvgpr_write_b32 a53, v109
  v_accvgpr_write_b32 a54, v110
  v_accvgpr_write_b32 a55, v111
  v_accvgpr_read_b32 v104, a56
  v_accvgpr_read_b32 v105, a57
  v_accvgpr_read_b32 v106, a58
  v_accvgpr_read_b32 v107, a59
  v_accvgpr_read_b32 v108, a60
  v_accvgpr_read_b32 v109, a61
  v_accvgpr_read_b32 v110, a62
  v_accvgpr_read_b32 v111, a63
  v_mul_f32 v104, v104, v17
  v_mul_f32 v105, v105, v17
  v_mul_f32 v106, v106, v17
  v_mul_f32 v107, v107, v17
  v_mul_f32 v108, v108, v17
  v_mul_f32 v109, v109, v17
  v_mul_f32 v110, v110, v17
  v_mul_f32 v111, v111, v17
  v_accvgpr_write_b32 a56, v104
  v_accvgpr_write_b32 a57, v105
  v_accvgpr_write_b32 a58, v106
  v_accvgpr_write_b32 a59, v107
  v_accvgpr_write_b32 a60, v108
  v_accvgpr_write_b32 a61, v109
  v_accvgpr_write_b32 a62, v110
  v_accvgpr_write_b32 a63, v111
  v_exp_f32 v96, v48
  v_exp_f32 v97, v49
  v_exp_f32 v98, v50
  v_exp_f32 v99, v51
  v_mov_b32 v15, v96
  v_mov_b32 v16, v97
  v_cvt_pk_bf16_f32 v88, v96, v97
  v_exp_f32 v100, v52
  v_exp_f32 v101, v53
  v_add_f32 v15, v15, v98
  v_add_f32 v16, v16, v99
  v_cvt_pk_bf16_f32 v89, v98, v99
  v_exp_f32 v102, v54
  v_exp_f32 v103, v55
  v_add_f32 v15, v15, v100
  v_add_f32 v16, v16, v101
  v_cvt_pk_bf16_f32 v90, v100, v101
  v_exp_f32 v96, v56
  v_exp_f32 v97, v57
  v_add_f32 v15, v15, v102
  v_add_f32 v16, v16, v103
  v_cvt_pk_bf16_f32 v91, v102, v103
  v_exp_f32 v98, v58
  v_exp_f32 v99, v59
  v_add_f32 v15, v15, v96
  v_add_f32 v16, v16, v97
  v_cvt_pk_bf16_f32 v92, v96, v97
  v_exp_f32 v100, v60
  v_exp_f32 v101, v61
  v_add_f32 v15, v15, v98
  v_add_f32 v16, v16, v99
  v_cvt_pk_bf16_f32 v93, v98, v99
  v_exp_f32 v102, v62
  v_exp_f32 v103, v63
  v_add_f32 v15, v15, v100
  v_add_f32 v16, v16, v101
  v_cvt_pk_bf16_f32 v94, v100, v101
  v_add_f32 v15, v15, v102
  v_add_f32 v16, v16, v103
  v_cvt_pk_bf16_f32 v95, v102, v103
  v_add_f32 v15, v15, v16
  s_nop 3
  s_branch A_RET58
A_SLOW60:
  s_nop 15
  s_nop 3
  v_max3_f32 v5, v32, v33, v34
  v_max3_f32 v5, v5, v35, v36
  v_max3_f32 v5, v5, v37, v38
  v_max3_f32 v5, v5, v39, v40
  v_max3_f32 v5, v5, v41, v42
  v_max3_f32 v5, v5, v43, v44
  v_max3_f32 v5, v5, v45, v46
  v_max_f32 v5, v5, v47
  v_mov_b32 v6, v5
  s_nop 1
  v_permlane32_swap_b32 v5, v6
  v_max_f32 v5, v5, v6
  v_add_f32 v5, 0x42200000, v5
  v_max_f32 v18, 0, v5
  v_exp_f32 v17, -v18
  v_sub_f32 v64, v64, v18
  v_sub_f32 v32, v32, v18
  v_sub_f32 v48, v48, v18
  v_sub_f32 v65, v65, v18
  v_sub_f32 v33, v33, v18
  v_sub_f32 v49, v49, v18
  v_sub_f32 v66, v66, v18
  v_sub_f32 v34, v34, v18
  v_sub_f32 v50, v50, v18
  v_sub_f32 v67, v67, v18
  v_sub_f32 v35, v35, v18
  v_sub_f32 v51, v51, v18
  v_sub_f32 v68, v68, v18
  v_sub_f32 v36, v36, v18
  v_sub_f32 v52, v52, v18
  v_sub_f32 v69, v69, v18
  v_sub_f32 v37, v37, v18
  v_sub_f32 v53, v53, v18
  v_sub_f32 v70, v70, v18
  v_sub_f32 v38, v38, v18
  v_sub_f32 v54, v54, v18
  v_sub_f32 v71, v71, v18
  v_sub_f32 v39, v39, v18
  v_sub_f32 v55, v55, v18
  v_sub_f32 v72, v72, v18
  v_sub_f32 v40, v40, v18
  v_sub_f32 v56, v56, v18
  v_sub_f32 v73, v73, v18
  v_sub_f32 v41, v41, v18
  v_sub_f32 v57, v57, v18
  v_sub_f32 v74, v74, v18
  v_sub_f32 v42, v42, v18
  v_sub_f32 v58, v58, v18
  v_sub_f32 v75, v75, v18
  v_sub_f32 v43, v43, v18
  v_sub_f32 v59, v59, v18
  v_sub_f32 v76, v76, v18
  v_sub_f32 v44, v44, v18
  v_sub_f32 v60, v60, v18
  v_sub_f32 v77, v77, v18
  v_sub_f32 v45, v45, v18
  v_sub_f32 v61, v61, v18
  v_sub_f32 v78, v78, v18
  v_sub_f32 v46, v46, v18
  v_sub_f32 v62, v62, v18
  v_sub_f32 v79, v79, v18
  v_sub_f32 v47, v47, v18
  v_sub_f32 v63, v63, v18
  v_mul_f32 v10, v10, v17
  v_accvgpr_read_b32 v104, a0
  v_accvgpr_read_b32 v105, a1
  v_accvgpr_read_b32 v106, a2
  v_accvgpr_read_b32 v107, a3
  v_accvgpr_read_b32 v108, a4
  v_accvgpr_read_b32 v109, a5
  v_accvgpr_read_b32 v110, a6
  v_accvgpr_read_b32 v111, a7
  v_mul_f32 v104, v104, v17
  v_mul_f32 v105, v105, v17
  v_mul_f32 v106, v106, v17
  v_mul_f32 v107, v107, v17
  v_mul_f32 v108, v108, v17
  v_mul_f32 v109, v109, v17
  v_mul_f32 v110, v110, v17
  v_mul_f32 v111, v111, v17
  v_accvgpr_write_b32 a0, v104
  v_accvgpr_write_b32 a1, v105
  v_accvgpr_write_b32 a2, v106
  v_accvgpr_write_b32 a3, v107
  v_accvgpr_write_b32 a4, v108
  v_accvgpr_write_b32 a5, v109
  v_accvgpr_write_b32 a6, v110
  v_accvgpr_write_b32 a7, v111
  v_accvgpr_read_b32 v104, a8
  v_accvgpr_read_b32 v105, a9
  v_accvgpr_read_b32 v106, a10
  v_accvgpr_read_b32 v107, a11
  v_accvgpr_read_b32 v108, a12
  v_accvgpr_read_b32 v109, a13
  v_accvgpr_read_b32 v110, a14
  v_accvgpr_read_b32 v111, a15
  v_mul_f32 v104, v104, v17
  v_mul_f32 v105, v105, v17
  v_mul_f32 v106, v106, v17
  v_mul_f32 v107, v107, v17
  v_mul_f32 v108, v108, v17
  v_mul_f32 v109, v109, v17
  v_mul_f32 v110, v110, v17
  v_mul_f32 v111, v111, v17
  v_accvgpr_write_b32 a8, v104
  v_accvgpr_write_b32 a9, v105
  v_accvgpr_write_b32 a10, v106
  v_accvgpr_write_b32 a11, v107
  v_accvgpr_write_b32 a12, v108
  v_accvgpr_write_b32 a13, v109
  v_accvgpr_write_b32 a14, v110
  v_accvgpr_write_b32 a15, v111
  v_accvgpr_read_b32 v104, a16
  v_accvgpr_read_b32 v105, a17
  v_accvgpr_read_b32 v106, a18
  v_accvgpr_read_b32 v107, a19
  v_accvgpr_read_b32 v108, a20
  v_accvgpr_read_b32 v109, a21
  v_accvgpr_read_b32 v110, a22
  v_accvgpr_read_b32 v111, a23
  v_mul_f32 v104, v104, v17
  v_mul_f32 v105, v105, v17
  v_mul_f32 v106, v106, v17
  v_mul_f32 v107, v107, v17
  v_mul_f32 v108, v108, v17
  v_mul_f32 v109, v109, v17
  v_mul_f32 v110, v110, v17
  v_mul_f32 v111, v111, v17
  v_accvgpr_write_b32 a16, v104
  v_accvgpr_write_b32 a17, v105
  v_accvgpr_write_b32 a18, v106
  v_accvgpr_write_b32 a19, v107
  v_accvgpr_write_b32 a20, v108
  v_accvgpr_write_b32 a21, v109
  v_accvgpr_write_b32 a22, v110
  v_accvgpr_write_b32 a23, v111
  v_accvgpr_read_b32 v104, a24
  v_accvgpr_read_b32 v105, a25
  v_accvgpr_read_b32 v106, a26
  v_accvgpr_read_b32 v107, a27
  v_accvgpr_read_b32 v108, a28
  v_accvgpr_read_b32 v109, a29
  v_accvgpr_read_b32 v110, a30
  v_accvgpr_read_b32 v111, a31
  v_mul_f32 v104, v104, v17
  v_mul_f32 v105, v105, v17
  v_mul_f32 v106, v106, v17
  v_mul_f32 v107, v107, v17
  v_mul_f32 v108, v108, v17
  v_mul_f32 v109, v109, v17
  v_mul_f32 v110, v110, v17
  v_mul_f32 v111, v111, v17
  v_accvgpr_write_b32 a24, v104
  v_accvgpr_write_b32 a25, v105
  v_accvgpr_write_b32 a26, v106
  v_accvgpr_write_b32 a27, v107
  v_accvgpr_write_b32 a28, v108
  v_accvgpr_write_b32 a29, v109
  v_accvgpr_write_b32 a30, v110
  v_accvgpr_write_b32 a31, v111
  v_accvgpr_read_b32 v104, a32
  v_accvgpr_read_b32 v105, a33
  v_accvgpr_read_b32 v106, a34
  v_accvgpr_read_b32 v107, a35
  v_accvgpr_read_b32 v108, a36
  v_accvgpr_read_b32 v109, a37
  v_accvgpr_read_b32 v110, a38
  v_accvgpr_read_b32 v111, a39
  v_mul_f32 v104, v104, v17
  v_mul_f32 v105, v105, v17
  v_mul_f32 v106, v106, v17
  v_mul_f32 v107, v107, v17
  v_mul_f32 v108, v108, v17
  v_mul_f32 v109, v109, v17
  v_mul_f32 v110, v110, v17
  v_mul_f32 v111, v111, v17
  v_accvgpr_write_b32 a32, v104
  v_accvgpr_write_b32 a33, v105
  v_accvgpr_write_b32 a34, v106
  v_accvgpr_write_b32 a35, v107
  v_accvgpr_write_b32 a36, v108
  v_accvgpr_write_b32 a37, v109
  v_accvgpr_write_b32 a38, v110
  v_accvgpr_write_b32 a39, v111
  v_accvgpr_read_b32 v104, a40
  v_accvgpr_read_b32 v105, a41
  v_accvgpr_read_b32 v106, a42
  v_accvgpr_read_b32 v107, a43
  v_accvgpr_read_b32 v108, a44
  v_accvgpr_read_b32 v109, a45
  v_accvgpr_read_b32 v110, a46
  v_accvgpr_read_b32 v111, a47
  v_mul_f32 v104, v104, v17
  v_mul_f32 v105, v105, v17
  v_mul_f32 v106, v106, v17
  v_mul_f32 v107, v107, v17
  v_mul_f32 v108, v108, v17
  v_mul_f32 v109, v109, v17
  v_mul_f32 v110, v110, v17
  v_mul_f32 v111, v111, v17
  v_accvgpr_write_b32 a40, v104
  v_accvgpr_write_b32 a41, v105
  v_accvgpr_write_b32 a42, v106
  v_accvgpr_write_b32 a43, v107
  v_accvgpr_write_b32 a44, v108
  v_accvgpr_write_b32 a45, v109
  v_accvgpr_write_b32 a46, v110
  v_accvgpr_write_b32 a47, v111
  v_accvgpr_read_b32 v104, a48
  v_accvgpr_read_b32 v105, a49
  v_accvgpr_read_b32 v106, a50
  v_accvgpr_read_b32 v107, a51
  v_accvgpr_read_b32 v108, a52
  v_accvgpr_read_b32 v109, a53
  v_accvgpr_read_b32 v110, a54
  v_accvgpr_read_b32 v111, a55
  v_mul_f32 v104, v104, v17
  v_mul_f32 v105, v105, v17
  v_mul_f32 v106, v106, v17
  v_mul_f32 v107, v107, v17
  v_mul_f32 v108, v108, v17
  v_mul_f32 v109, v109, v17
  v_mul_f32 v110, v110, v17
  v_mul_f32 v111, v111, v17
  v_accvgpr_write_b32 a48, v104
  v_accvgpr_write_b32 a49, v105
  v_accvgpr_write_b32 a50, v106
  v_accvgpr_write_b32 a51, v107
  v_accvgpr_write_b32 a52, v108
  v_accvgpr_write_b32 a53, v109
  v_accvgpr_write_b32 a54, v110
  v_accvgpr_write_b32 a55, v111
  v_accvgpr_read_b32 v104, a56
  v_accvgpr_read_b32 v105, a57
  v_accvgpr_read_b32 v106, a58
  v_accvgpr_read_b32 v107, a59
  v_accvgpr_read_b32 v108, a60
  v_accvgpr_read_b32 v109, a61
  v_accvgpr_read_b32 v110, a62
  v_accvgpr_read_b32 v111, a63
  v_mul_f32 v104, v104, v17
  v_mul_f32 v105, v105, v17
  v_mul_f32 v106, v106, v17
  v_mul_f32 v107, v107, v17
  v_mul_f32 v108, v108, v17
  v_mul_f32 v109, v109, v17
  v_mul_f32 v110, v110, v17
  v_mul_f32 v111, v111, v17
  v_accvgpr_write_b32 a56, v104
  v_accvgpr_write_b32 a57, v105
  v_accvgpr_write_b32 a58, v106
  v_accvgpr_write_b32 a59, v107
  v_accvgpr_write_b32 a60, v108
  v_accvgpr_write_b32 a61, v109
  v_accvgpr_write_b32 a62, v110
  v_accvgpr_write_b32 a63, v111
  v_exp_f32 v96, v32
  v_exp_f32 v97, v33
  v_exp_f32 v98, v34
  v_exp_f32 v99, v35
  v_mov_b32 v15, v96
  v_mov_b32 v16, v97
  v_cvt_pk_bf16_f32 v80, v96, v97
  v_exp_f32 v100, v36
  v_exp_f32 v101, v37
  v_add_f32 v15, v15, v98
  v_add_f32 v16, v16, v99
  v_cvt_pk_bf16_f32 v81, v98, v99
  v_exp_f32 v102, v38
  v_exp_f32 v103, v39
  v_add_f32 v15, v15, v100
  v_add_f32 v16, v16, v101
  v_cvt_pk_bf16_f32 v82, v100, v101
  v_exp_f32 v96, v40
  v_exp_f32 v97, v41
  v_add_f32 v15, v15, v102
  v_add_f32 v16, v16, v103
  v_cvt_pk_bf16_f32 v83, v102, v103
  v_exp_f32 v98, v42
  v_exp_f32 v99, v43
  v_add_f32 v15, v15, v96
  v_add_f32 v16, v16, v97
  v_cvt_pk_bf16_f32 v84, v96, v97
  v_exp_f32 v100, v44
  v_exp_f32 v101, v45
  v_add_f32 v15, v15, v98
  v_add_f32 v16, v16, v99
  v_cvt_pk_bf16_f32 v85, v98, v99
  v_exp_f32 v102, v46
  v_exp_f32 v103, v47
  v_add_f32 v15, v15, v100
  v_add_f32 v16, v16, v101
  v_cvt_pk_bf16_f32 v86, v100, v101
  v_add_f32 v15, v15, v102
  v_add_f32 v16, v16, v103
  v_cvt_pk_bf16_f32 v87, v102, v103
  v_add_f32 v15, v15, v16
  s_nop 3
  s_branch A_RET61
A_SLOW62:
  s_nop 15
  s_nop 3
  v_max3_f32 v5, v48, v49, v50
  v_max3_f32 v5, v5, v51, v52
  v_max3_f32 v5, v5, v53, v54
  v_max3_f32 v5, v5, v55, v56
  v_max3_f32 v5, v5, v57, v58
  v_max3_f32 v5, v5, v59, v60
  v_max3_f32 v5, v5, v61, v62
  v_max_f32 v5, v5, v63
  v_mov_b32 v6, v5
  s_nop 1
  v_permlane32_swap_b32 v5, v6
  v_max_f32 v5, v5, v6
  v_add_f32 v5, 0x42200000, v5
  v_max_f32 v18, 0, v5
  v_exp_f32 v17, -v18
  v_sub_f32 v64, v64, v18
  v_sub_f32 v48, v48, v18
  v_sub_f32 v65, v65, v18
  v_sub_f32 v49, v49, v18
  v_sub_f32 v66, v66, v18
  v_sub_f32 v50, v50, v18
  v_sub_f32 v67, v67, v18
  v_sub_f32 v51, v51, v18
  v_sub_f32 v68, v68, v18
  v_sub_f32 v52, v52, v18
  v_sub_f32 v69, v69, v18
  v_sub_f32 v53, v53, v18
  v_sub_f32 v70, v70, v18
  v_sub_f32 v54, v54, v18
  v_sub_f32 v71, v71, v18
  v_sub_f32 v55, v55, v18
  v_sub_f32 v72, v72, v18
  v_sub_f32 v56, v56, v18
  v_sub_f32 v73, v73, v18
  v_sub_f32 v57, v57, v18
  v_sub_f32 v74, v74, v18
  v_sub_f32 v58, v58, v18
  v_sub_f32 v75, v75, v18
  v_sub_f32 v59, v59, v18
  v_sub_f32 v76, v76, v18
  v_sub_f32 v60, v60, v18
  v_sub_f32 v77, v77, v18
  v_sub_f32 v61, v61, v18
  v_sub_f32 v78, v78, v18
  v_sub_f32 v62, v62, v18
  v_sub_f32 v79, v79, v18
  v_sub_f32 v63, v63, v18
  v_mul_f32 v10, v10, v17
  v_accvgpr_read_b32 v104, a0
  v_accvgpr_read_b32 v105, a1
  v_accvgpr_read_b32 v106, a2
  v_accvgpr_read_b32 v107, a3
  v_accvgpr_read_b32 v108, a4
  v_accvgpr_read_b32 v109, a5
  v_accvgpr_read_b32 v110, a6
  v_accvgpr_read_b32 v111, a7
  v_mul_f32 v104, v104, v17
  v_mul_f32 v105, v105, v17
  v_mul_f32 v106, v106, v17
  v_mul_f32 v107, v107, v17
  v_mul_f32 v108, v108, v17
  v_mul_f32 v109, v109, v17
  v_mul_f32 v110, v110, v17
  v_mul_f32 v111, v111, v17
  v_accvgpr_write_b32 a0, v104
  v_accvgpr_write_b32 a1, v105
  v_accvgpr_write_b32 a2, v106
  v_accvgpr_write_b32 a3, v107
  v_accvgpr_write_b32 a4, v108
  v_accvgpr_write_b32 a5, v109
  v_accvgpr_write_b32 a6, v110
  v_accvgpr_write_b32 a7, v111
  v_accvgpr_read_b32 v104, a8
  v_accvgpr_read_b32 v105, a9
  v_accvgpr_read_b32 v106, a10
  v_accvgpr_read_b32 v107, a11
  v_accvgpr_read_b32 v108, a12
  v_accvgpr_read_b32 v109, a13
  v_accvgpr_read_b32 v110, a14
  v_accvgpr_read_b32 v111, a15
  v_mul_f32 v104, v104, v17
  v_mul_f32 v105, v105, v17
  v_mul_f32 v106, v106, v17
  v_mul_f32 v107, v107, v17
  v_mul_f32 v108, v108, v17
  v_mul_f32 v109, v109, v17
  v_mul_f32 v110, v110, v17
  v_mul_f32 v111, v111, v17
  v_accvgpr_write_b32 a8, v104
  v_accvgpr_write_b32 a9, v105
  v_accvgpr_write_b32 a10, v106
  v_accvgpr_write_b32 a11, v107
  v_accvgpr_write_b32 a12, v108
  v_accvgpr_write_b32 a13, v109
  v_accvgpr_write_b32 a14, v110
  v_accvgpr_write_b32 a15, v111
  v_accvgpr_read_b32 v104, a16
  v_accvgpr_read_b32 v105, a17
  v_accvgpr_read_b32 v106, a18
  v_accvgpr_read_b32 v107, a19
  v_accvgpr_read_b32 v108, a20
  v_accvgpr_read_b32 v109, a21
  v_accvgpr_read_b32 v110, a22
  v_accvgpr_read_b32 v111, a23
  v_mul_f32 v104, v104, v17
  v_mul_f32 v105, v105, v17
  v_mul_f32 v106, v106, v17
  v_mul_f32 v107, v107, v17
  v_mul_f32 v108, v108, v17
  v_mul_f32 v109, v109, v17
  v_mul_f32 v110, v110, v17
  v_mul_f32 v111, v111, v17
  v_accvgpr_write_b32 a16, v104
  v_accvgpr_write_b32 a17, v105
  v_accvgpr_write_b32 a18, v106
  v_accvgpr_write_b32 a19, v107
  v_accvgpr_write_b32 a20, v108
  v_accvgpr_write_b32 a21, v109
  v_accvgpr_write_b32 a22, v110
  v_accvgpr_write_b32 a23, v111
  v_accvgpr_read_b32 v104, a24
  v_accvgpr_read_b32 v105, a25
  v_accvgpr_read_b32 v106, a26
  v_accvgpr_read_b32 v107, a27
  v_accvgpr_read_b32 v108, a28
  v_accvgpr_read_b32 v109, a29
  v_accvgpr_read_b32 v110, a30
  v_accvgpr_read_b32 v111, a31
  v_mul_f32 v104, v104, v17
  v_mul_f32 v105, v105, v17
  v_mul_f32 v106, v106, v17
  v_mul_f32 v107, v107, v17
  v_mul_f32 v108, v108, v17
  v_mul_f32 v109, v109, v17
  v_mul_f32 v110, v110, v17
  v_mul_f32 v111, v111, v17
  v_accvgpr_write_b32 a24, v104
  v_accvgpr_write_b32 a25, v105
  v_accvgpr_write_b32 a26, v106
  v_accvgpr_write_b32 a27, v107
  v_accvgpr_write_b32 a28, v108
  v_accvgpr_write_b32 a29, v109
  v_accvgpr_write_b32 a30, v110
  v_accvgpr_write_b32 a31, v111
  v_accvgpr_read_b32 v104, a32
  v_accvgpr_read_b32 v105, a33
  v_accvgpr_read_b32 v106, a34
  v_accvgpr_read_b32 v107, a35
  v_accvgpr_read_b32 v108, a36
  v_accvgpr_read_b32 v109, a37
  v_accvgpr_read_b32 v110, a38
  v_accvgpr_read_b32 v111, a39
  v_mul_f32 v104, v104, v17
  v_mul_f32 v105, v105, v17
  v_mul_f32 v106, v106, v17
  v_mul_f32 v107, v107, v17
  v_mul_f32 v108, v108, v17
  v_mul_f32 v109, v109, v17
  v_mul_f32 v110, v110, v17
  v_mul_f32 v111, v111, v17
  v_accvgpr_write_b32 a32, v104
  v_accvgpr_write_b32 a33, v105
  v_accvgpr_write_b32 a34, v106
  v_accvgpr_write_b32 a35, v107
  v_accvgpr_write_b32 a36, v108
  v_accvgpr_write_b32 a37, v109
  v_accvgpr_write_b32 a38, v110
  v_accvgpr_write_b32 a39, v111
  v_accvgpr_read_b32 v104, a40
  v_accvgpr_read_b32 v105, a41
  v_accvgpr_read_b32 v106, a42
  v_accvgpr_read_b32 v107, a43
  v_accvgpr_read_b32 v108, a44
  v_accvgpr_read_b32 v109, a45
  v_accvgpr_read_b32 v110, a46
  v_accvgpr_read_b32 v111, a47
  v_mul_f32 v104, v104, v17
  v_mul_f32 v105, v105, v17
  v_mul_f32 v106, v106, v17
  v_mul_f32 v107, v107, v17
  v_mul_f32 v108, v108, v17
  v_mul_f32 v109, v109, v17
  v_mul_f32 v110, v110, v17
  v_mul_f32 v111, v111, v17
  v_accvgpr_write_b32 a40, v104
  v_accvgpr_write_b32 a41, v105
  v_accvgpr_write_b32 a42, v106
  v_accvgpr_write_b32 a43, v107
  v_accvgpr_write_b32 a44, v108
  v_accvgpr_write_b32 a45, v109
  v_accvgpr_write_b32 a46, v110
  v_accvgpr_write_b32 a47, v111
  v_accvgpr_read_b32 v104, a48
  v_accvgpr_read_b32 v105, a49
  v_accvgpr_read_b32 v106, a50
  v_accvgpr_read_b32 v107, a51
  v_accvgpr_read_b32 v108, a52
  v_accvgpr_read_b32 v109, a53
  v_accvgpr_read_b32 v110, a54
  v_accvgpr_read_b32 v111, a55
  v_mul_f32 v104, v104, v17
  v_mul_f32 v105, v105, v17
  v_mul_f32 v106, v106, v17
  v_mul_f32 v107, v107, v17
  v_mul_f32 v108, v108, v17
  v_mul_f32 v109, v109, v17
  v_mul_f32 v110, v110, v17
  v_mul_f32 v111, v111, v17
  v_accvgpr_write_b32 a48, v104
  v_accvgpr_write_b32 a49, v105
  v_accvgpr_write_b32 a50, v106
  v_accvgpr_write_b32 a51, v107
  v_accvgpr_write_b32 a52, v108
  v_accvgpr_write_b32 a53, v109
  v_accvgpr_write_b32 a54, v110
  v_accvgpr_write_b32 a55, v111
  v_accvgpr_read_b32 v104, a56
  v_accvgpr_read_b32 v105, a57
  v_accvgpr_read_b32 v106, a58
  v_accvgpr_read_b32 v107, a59
  v_accvgpr_read_b32 v108, a60
  v_accvgpr_read_b32 v109, a61
  v_accvgpr_read_b32 v110, a62
  v_accvgpr_read_b32 v111, a63
  v_mul_f32 v104, v104, v17
  v_mul_f32 v105, v105, v17
  v_mul_f32 v106, v106, v17
  v_mul_f32 v107, v107, v17
  v_mul_f32 v108, v108, v17
  v_mul_f32 v109, v109, v17
  v_mul_f32 v110, v110, v17
  v_mul_f32 v111, v111, v17
  v_accvgpr_write_b32 a56, v104
  v_accvgpr_write_b32 a57, v105
  v_accvgpr_write_b32 a58, v106
  v_accvgpr_write_b32 a59, v107
  v_accvgpr_write_b32 a60, v108
  v_accvgpr_write_b32 a61, v109
  v_accvgpr_write_b32 a62, v110
  v_accvgpr_write_b32 a63, v111
  v_exp_f32 v96, v48
  v_exp_f32 v97, v49
  v_exp_f32 v98, v50
  v_exp_f32 v99, v51
  v_mov_b32 v15, v96
  v_mov_b32 v16, v97
  v_cvt_pk_bf16_f32 v88, v96, v97
  v_exp_f32 v100, v52
  v_exp_f32 v101, v53
  v_add_f32 v15, v15, v98
  v_add_f32 v16, v16, v99
  v_cvt_pk_bf16_f32 v89, v98, v99
  v_exp_f32 v102, v54
  v_exp_f32 v103, v55
  v_add_f32 v15, v15, v100
  v_add_f32 v16, v16, v101
  v_cvt_pk_bf16_f32 v90, v100, v101
  v_exp_f32 v96, v56
  v_exp_f32 v97, v57
  v_add_f32 v15, v15, v102
  v_add_f32 v16, v16, v103
  v_cvt_pk_bf16_f32 v91, v102, v103
  v_exp_f32 v98, v58
  v_exp_f32 v99, v59
  v_add_f32 v15, v15, v96
  v_add_f32 v16, v16, v97
  v_cvt_pk_bf16_f32 v92, v96, v97
  v_exp_f32 v100, v60
  v_exp_f32 v101, v61
  v_add_f32 v15, v15, v98
  v_add_f32 v16, v16, v99
  v_cvt_pk_bf16_f32 v93, v98, v99
  v_exp_f32 v102, v62
  v_exp_f32 v103, v63
  v_add_f32 v15, v15, v100
  v_add_f32 v16, v16, v101
  v_cvt_pk_bf16_f32 v94, v100, v101
  v_add_f32 v15, v15, v102
  v_add_f32 v16, v16, v103
  v_cvt_pk_bf16_f32 v95, v102, v103
  v_add_f32 v15, v15, v16
  s_nop 3
  s_branch A_RET63
A_SLOW66:
  s_nop 15
  s_nop 3
  v_max3_f32 v5, v32, v33, v34
  v_max3_f32 v5, v5, v35, v36
  v_max3_f32 v5, v5, v37, v38
  v_max3_f32 v5, v5, v39, v40
  v_max3_f32 v5, v5, v41, v42
  v_max3_f32 v5, v5, v43, v44
  v_max3_f32 v5, v5, v45, v46
  v_max_f32 v5, v5, v47
  v_mov_b32 v6, v5
  s_nop 1
  v_permlane32_swap_b32 v5, v6
  v_max_f32 v5, v5, v6
  v_add_f32 v5, 0x42200000, v5
  v_max_f32 v18, 0, v5
  v_exp_f32 v17, -v18
  v_sub_f32 v64, v64, v18
  v_sub_f32 v32, v32, v18
  v_sub_f32 v65, v65, v18
  v_sub_f32 v33, v33, v18
  v_sub_f32 v66, v66, v18
  v_sub_f32 v34, v34, v18
  v_sub_f32 v67, v67, v18
  v_sub_f32 v35, v35, v18
  v_sub_f32 v68, v68, v18
  v_sub_f32 v36, v36, v18
  v_sub_f32 v69, v69, v18
  v_sub_f32 v37, v37, v18
  v_sub_f32 v70, v70, v18
  v_sub_f32 v38, v38, v18
  v_sub_f32 v71, v71, v18
  v_sub_f32 v39, v39, v18
  v_sub_f32 v72, v72, v18
  v_sub_f32 v40, v40, v18
  v_sub_f32 v73, v73, v18
  v_sub_f32 v41, v41, v18
  v_sub_f32 v74, v74, v18
  v_sub_f32 v42, v42, v18
  v_sub_f32 v75, v75, v18
  v_sub_f32 v43, v43, v18
  v_sub_f32 v76, v76, v18
  v_sub_f32 v44, v44, v18
  v_sub_f32 v77, v77, v18
  v_sub_f32 v45, v45, v18
  v_sub_f32 v78, v78, v18
  v_sub_f32 v46, v46, v18
  v_sub_f32 v79, v79, v18
  v_sub_f32 v47, v47, v18
  v_mul_f32 v10, v10, v17
  v_accvgpr_read_b32 v104, a0
  v_accvgpr_read_b32 v105, a1
  v_accvgpr_read_b32 v106, a2
  v_accvgpr_read_b32 v107, a3
  v_accvgpr_read_b32 v108, a4
  v_accvgpr_read_b32 v109, a5
  v_accvgpr_read_b32 v110, a6
  v_accvgpr_read_b32 v111, a7
  v_mul_f32 v104, v104, v17
  v_mul_f32 v105, v105, v17
  v_mul_f32 v106, v106, v17
  v_mul_f32 v107, v107, v17
  v_mul_f32 v108, v108, v17
  v_mul_f32 v109, v109, v17
  v_mul_f32 v110, v110, v17
  v_mul_f32 v111, v111, v17
  v_accvgpr_write_b32 a0, v104
  v_accvgpr_write_b32 a1, v105
  v_accvgpr_write_b32 a2, v106
  v_accvgpr_write_b32 a3, v107
  v_accvgpr_write_b32 a4, v108
  v_accvgpr_write_b32 a5, v109
  v_accvgpr_write_b32 a6, v110
  v_accvgpr_write_b32 a7, v111
  v_accvgpr_read_b32 v104, a8
  v_accvgpr_read_b32 v105, a9
  v_accvgpr_read_b32 v106, a10
  v_accvgpr_read_b32 v107, a11
  v_accvgpr_read_b32 v108, a12
  v_accvgpr_read_b32 v109, a13
  v_accvgpr_read_b32 v110, a14
  v_accvgpr_read_b32 v111, a15
  v_mul_f32 v104, v104, v17
  v_mul_f32 v105, v105, v17
  v_mul_f32 v106, v106, v17
  v_mul_f32 v107, v107, v17
  v_mul_f32 v108, v108, v17
  v_mul_f32 v109, v109, v17
  v_mul_f32 v110, v110, v17
  v_mul_f32 v111, v111, v17
  v_accvgpr_write_b32 a8, v104
  v_accvgpr_write_b32 a9, v105
  v_accvgpr_write_b32 a10, v106
  v_accvgpr_write_b32 a11, v107
  v_accvgpr_write_b32 a12, v108
  v_accvgpr_write_b32 a13, v109
  v_accvgpr_write_b32 a14, v110
  v_accvgpr_write_b32 a15, v111
  v_accvgpr_read_b32 v104, a16
  v_accvgpr_read_b32 v105, a17
  v_accvgpr_read_b32 v106, a18
  v_accvgpr_read_b32 v107, a19
  v_accvgpr_read_b32 v108, a20
  v_accvgpr_read_b32 v109, a21
  v_accvgpr_read_b32 v110, a22
  v_accvgpr_read_b32 v111, a23
  v_mul_f32 v104, v104, v17
  v_mul_f32 v105, v105, v17
  v_mul_f32 v106, v106, v17
  v_mul_f32 v107, v107, v17
  v_mul_f32 v108, v108, v17
  v_mul_f32 v109, v109, v17
  v_mul_f32 v110, v110, v17
  v_mul_f32 v111, v111, v17
  v_accvgpr_write_b32 a16, v104
  v_accvgpr_write_b32 a17, v105
  v_accvgpr_write_b32 a18, v106
  v_accvgpr_write_b32 a19, v107
  v_accvgpr_write_b32 a20, v108
  v_accvgpr_write_b32 a21, v109
  v_accvgpr_write_b32 a22, v110
  v_accvgpr_write_b32 a23, v111
  v_accvgpr_read_b32 v104, a24
  v_accvgpr_read_b32 v105, a25
  v_accvgpr_read_b32 v106, a26
  v_accvgpr_read_b32 v107, a27
  v_accvgpr_read_b32 v108, a28
  v_accvgpr_read_b32 v109, a29
  v_accvgpr_read_b32 v110, a30
  v_accvgpr_read_b32 v111, a31
  v_mul_f32 v104, v104, v17
  v_mul_f32 v105, v105, v17
  v_mul_f32 v106, v106, v17
  v_mul_f32 v107, v107, v17
  v_mul_f32 v108, v108, v17
  v_mul_f32 v109, v109, v17
  v_mul_f32 v110, v110, v17
  v_mul_f32 v111, v111, v17
  v_accvgpr_write_b32 a24, v104
  v_accvgpr_write_b32 a25, v105
  v_accvgpr_write_b32 a26, v106
  v_accvgpr_write_b32 a27, v107
  v_accvgpr_write_b32 a28, v108
  v_accvgpr_write_b32 a29, v109
  v_accvgpr_write_b32 a30, v110
  v_accvgpr_write_b32 a31, v111
  v_accvgpr_read_b32 v104, a32
  v_accvgpr_read_b32 v105, a33
  v_accvgpr_read_b32 v106, a34
  v_accvgpr_read_b32 v107, a35
  v_accvgpr_read_b32 v108, a36
  v_accvgpr_read_b32 v109, a37
  v_accvgpr_read_b32 v110, a38
  v_accvgpr_read_b32 v111, a39
  v_mul_f32 v104, v104, v17
  v_mul_f32 v105, v105, v17
  v_mul_f32 v106, v106, v17
  v_mul_f32 v107, v107, v17
  v_mul_f32 v108, v108, v17
  v_mul_f32 v109, v109, v17
  v_mul_f32 v110, v110, v17
  v_mul_f32 v111, v111, v17
  v_accvgpr_write_b32 a32, v104
  v_accvgpr_write_b32 a33, v105
  v_accvgpr_write_b32 a34, v106
  v_accvgpr_write_b32 a35, v107
  v_accvgpr_write_b32 a36, v108
  v_accvgpr_write_b32 a37, v109
  v_accvgpr_write_b32 a38, v110
  v_accvgpr_write_b32 a39, v111
  v_accvgpr_read_b32 v104, a40
  v_accvgpr_read_b32 v105, a41
  v_accvgpr_read_b32 v106, a42
  v_accvgpr_read_b32 v107, a43
  v_accvgpr_read_b32 v108, a44
  v_accvgpr_read_b32 v109, a45
  v_accvgpr_read_b32 v110, a46
  v_accvgpr_read_b32 v111, a47
  v_mul_f32 v104, v104, v17
  v_mul_f32 v105, v105, v17
  v_mul_f32 v106, v106, v17
  v_mul_f32 v107, v107, v17
  v_mul_f32 v108, v108, v17
  v_mul_f32 v109, v109, v17
  v_mul_f32 v110, v110, v17
  v_mul_f32 v111, v111, v17
  v_accvgpr_write_b32 a40, v104
  v_accvgpr_write_b32 a41, v105
  v_accvgpr_write_b32 a42, v106
  v_accvgpr_write_b32 a43, v107
  v_accvgpr_write_b32 a44, v108
  v_accvgpr_write_b32 a45, v109
  v_accvgpr_write_b32 a46, v110
  v_accvgpr_write_b32 a47, v111
  v_accvgpr_read_b32 v104, a48
  v_accvgpr_read_b32 v105, a49
  v_accvgpr_read_b32 v106, a50
  v_accvgpr_read_b32 v107, a51
  v_accvgpr_read_b32 v108, a52
  v_accvgpr_read_b32 v109, a53
  v_accvgpr_read_b32 v110, a54
  v_accvgpr_read_b32 v111, a55
  v_mul_f32 v104, v104, v17
  v_mul_f32 v105, v105, v17
  v_mul_f32 v106, v106, v17
  v_mul_f32 v107, v107, v17
  v_mul_f32 v108, v108, v17
  v_mul_f32 v109, v109, v17
  v_mul_f32 v110, v110, v17
  v_mul_f32 v111, v111, v17
  v_accvgpr_write_b32 a48, v104
  v_accvgpr_write_b32 a49, v105
  v_accvgpr_write_b32 a50, v106
  v_accvgpr_write_b32 a51, v107
  v_accvgpr_write_b32 a52, v108
  v_accvgpr_write_b32 a53, v109
  v_accvgpr_write_b32 a54, v110
  v_accvgpr_write_b32 a55, v111
  v_accvgpr_read_b32 v104, a56
  v_accvgpr_read_b32 v105, a57
  v_accvgpr_read_b32 v106, a58
  v_accvgpr_read_b32 v107, a59
  v_accvgpr_read_b32 v108, a60
  v_accvgpr_read_b32 v109, a61
  v_accvgpr_read_b32 v110, a62
  v_accvgpr_read_b32 v111, a63
  v_mul_f32 v104, v104, v17
  v_mul_f32 v105, v105, v17
  v_mul_f32 v106, v106, v17
  v_mul_f32 v107, v107, v17
  v_mul_f32 v108, v108, v17
  v_mul_f32 v109, v109, v17
  v_mul_f32 v110, v110, v17
  v_mul_f32 v111, v111, v17
  v_accvgpr_write_b32 a56, v104
  v_accvgpr_write_b32 a57, v105
  v_accvgpr_write_b32 a58, v106
  v_accvgpr_write_b32 a59, v107
  v_accvgpr_write_b32 a60, v108
  v_accvgpr_write_b32 a61, v109
  v_accvgpr_write_b32 a62, v110
  v_accvgpr_write_b32 a63, v111
  v_exp_f32 v96, v32
  v_exp_f32 v97, v33
  v_exp_f32 v98, v34
  v_exp_f32 v99, v35
  v_mov_b32 v15, v96
  v_mov_b32 v16, v97
  v_cvt_pk_bf16_f32 v80, v96, v97
  v_exp_f32 v100, v36
  v_exp_f32 v101, v37
  v_add_f32 v15, v15, v98
  v_add_f32 v16, v16, v99
  v_cvt_pk_bf16_f32 v81, v98, v99
  v_exp_f32 v102, v38
  v_exp_f32 v103, v39
  v_add_f32 v15, v15, v100
  v_add_f32 v16, v16, v101
  v_cvt_pk_bf16_f32 v82, v100, v101
  v_exp_f32 v96, v40
  v_exp_f32 v97, v41
  v_add_f32 v15, v15, v102
  v_add_f32 v16, v16, v103
  v_cvt_pk_bf16_f32 v83, v102, v103
  v_exp_f32 v98, v42
  v_exp_f32 v99, v43
  v_add_f32 v15, v15, v96
  v_add_f32 v16, v16, v97
  v_cvt_pk_bf16_f32 v84, v96, v97
  v_exp_f32 v100, v44
  v_exp_f32 v101, v45
  v_add_f32 v15, v15, v98
  v_add_f32 v16, v16, v99
  v_cvt_pk_bf16_f32 v85, v98, v99
  v_exp_f32 v102, v46
  v_exp_f32 v103, v47
  v_add_f32 v15, v15, v100
  v_add_f32 v16, v16, v101
  v_cvt_pk_bf16_f32 v86, v100, v101
  v_add_f32 v15, v15, v102
  v_add_f32 v16, v16, v103
  v_cvt_pk_bf16_f32 v87, v102, v103
  v_add_f32 v15, v15, v16
  s_nop 3
  s_branch A_RET67
F_CODE_END:
  s_endpgm
.section .rodata,"a"
.p2align 6
.amdhsa_kernel concat_heads__compressed_kv_cla__linear_kernel_hedgehog__prompt_kernel
  .amdhsa_next_free_vgpr 256
  .amdhsa_next_free_sgpr 102
  .amdhsa_accum_offset 128
  .amdhsa_group_segment_fixed_size 0
  .amdhsa_kernarg_size 104
  .amdhsa_user_sgpr_count 2
  .amdhsa_user_sgpr_kernarg_segment_ptr 1
  .amdhsa_system_sgpr_workgroup_id_x 1
.end_amdhsa_kernel
```
